```python
import torch

def _softmax(x, axis=-1):
    return torch.softmax(x, dim=axis)
def _gelu(x):
    return torch.nn.functional.gelu(x, approximate="tanh")
def _silu(x):
    return torch.nn.functional.silu(x)
def _sigmoid(x):
    return torch.sigmoid(x)
def _layernorm(x, axis=-1, eps=1e-5):
    m = x.mean(dim=axis, keepdim=True)
    v = x.var(dim=axis, keepdim=True, unbiased=False)
    return (x - m) / torch.sqrt(v + eps)
def _scatter_add(tgt, idx, src, axis=0):
    return tgt.clone().index_add_(axis, idx, src)
def _segment_sum(src, seg, n):
    out = torch.zeros((n,) + src.shape[1:], dtype=src.dtype)
    return out.index_add_(0, seg, src)
def _pad(x, pw):
    flat = tuple(v for pair in reversed(pw) for v in pair)
    return torch.nn.functional.pad(x, flat)

kernel_name = 'recurrent_scan__gqa_block_cached__glu_gated_geglu__prompt'

def setup_inputs():

    _w = (lambda a: (lambda t: t.to(torch.bfloat16) if t.is_floating_point() else t)(torch.as_tensor(a)))
    def _A_setup():
        B, Sq, D = 1, 2048, 448
        Hq, Hkv, Sk, Dh = 16, 8, 2048, 256
        assert Hq % Hkv == 0, (Hq, Hkv)
        return {
            "x": _w((lambda *s: torch.randn(*s, dtype=torch.bfloat16) * 0.05)(B, Sq, D)),
            "k_cache": _w((lambda *s: torch.randn(*s, dtype=torch.bfloat16) * 3.2)(B, Hkv, Sk, Dh)),
            "v_cache": _w((lambda *s: torch.randn(*s, dtype=torch.bfloat16) * 3.2)(B, Hkv, Sk, Dh)),
            "wq": _w((lambda *s: torch.randn(*s, dtype=torch.bfloat16) * 3.2)(D, Hq * Dh) * (D ** -0.5)),
            "wo": _w((lambda *s: torch.randn(*s, dtype=torch.bfloat16) * 3.2)(Hq * Dh, D) * ((Hq * Dh) ** -0.5)),
        }
    _A_in = _A_setup()

    def _B_setup():
        B, S, Dm, Df = 1, 2048, 448, 1792
        return {
            "x": _w((lambda *s: torch.randn(*s, dtype=torch.bfloat16) * 0.05)(B, S, Dm)),
            "w_gate": _w((lambda *s: torch.randn(*s, dtype=torch.bfloat16) * 0.4)(Dm, Df) * (Dm ** -0.5)),
            "w_up": _w((lambda *s: torch.randn(*s, dtype=torch.bfloat16) * 0.4)(Dm, Df) * (Dm ** -0.5)),
            "w_down": _w((lambda *s: torch.randn(*s, dtype=torch.bfloat16) * 0.4)(Df, Dm) * (Df ** -0.5)),
        }
    _B_in = _B_setup()

    return {
        "A_x": _A_in["x"],
        "A_k_cache": _A_in["k_cache"],
        "A_v_cache": _A_in["v_cache"],
        "A_wq": _A_in["wq"],
        "A_wo": _A_in["wo"],
        "B_x": _B_in["x"],
        "B_w_gate": _B_in["w_gate"],
        "B_w_up": _B_in["w_up"],
        "B_w_down": _B_in["w_down"],
    }

def reference(A_x, A_k_cache, A_v_cache, A_wq, A_wo, B_x, B_w_gate, B_w_up, B_w_down):
    def _A_ref(x, k_cache, v_cache, wq, wo):
        B, Sq, D = x.shape
        Hq, Dh = 16, 256
        Hkv = k_cache.shape[1]
        rep = Hq // Hkv
        q = (lambda x, *d: x.permute(*d))((x @ wq).reshape(B, Sq, Hq, Dh), 0, 2, 1, 3)
        k = (lambda x, n, axis: torch.repeat_interleave(x, n, dim=axis))(k_cache, rep, axis=1)
        v = (lambda x, n, axis: torch.repeat_interleave(x, n, dim=axis))(v_cache, rep, axis=1)
        scores = torch.einsum("bhqd,bhkd->bhqk", q, k) * (Dh ** -0.5)
        p = _softmax(scores, axis=-1)
        o = torch.einsum("bhqk,bhkd->bhqd", p, v)
        return (lambda x, *d: x.permute(*d))(o, 0, 2, 1, 3).reshape(B, Sq, Hq * Dh) @ wo

    def _B_ref(x, w_gate, w_up, w_down):
        g = torch.einsum("bsd,df->bsf", x, w_gate)
        u = torch.einsum("bsd,df->bsf", x, w_up)
        h = _gelu(g) * u
        return torch.einsum("bsf,fd->bsd", h, w_down)

    x = A_x
    xn = _layernorm(x, axis=-1)
    s = _A_ref(xn, A_k_cache, A_v_cache, A_wq, A_wo)
    g = _silu(_B_ref(xn, B_w_gate, B_w_up, B_w_down))
    return x + s * g
```

```asm
; @launch kernel=ka_kernel grid=(256,1,1) block=(256,1,1) lds=163840
; @launch kernel=kb_kernel grid=(224,1,1) block=(256,1,1) lds=131072
.amdgcn_target "amdgcn-amd-amdhsa--gfx950"
.text
.globl ka_kernel
.p2align 8
.type ka_kernel,@function
ka_kernel:
    s_cmp_ge_u32 s2, 256
    s_cbranch_scc1 ka_kernel_end
    s_load_dwordx8 s[4:11], s[0:1], 0
    s_load_dwordx4 s[80:83], s[0:1], 48
    s_load_dwordx2 s[84:85], s[0:1], 88
    s_load_dwordx2 s[94:95], s[0:1], 32
    s_load_dwordx2 s[96:97], s[0:1], 64
    s_getpc_b64 s[98:99]
ka_kernel_pc:
    s_lshr_b32 s3, s2, 3
    s_lshl_b32 s3, s3, 11
    v_lshl_add_u32 v252, v0, 3, s3
    s_mov_b32 s3, kb_kernel_end-ka_kernel_pc-4
    v_min_u32 v252, s3, v252
    v_mov_b32 v253, s99
    v_add_co_u32 v252, vcc, s98, v252
    s_nop 1
    v_addc_co_u32 v253, vcc, 0, v253, vcc
    global_load_dword v254, v[252:253], off
    v_lshrrev_b32 v251, 6, v0
    v_and_b32 v255, 63, v0
    s_and_b32 s29, s2, 7
    v_readfirstlane_b32 s24, v251
    s_lshr_b32 s30, s2, 3
    s_lshr_b32 s27, s30, 4
    s_lshl_b32 s3, s29, 1
    s_add_u32 s27, s27, s3
    s_and_b32 s28, s30, 15
    s_lshr_b32 s25, s24, 1
    s_and_b32 s26, s24, 1
    s_lshr_b32 s3, s30, 4
    s_mul_i32 s3, s3, 0
    s_add_u32 s36, s28, s3
    s_mul_i32 s3, s36, 37
    s_lshr_b32 s3, s3, 8
    s_mul_i32 s3, s3, 7
    s_sub_u32 s36, s36, s3
    s_lshl_b32 s87, s36, 7
    s_mul_i32 s86, s36, 229376
    s_lshl_b32 s93, s24, 12
    s_mul_i32 s92, s25, 7168
    s_mul_i32 s3, s26, 3072
    s_add_u32 s92, s92, s3
    s_lshl_b32 s3, s28, 7
    s_lshl_b32 s34, s24, 5
    s_add_u32 s34, s34, s3
    s_mul_i32 s34, s34, 896
    s_movk_i32 s3, 896
    v_lshrrev_b32 v232, 3, v255
    v_mul_u32_u24 v232, s3, v232
    v_add_u32 v232, s34, v232
    v_lshrrev_b32 v233, 4, v255
    v_xor_b32 v233, v233, v255
    v_and_b32 v233, 7, v233
    v_lshl_add_u32 v172, v233, 4, v232
    v_xor_b32 v233, 4, v233
    v_lshl_add_u32 v173, v233, 4, v232
    v_add_u32 v173, 6144, v173
    v_add_u32 v174, 12288, v172
    v_add_u32 v175, 12288, v173
    s_mul_i32 s34, s26, 192
    s_movk_i32 s3, 4682
    s_movk_i32 s37, 3584
    s_mul_i32 s38, s27, 224
    v_add_u32 v235, s34, v255
    v_mul_u32_u24 v232, s3, v235
    v_lshrrev_b32 v232, 16, v232
    v_mul_u32_u24 v233, 14, v232
    v_sub_u32 v233, v235, v233
    v_lshrrev_b32 v234, 1, v232
    v_xor_b32 v234, v234, v232
    v_bfe_u32 v234, v234, 2, 1
    v_mul_u32_u24 v234, 12, v234
    v_xor_b32 v232, v232, v234
    v_lshl_add_u32 v233, v233, 4, s38
    v_mad_u32_u24 v168, v232, s37, v233
    v_add_u32 v235, 64, v235
    s_sub_u32 s38, s38, 1024
    v_mul_u32_u24 v232, s3, v235
    v_lshrrev_b32 v232, 16, v232
    v_mul_u32_u24 v233, 14, v232
    v_sub_u32 v233, v235, v233
    v_lshrrev_b32 v234, 1, v232
    v_xor_b32 v234, v234, v232
    v_bfe_u32 v234, v234, 2, 1
    v_mul_u32_u24 v234, 12, v234
    v_xor_b32 v232, v232, v234
    v_lshl_add_u32 v233, v233, 4, s38
    v_mad_u32_u24 v169, v232, s37, v233
    v_add_u32 v235, 64, v235
    s_sub_u32 s38, s38, 1024
    v_mul_u32_u24 v232, s3, v235
    v_lshrrev_b32 v232, 16, v232
    v_mul_u32_u24 v233, 14, v232
    v_sub_u32 v233, v235, v233
    v_lshrrev_b32 v234, 1, v232
    v_xor_b32 v234, v234, v232
    v_bfe_u32 v234, v234, 2, 1
    v_mul_u32_u24 v234, 12, v234
    v_xor_b32 v232, v232, v234
    v_lshl_add_u32 v233, v233, 4, s38
    v_mad_u32_u24 v170, v232, s37, v233
    v_add_u32 v235, 64, v235
    s_sub_u32 s38, s38, 1024
    v_mul_u32_u24 v232, s3, v235
    v_lshrrev_b32 v232, 16, v232
    v_mul_u32_u24 v233, 14, v232
    v_sub_u32 v233, v235, v233
    v_lshrrev_b32 v234, 1, v232
    v_xor_b32 v234, v234, v232
    v_bfe_u32 v234, v234, 2, 1
    v_mul_u32_u24 v234, 12, v234
    v_xor_b32 v232, v232, v234
    v_lshl_add_u32 v233, v233, 4, s38
    v_mad_u32_u24 v171, v232, s37, v233
    s_lshl_b32 s34, s29, 20
    s_cmp_eq_u32 s25, 0
    s_waitcnt lgkmcnt(0)
    s_load_dwordx2 s[32:33], s[8:9], s34
    s_mov_b32 s44, s4
    s_mov_b32 s45, s5
    s_mov_b32 s46, 1835008
    s_mov_b32 s47, 0x00020000
    s_cselect_b32 s40, s80, s82
    s_cselect_b32 s41, s81, s83
    s_mov_b32 s42, 1605632
    s_mov_b32 s43, 0x00020000
    s_add_u32 m0, s93, 43008
    s_nop 0
    buffer_load_dwordx4 v172, s[44:47], s87 offen offset:0 lds
    buffer_load_dwordx4 v173, s[44:47], s87 offen offset:1024 lds
    buffer_load_dwordx4 v174, s[44:47], s87 offen offset:2048 lds
    buffer_load_dwordx4 v175, s[44:47], s87 offen offset:3072 lds
    s_add_u32 s87, s87, 128
    s_cmp_eq_u32 s87, 896
    s_cselect_b32 s87, 0, s87
    s_add_u32 m0, s92, 59392
    s_nop 0
    buffer_load_dwordx4 v168, s[40:43], s86 offen offset:0 lds
    buffer_load_dwordx4 v169, s[40:43], s86 offen offset:1024 lds
    buffer_load_dwordx4 v170, s[40:43], s86 offen offset:2048 lds
    buffer_load_dwordx4 v171, s[40:43], s86 offen offset:3072 lds
    s_add_u32 s86, s86, 114688
    s_cmp_eq_u32 s86, 1605632
    s_cselect_b32 s86, 0, s86
    s_add_u32 m0, s92, 28672
    s_nop 0
    buffer_load_dwordx4 v168, s[40:43], s86 offen offset:0 lds
    buffer_load_dwordx4 v169, s[40:43], s86 offen offset:1024 lds
    buffer_load_dwordx4 v170, s[40:43], s86 offen offset:2048 lds
    buffer_load_dwordx4 v171, s[40:43], s86 offen offset:3072 lds
    s_add_u32 s86, s86, 114688
    s_cmp_eq_u32 s86, 1605632
    s_cselect_b32 s86, 0, s86
    v_lshrrev_b32 v232, 4, v255
    v_bfe_u32 v233, v255, 1, 3
    v_xor_b32 v232, v232, v233
    v_and_b32 v233, 15, v255
    v_lshlrev_b32 v233, 7, v233
    v_lshl_add_u32 v232, v232, 4, v233
    v_add_u32 v160, s93, v232
    v_xor_b32 v161, 64, v160
    v_xor_b32 v162, 0x1000, v160
    v_xor_b32 v163, 64, v162
    v_add_u32 v164, 88064, v160
    v_add_u32 v165, 88064, v161
    v_add_u32 v166, 88064, v162
    v_add_u32 v167, 88064, v163
    v_bfe_u32 v233, v255, 2, 2
    s_mov_b32 s3, 224
    v_mul_u32_u24 v233, s3, v233
    v_bfe_u32 v232, v255, 4, 1
    s_mov_b32 s3, 896
    v_mad_u32_u24 v233, v232, s3, v233
    v_bfe_u32 v232, v255, 5, 1
    s_mov_b32 s3, 3584
    v_mad_u32_u24 v233, v232, s3, v233
    v_bfe_u32 v232, v255, 0, 2
    v_lshl_add_u32 v233, v232, 3, v233
    v_add_u32 v233, 28672, v233
    s_lshl_b32 s3, s26, 7
    s_mul_i32 s34, s25, 7168
    v_add_u32 v192, s3, v233
    v_add_u32 v194, 96, v233
    v_add_u32 v196, s34, v192
    v_add_u32 v198, s34, v194
    v_add_u32 v193, 75776, v192
    v_add_u32 v195, 75776, v194
    v_add_u32 v197, 75776, v196
    v_add_u32 v199, 75776, v198
    v_mov_b32 v144, 0x3f803f80
    v_mov_b32 v145, 0x3f803f80
    v_mov_b32 v146, 0x3f803f80
    v_mov_b32 v147, 0x3f803f80
    s_add_u32 m0, s93, 147456
    s_nop 0
    buffer_load_dwordx4 v172, s[44:47], s87 offen offset:0 lds
    buffer_load_dwordx4 v173, s[44:47], s87 offen offset:1024 lds
    buffer_load_dwordx4 v174, s[44:47], s87 offen offset:2048 lds
    buffer_load_dwordx4 v175, s[44:47], s87 offen offset:3072 lds
    s_add_u32 s87, s87, 128
    s_cmp_eq_u32 s87, 896
    s_cselect_b32 s87, 0, s87
    s_add_u32 m0, s92, 133120
    s_nop 0
    buffer_load_dwordx4 v168, s[40:43], s86 offen offset:0 lds
    buffer_load_dwordx4 v169, s[40:43], s86 offen offset:1024 lds
    buffer_load_dwordx4 v170, s[40:43], s86 offen offset:2048 lds
    buffer_load_dwordx4 v171, s[40:43], s86 offen offset:3072 lds
    s_add_u32 s86, s86, 114688
    s_cmp_eq_u32 s86, 1605632
    s_cselect_b32 s86, 0, s86
    s_waitcnt vmcnt(12)
    s_barrier
    ds_read_b128 a[0:3], v160 offset:43008
    ds_read_b128 a[4:7], v160 offset:45056
    ds_read_b128 a[8:11], v162 offset:43008
    ds_read_b128 a[12:15], v162 offset:45056
    ds_read_b64_tr_b16 v[208:209], v192 offset:30720
    ds_read_b64_tr_b16 v[212:213], v196 offset:30720
    ds_read_b64_tr_b16 v[216:217], v192 offset:37888
    ds_read_b64_tr_b16 v[220:221], v196 offset:30752
    ds_read_b64_tr_b16 v[224:225], v192 offset:30752
    ds_read_b64_tr_b16 v[210:211], v192 offset:32512
    ds_read_b64_tr_b16 v[214:215], v196 offset:32512
    s_waitcnt lgkmcnt(0)
    v_mfma_f32_16x16x32_bf16 v[0:3], v[208:211], a[0:3], 0
    s_add_u32 m0, s92, 118784
    ds_read_b64_tr_b16 v[218:219], v192 offset:39680
    ds_read_b64_tr_b16 v[222:223], v196 offset:32544
    ds_read_b64_tr_b16 v[226:227], v192 offset:32544
    v_mfma_f32_16x16x32_bf16 v[8:11], v[208:211], a[4:7], 0
    buffer_load_dwordx4 v168, s[40:43], s86 offen offset:0 lds
    ds_read_b128 a[16:19], v161 offset:43008
    v_mfma_f32_16x16x32_bf16 v[16:19], v[208:211], a[8:11], 0
    ds_read_b128 a[20:23], v161 offset:45056
    ds_read_b64_tr_b16 v[228:229], v196 offset:30784
    v_mfma_f32_16x16x32_bf16 v[24:27], v[208:211], a[12:15], 0
    ds_read_b128 a[24:27], v163 offset:43008
    ds_read_b64_tr_b16 v[230:231], v196 offset:32576
    v_mfma_f32_16x16x32_bf16 v[112:115], v[212:215], v[144:147], 0
    s_waitcnt vmcnt(9)
    s_barrier
    ds_read_b128 a[28:31], v163 offset:45056
    v_mfma_f32_16x16x32_bf16 v[128:131], v[144:147], a[0:3], 0
    s_lshl_b32 s29, s29, 20
    buffer_load_dwordx4 v169, s[40:43], s86 offen offset:1024 lds
    s_add_u32 s12, s6, s29
    v_mfma_f32_16x16x32_bf16 v[136:139], a[0:3], a[0:3], 0
    s_addc_u32 s13, s7, 0
    ds_read_b64_tr_b16 v[200:201], v192 offset:37920
    s_mov_b32 s14, 0x100000
    v_mfma_f32_16x16x32_bf16 v[132:135], v[144:147], a[4:7], 0
    s_mov_b32 s15, 0x00020000
    ds_read_b64_tr_b16 v[202:203], v192 offset:39712
    v_mfma_f32_16x16x32_bf16 v[140:143], a[4:7], a[4:7], 0
    s_waitcnt lgkmcnt(9)
    buffer_load_dwordx4 v170, s[40:43], s86 offen offset:2048 lds
    v_mfma_f32_16x16x32_bf16 v[4:7], v[216:219], a[0:3], 0
    s_add_u32 s16, s8, s29
    s_addc_u32 s17, s9, 0
    v_mfma_f32_16x16x32_bf16 v[12:15], v[216:219], a[4:7], 0
    s_mov_b32 s18, 0x100000
    ds_read_b64_tr_b16 v[204:205], v198 offset:30720
    v_mfma_f32_16x16x32_bf16 v[20:23], v[216:219], a[8:11], 0
    ds_read_b64_tr_b16 v[206:207], v198 offset:32512
    ds_read_b64_tr_b16 v[208:209], v192 offset:30784
    v_mfma_f32_16x16x32_bf16 v[28:31], v[216:219], a[12:15], 0
    buffer_load_dwordx4 v171, s[40:43], s86 offen offset:3072 lds
    s_add_u32 s86, s86, 114688
    v_mfma_f32_16x16x32_bf16 v[116:119], v[220:223], v[144:147], 0
    s_waitcnt lgkmcnt(6)
    ds_read_b64_tr_b16 v[210:211], v192 offset:32576
    s_cmp_eq_u32 s86, 1605632
    v_mfma_f32_16x16x32_bf16 v[32:35], v[224:227], a[0:3], 0
    s_cselect_b32 s86, 0, s86
    s_mov_b32 s19, 0x00020000
    s_sub_u32 s88, s10, 4096
    v_mfma_f32_16x16x32_bf16 v[40:43], v[224:227], a[4:7], 0
    s_subb_u32 s89, s11, 0
    ds_read_b64_tr_b16 v[212:213], v194 offset:30720
    s_mov_b32 s90, 3674112
    v_mfma_f32_16x16x32_bf16 v[48:51], v[224:227], a[8:11], 0
    s_add_u32 m0, s93, 88064
    s_nop 0
    buffer_load_dwordx4 v172, s[44:47], s87 offen offset:0 lds
    ds_read_b64_tr_b16 v[214:215], v194 offset:32512
    v_mfma_f32_16x16x32_bf16 v[56:59], v[224:227], a[12:15], 0
    s_mov_b32 s91, 0x00020000
    ds_read_b64_tr_b16 v[216:217], v192 offset:37952
    v_mfma_f32_16x16x32_bf16 v[120:123], v[228:231], v[144:147], 0
    s_mov_b32 s20, s84
    ds_read_b64_tr_b16 v[218:219], v192 offset:39744
    v_mfma_f32_16x16x32_bf16 v[128:131], v[144:147], a[16:19], v[128:131]
    s_mov_b32 s21, s85
    s_mov_b32 s22, 67108864
    v_mfma_f32_16x16x32_bf16 v[136:139], a[16:19], a[16:19], v[136:139]
    s_mov_b32 s23, 0x00020000
    buffer_load_dwordx4 v173, s[44:47], s87 offen offset:1024 lds
    v_mfma_f32_16x16x32_bf16 v[132:135], v[144:147], a[20:23], v[132:135]
    s_lshl_b32 s3, s36, 19
    ds_read_b64_tr_b16 v[220:221], v194 offset:37888
    v_mfma_f32_16x16x32_bf16 v[140:143], a[20:23], a[20:23], v[140:143]
    s_waitcnt lgkmcnt(7)
    ds_read_b64_tr_b16 v[222:223], v194 offset:39680
    v_mfma_f32_16x16x32_bf16 v[36:39], v[200:203], a[0:3], 0
    s_add_u32 s4, s3, 4096
    ds_read_b64_tr_b16 v[224:225], v192 offset:0
    v_mfma_f32_16x16x32_bf16 v[44:47], v[200:203], a[4:7], 0
    buffer_load_dwordx4 v174, s[44:47], s87 offen offset:2048 lds
    ds_read_b64_tr_b16 v[226:227], v192 offset:1792
    v_mfma_f32_16x16x32_bf16 v[52:55], v[200:203], a[8:11], 0
    s_add_u32 s5, s3, 265216
    s_add_u32 s3, s3, 524288
    v_mfma_f32_16x16x32_bf16 v[60:63], v[200:203], a[12:15], 0
    s_cmp_eq_u32 s3, 3670016
    s_cselect_b32 s3, 0, s3
    v_mfma_f32_16x16x32_bf16 v[124:127], v[204:207], v[144:147], 0
    s_waitcnt lgkmcnt(6)
    ds_read_b64_tr_b16 v[228:229], v196 offset:0
    v_mfma_f32_16x16x32_bf16 v[64:67], v[208:211], a[0:3], 0
    buffer_load_dwordx4 v175, s[44:47], s87 offen offset:3072 lds
    s_add_u32 s87, s87, 128
    v_mfma_f32_16x16x32_bf16 v[72:75], v[208:211], a[4:7], 0
    s_cmp_eq_u32 s87, 896
    ds_read_b64_tr_b16 v[230:231], v196 offset:1792
    ds_read_b64_tr_b16 v[200:201], v192 offset:7168
    v_mfma_f32_16x16x32_bf16 v[80:83], v[208:211], a[8:11], 0
    s_cselect_b32 s87, 0, s87
    ds_read_b64_tr_b16 v[202:203], v192 offset:8960
    s_add_u32 s6, s3, 2048
    v_mfma_f32_16x16x32_bf16 v[88:91], v[208:211], a[12:15], 0
    s_add_u32 s7, s3, 263168
    s_add_u32 s3, s3, 524288
    s_cmp_eq_u32 s3, 3670016
    v_mfma_f32_16x16x32_bf16 v[96:99], v[212:215], a[0:3], 0
    s_cselect_b32 s3, 0, s3
    ds_read_b64_tr_b16 v[204:205], v196 offset:32
    s_add_u32 m0, s92, 104448
    v_mfma_f32_16x16x32_bf16 v[104:107], v[212:215], a[4:7], 0
    s_waitcnt lgkmcnt(7)
    buffer_load_dwordx4 v168, s[40:43], s86 offen offset:0 lds
    ds_read_b64_tr_b16 v[206:207], v196 offset:1824
    v_mfma_f32_16x16x32_bf16 v[68:71], v[216:219], a[0:3], 0
    s_add_u32 s8, s3, 4096
    ds_read_b64_tr_b16 v[208:209], v192 offset:32
    ds_read_b64_tr_b16 v[210:211], v192 offset:1824
    v_mfma_f32_16x16x32_bf16 v[76:79], v[216:219], a[4:7], 0
    s_add_u32 s9, s3, 265216
    s_add_u32 s3, s3, 524288
    v_mfma_f32_16x16x32_bf16 v[84:87], v[216:219], a[8:11], 0
    buffer_load_dwordx4 v169, s[40:43], s86 offen offset:1024 lds
    v_mfma_f32_16x16x32_bf16 v[92:95], v[216:219], a[12:15], 0
    ds_read_b64_tr_b16 v[212:213], v196 offset:64
    v_mfma_f32_16x16x32_bf16 v[100:103], v[220:223], a[0:3], 0
    ds_read_b64_tr_b16 v[214:215], v196 offset:1856
    ds_read_b64_tr_b16 v[216:217], v192 offset:7200
    v_mfma_f32_16x16x32_bf16 v[108:111], v[220:223], a[4:7], 0
    s_waitcnt lgkmcnt(9)
    ds_read_b64_tr_b16 v[218:219], v192 offset:8992
    v_mfma_f32_16x16x32_bf16 v[0:3], v[224:227], a[16:19], v[0:3]
    buffer_load_dwordx4 v170, s[40:43], s86 offen offset:2048 lds
    v_mfma_f32_16x16x32_bf16 v[8:11], v[224:227], a[20:23], v[8:11]
    s_cmp_eq_u32 s3, 3670016
    s_cselect_b32 s3, 0, s3
    v_mfma_f32_16x16x32_bf16 v[16:19], v[224:227], a[24:27], v[16:19]
    s_add_u32 s10, s3, 2048
    ds_read_b64_tr_b16 v[220:221], v198 offset:0
    v_mfma_f32_16x16x32_bf16 v[24:27], v[224:227], a[28:31], v[24:27]
    s_waitcnt vmcnt(11)
    s_barrier
    ds_read_b64_tr_b16 v[222:223], v198 offset:1792
    v_mfma_f32_16x16x32_bf16 v[112:115], v[228:231], v[144:147], v[112:115]
    s_waitcnt lgkmcnt(8)
    ds_read_b64_tr_b16 v[224:225], v192 offset:64
    buffer_load_dwordx4 v171, s[40:43], s86 offen offset:3072 lds
    v_mfma_f32_16x16x32_bf16 v[4:7], v[200:203], a[16:19], v[4:7]
    s_add_u32 s86, s86, 114688
    ds_read_b64_tr_b16 v[226:227], v192 offset:1856
    s_cmp_eq_u32 s86, 1605632
    v_mfma_f32_16x16x32_bf16 v[12:15], v[200:203], a[20:23], v[12:15]
    s_cselect_b32 s86, 0, s86
    ds_read_b128 a[32:35], v164 offset:59392
    ds_read_b128 a[36:39], v164 offset:61440
    v_mfma_f32_16x16x32_bf16 v[20:23], v[200:203], a[24:27], v[20:23]
    ds_read_b128 a[40:43], v166 offset:59392
    ds_read_b128 a[44:47], v166 offset:61440
    v_mfma_f32_16x16x32_bf16 v[28:31], v[200:203], a[28:31], v[28:31]
    s_add_u32 m0, s92, 73728
    ds_read_b128 a[48:51], v165 offset:59392
    s_waitcnt lgkmcnt(9)
    ds_read_b64_tr_b16 v[228:229], v194 offset:0
    v_mfma_f32_16x16x32_bf16 v[116:119], v[204:207], v[144:147], v[116:119]
    ds_read_b128 a[52:55], v165 offset:61440
    buffer_load_dwordx4 v168, s[40:43], s86 offen offset:0 lds
    ds_read_b64_tr_b16 v[230:231], v194 offset:1792
    v_mfma_f32_16x16x32_bf16 v[32:35], v[208:211], a[16:19], v[32:35]
    ds_read_b64_tr_b16 v[200:201], v192 offset:7232
    ds_read_b128 a[56:59], v167 offset:59392
    v_mfma_f32_16x16x32_bf16 v[40:43], v[208:211], a[20:23], v[40:43]
    s_add_u32 s11, s3, 266240
    ds_read_b64_tr_b16 v[202:203], v192 offset:9024
    s_waitcnt lgkmcnt(9)
    ds_read_b128 a[60:63], v167 offset:61440
    v_mfma_f32_16x16x32_bf16 v[48:51], v[208:211], a[24:27], v[48:51]
    s_add_u32 s3, s3, 524288
    buffer_load_dwordx4 v169, s[40:43], s86 offen offset:1024 lds
    v_mfma_f32_16x16x32_bf16 v[56:59], v[208:211], a[28:31], v[56:59]
    ds_read_b64_tr_b16 v[204:205], v194 offset:7168
    v_mfma_f32_16x16x32_bf16 v[120:123], v[212:215], v[144:147], v[120:123]
    ds_read_b64_tr_b16 v[206:207], v194 offset:8960
    v_mfma_f32_16x16x32_bf16 v[36:39], v[216:219], a[16:19], v[36:39]
    ds_read_b64_tr_b16 v[208:209], v193 offset:28672
    v_mfma_f32_16x16x32_bf16 v[44:47], v[216:219], a[20:23], v[44:47]
    buffer_load_dwordx4 v170, s[40:43], s86 offen offset:2048 lds
    ds_read_b64_tr_b16 v[210:211], v193 offset:30464
    v_mfma_f32_16x16x32_bf16 v[52:55], v[216:219], a[24:27], v[52:55]
    s_cmp_eq_u32 s3, 3670016
    s_cselect_b32 s3, 0, s3
    v_mfma_f32_16x16x32_bf16 v[60:63], v[216:219], a[28:31], v[60:63]
    s_add_u32 s80, s3, 3072
    s_add_u32 s81, s3, 264192
    v_mfma_f32_16x16x32_bf16 v[124:127], v[220:223], v[144:147], v[124:127]
    s_waitcnt lgkmcnt(8)
    ds_read_b64_tr_b16 v[212:213], v197 offset:28672
    v_mfma_f32_16x16x32_bf16 v[64:67], v[224:227], a[16:19], v[64:67]
    buffer_load_dwordx4 v171, s[40:43], s86 offen offset:3072 lds
    s_add_u32 s86, s86, 114688
    v_mfma_f32_16x16x32_bf16 v[72:75], v[224:227], a[20:23], v[72:75]
    s_cmp_eq_u32 s86, 1605632
    ds_read_b64_tr_b16 v[214:215], v197 offset:30464
    s_cselect_b32 s86, 0, s86
    v_mfma_f32_16x16x32_bf16 v[80:83], v[224:227], a[24:27], v[80:83]
    s_add_u32 s3, s3, 524288
    s_cmp_eq_u32 s3, 3670016
    s_cselect_b32 s3, 0, s3
    v_mfma_f32_16x16x32_bf16 v[88:91], v[224:227], a[28:31], v[88:91]
    s_add_u32 s82, s3, 1024
    s_add_u32 s83, s3, 266240
    v_mfma_f32_16x16x32_bf16 v[96:99], v[228:231], a[16:19], v[96:99]
    s_add_u32 m0, s93, 43008
    s_nop 0
    buffer_load_dwordx4 v172, s[44:47], s87 offen offset:0 lds
    ds_read_b64_tr_b16 v[216:217], v193 offset:35840
    v_mfma_f32_16x16x32_bf16 v[104:107], v[228:231], a[20:23], v[104:107]
    s_waitcnt lgkmcnt(5)
    ds_read_b64_tr_b16 v[218:219], v193 offset:37632
    v_mfma_f32_16x16x32_bf16 v[68:71], v[200:203], a[16:19], v[68:71]
    s_add_u32 s3, s3, 524288
    v_mfma_f32_16x16x32_bf16 v[76:79], v[200:203], a[20:23], v[76:79]
    s_cmp_eq_u32 s3, 3670016
    s_cselect_b32 s3, 0, s3
    v_mfma_f32_16x16x32_bf16 v[84:87], v[200:203], a[24:27], v[84:87]
    buffer_load_dwordx4 v173, s[44:47], s87 offen offset:1024 lds
    ds_read_b64_tr_b16 v[220:221], v197 offset:28704
    v_mfma_f32_16x16x32_bf16 v[92:95], v[200:203], a[28:31], v[92:95]
    ds_read_b64_tr_b16 v[222:223], v197 offset:30496
    ds_read_b64_tr_b16 v[224:225], v193 offset:28704
    v_mfma_f32_16x16x32_bf16 v[100:103], v[204:207], a[16:19], v[100:103]
    s_add_u32 s84, s3, 3072
    ds_read_b64_tr_b16 v[226:227], v193 offset:30496
    v_mfma_f32_16x16x32_bf16 v[108:111], v[204:207], a[20:23], v[108:111]
    s_waitcnt lgkmcnt(6)
    s_add_u32 s85, s3, 264192
    v_mfma_f32_16x16x32_bf16 v[0:3], v[208:211], a[32:35], v[0:3]
    s_lshl_b32 s3, s25, 17
    buffer_load_dwordx4 v174, s[44:47], s87 offen offset:2048 lds
    v_mfma_f32_16x16x32_bf16 v[8:11], v[208:211], a[36:39], v[8:11]
    s_lshl_b32 s34, s26, 15
    ds_read_b64_tr_b16 v[228:229], v197 offset:28736
    v_mfma_f32_16x16x32_bf16 v[16:19], v[208:211], a[40:43], v[16:19]
    s_add_u32 s3, s3, s34
    ds_read_b64_tr_b16 v[230:231], v197 offset:30528
    v_mfma_f32_16x16x32_bf16 v[24:27], v[208:211], a[44:47], v[24:27]
    s_waitcnt vmcnt(15)
    s_barrier
    v_mfma_f32_16x16x32_bf16 v[112:115], v[212:215], v[144:147], v[112:115]
    buffer_load_dwordx4 v175, s[44:47], s87 offen offset:3072 lds
    s_add_u32 s87, s87, 128
    v_mfma_f32_16x16x32_bf16 v[128:131], v[144:147], a[32:35], v[128:131]
    s_cmp_eq_u32 s87, 896
    s_cselect_b32 s87, 0, s87
    s_lshl_b32 s34, s27, 9
    v_mfma_f32_16x16x32_bf16 v[136:139], a[32:35], a[32:35], v[136:139]
    s_add_u32 s34, s34, s3
    ds_read_b64_tr_b16 v[200:201], v193 offset:35872
    s_mul_i32 s50, s24, 7168
    v_mfma_f32_16x16x32_bf16 v[132:135], v[144:147], a[36:39], v[132:135]
    s_add_u32 s50, s50, 66176
    ds_read_b64_tr_b16 v[202:203], v193 offset:37664
    v_mfma_f32_16x16x32_bf16 v[140:143], a[36:39], a[36:39], v[140:143]
    s_waitcnt lgkmcnt(6)
    s_add_u32 m0, s92, 59392
    s_nop 0
    buffer_load_dwordx4 v168, s[40:43], s86 offen offset:0 lds
    v_mfma_f32_16x16x32_bf16 v[4:7], v[216:219], a[32:35], v[4:7]
    v_bfe_u32 v180, v255, 3, 2
    v_lshlrev_b32 v180, 13, v180
    v_mfma_f32_16x16x32_bf16 v[12:15], v[216:219], a[36:39], v[12:15]
    ds_read_b64_tr_b16 v[204:205], v199 offset:28672
    v_bfe_u32 v232, v255, 5, 1
    v_mfma_f32_16x16x32_bf16 v[20:23], v[216:219], a[40:43], v[20:23]
    ds_read_b64_tr_b16 v[206:207], v199 offset:30464
    ds_read_b64_tr_b16 v[208:209], v193 offset:28736
    v_mfma_f32_16x16x32_bf16 v[28:31], v[216:219], a[44:47], v[28:31]
    buffer_load_dwordx4 v169, s[40:43], s86 offen offset:1024 lds
    ds_read_b64_tr_b16 v[210:211], v193 offset:30528
    v_mfma_f32_16x16x32_bf16 v[116:119], v[220:223], v[144:147], v[116:119]
    s_waitcnt lgkmcnt(6)
    v_lshl_add_u32 v180, v232, 16, v180
    v_mfma_f32_16x16x32_bf16 v[32:35], v[224:227], a[32:35], v[32:35]
    v_bfe_u32 v232, v255, 0, 1
    v_lshl_add_u32 v180, v232, 4, v180
    v_mfma_f32_16x16x32_bf16 v[40:43], v[224:227], a[36:39], v[40:43]
    ds_read_b64_tr_b16 v[212:213], v195 offset:28672
    v_add_u32 v180, s34, v180
    v_mfma_f32_16x16x32_bf16 v[48:51], v[224:227], a[40:43], v[48:51]
    buffer_load_dwordx4 v170, s[40:43], s86 offen offset:2048 lds
    ds_read_b64_tr_b16 v[214:215], v195 offset:30464
    v_mfma_f32_16x16x32_bf16 v[56:59], v[224:227], a[44:47], v[56:59]
    ds_read_b64_tr_b16 v[216:217], v193 offset:35904
    v_lshrrev_b32 v232, 3, v255
    v_mfma_f32_16x16x32_bf16 v[120:123], v[228:231], v[144:147], v[120:123]
    ds_read_b64_tr_b16 v[218:219], v193 offset:37696
    v_xor_b32 v232, v232, v255
    v_mfma_f32_16x16x32_bf16 v[128:131], v[144:147], a[48:51], v[128:131]
    v_bfe_u32 v232, v232, 1, 2
    v_lshl_add_u32 v180, v232, 5, v180
    v_mfma_f32_16x16x32_bf16 v[136:139], a[48:51], a[48:51], v[136:139]
    buffer_load_dwordx4 v171, s[40:43], s86 offen offset:3072 lds
    s_add_u32 s86, s86, 114688
    v_mfma_f32_16x16x32_bf16 v[132:135], v[144:147], a[52:55], v[132:135]
    s_cmp_eq_u32 s86, 1605632
    ds_read_b64_tr_b16 v[220:221], v195 offset:35840
    s_cselect_b32 s86, 0, s86
    v_mfma_f32_16x16x32_bf16 v[140:143], a[52:55], a[52:55], v[140:143]
    s_waitcnt lgkmcnt(7)
    ds_read_b64_tr_b16 v[222:223], v195 offset:37632
    s_and_b32 s30, s30, 0
    v_mfma_f32_16x16x32_bf16 v[36:39], v[200:203], a[32:35], v[36:39]
    s_mul_i32 s30, s30, 524288
    ds_read_b64_tr_b16 v[224:225], v193 offset:14336
    v_mfma_f32_16x16x32_bf16 v[44:47], v[200:203], a[36:39], v[44:47]
    s_add_u32 m0, s92, 28672
    s_nop 0
    buffer_load_dwordx4 v168, s[40:43], s86 offen offset:0 lds
    ds_read_b64_tr_b16 v[226:227], v193 offset:16128
    v_mfma_f32_16x16x32_bf16 v[52:55], v[200:203], a[40:43], v[52:55]
    s_mov_b32 s39, s30
    s_lshl_b32 s31, s26, 19
    v_mfma_f32_16x16x32_bf16 v[60:63], v[200:203], a[44:47], v[60:63]
    s_lshl_b32 s3, s25, 13
    s_add_u32 s31, s31, s3
    v_mfma_f32_16x16x32_bf16 v[124:127], v[204:207], v[144:147], v[124:127]
    s_waitcnt lgkmcnt(6)
    ds_read_b64_tr_b16 v[228:229], v197 offset:14336
    v_mfma_f32_16x16x32_bf16 v[64:67], v[208:211], a[32:35], v[64:67]
    buffer_load_dwordx4 v169, s[40:43], s86 offen offset:1024 lds
    ds_read_b64_tr_b16 v[230:231], v197 offset:16128
    v_mfma_f32_16x16x32_bf16 v[72:75], v[208:211], a[36:39], v[72:75]
    s_mul_i32 s35, s26, 16544
    ds_read_b64_tr_b16 v[200:201], v193 offset:21504
    ds_read_b64_tr_b16 v[202:203], v193 offset:23296
    v_mfma_f32_16x16x32_bf16 v[80:83], v[208:211], a[40:43], v[80:83]
    s_mul_i32 s3, s25, 8320
    s_add_u32 s35, s35, s3
    v_mfma_f32_16x16x32_bf16 v[88:91], v[208:211], a[44:47], v[88:91]
    s_mov_b32 s36, 14
    v_bfe_u32 v250, v255, 2, 1
    v_mfma_f32_16x16x32_bf16 v[96:99], v[212:215], a[32:35], v[96:99]
    buffer_load_dwordx4 v170, s[40:43], s86 offen offset:2048 lds
    ds_read_b64_tr_b16 v[204:205], v197 offset:14368
    v_mfma_f32_16x16x32_bf16 v[104:107], v[212:215], a[36:39], v[104:107]
    s_waitcnt lgkmcnt(7)
    ds_read_b64_tr_b16 v[206:207], v197 offset:16160
    ds_read_b64_tr_b16 v[208:209], v193 offset:14368
    v_mfma_f32_16x16x32_bf16 v[68:71], v[216:219], a[32:35], v[68:71]
    ds_read_b64_tr_b16 v[210:211], v193 offset:16160
    v_lshlrev_b32 v250, 9, v250
    v_mfma_f32_16x16x32_bf16 v[76:79], v[216:219], a[36:39], v[76:79]
    v_bfe_u32 v232, v255, 3, 3
    v_lshl_add_u32 v250, v232, 6, v250
    v_mfma_f32_16x16x32_bf16 v[84:87], v[216:219], a[40:43], v[84:87]
    buffer_load_dwordx4 v171, s[40:43], s86 offen offset:3072 lds
    s_add_u32 s86, s86, 114688
    v_mfma_f32_16x16x32_bf16 v[92:95], v[216:219], a[44:47], v[92:95]
    s_cmp_eq_u32 s86, 1605632
    ds_read_b64_tr_b16 v[212:213], v197 offset:14400
    s_cselect_b32 s86, 0, s86
    v_mfma_f32_16x16x32_bf16 v[100:103], v[220:223], a[32:35], v[100:103]
    ds_read_b64_tr_b16 v[214:215], v197 offset:16192
    v_bfe_u32 v232, v255, 0, 2
    v_mfma_f32_16x16x32_bf16 v[108:111], v[220:223], a[36:39], v[108:111]
    s_waitcnt lgkmcnt(8)
    ds_read_b64_tr_b16 v[216:217], v193 offset:21536
    ds_read_b64_tr_b16 v[218:219], v193 offset:23328
    v_mfma_f32_16x16x32_bf16 v[0:3], v[224:227], a[48:51], v[0:3]
    s_mul_i32 s34, s26, 16544
    v_lshl_add_u32 v250, v232, 4, v250
    v_mfma_f32_16x16x32_bf16 v[8:11], v[224:227], a[52:55], v[8:11]
    s_mov_b32 s3, 4128
    v_bfe_u32 v249, v255, 3, 1
    v_mfma_f32_16x16x32_bf16 v[16:19], v[224:227], a[56:59], v[16:19]
    ds_read_b64_tr_b16 v[220:221], v199 offset:14336
    v_mul_u32_u24 v249, s3, v249
    v_mfma_f32_16x16x32_bf16 v[24:27], v[224:227], a[60:63], v[24:27]
    s_waitcnt vmcnt(16)
    s_barrier
    s_waitcnt lgkmcnt(0)
    v_mfma_f32_16x16x32_bf16 v[112:115], v[228:231], v[144:147], v[112:115]
    s_bfe_u32 s38, s32, 0x80017
    ds_read_b64_tr_b16 v[222:223], v199 offset:16128
    ds_read_b64_tr_b16 v[224:225], v193 offset:14400
    v_mfma_f32_16x16x32_bf16 v[4:7], v[200:203], a[48:51], v[4:7]
    s_bfe_u32 s32, s32, 0x80007
    ds_read_b64_tr_b16 v[226:227], v193 offset:16192
    s_max_u32 s38, s38, s32
    v_mfma_f32_16x16x32_bf16 v[12:15], v[200:203], a[52:55], v[12:15]
    s_bfe_u32 s32, s33, 0x80017
    ds_read_b128 a[64:67], v164 offset:0
    ds_read_b128 a[68:71], v164 offset:2048
    s_max_u32 s38, s38, s32
    s_bfe_u32 s32, s33, 0x80007
    s_max_u32 s38, s38, s32
    s_max_u32 s38, s38, 25
    s_min_u32 s38, s38, 127
    s_sub_u32 s38, 216, s38
    s_lshl_b32 s38, s38, 23
    s_add_u32 m0, s93, 147456
    s_nop 0
    buffer_load_dwordx4 v172, s[44:47], s87 offen offset:0 lds
    v_mfma_f32_16x16x32_bf16 v[20:23], v[200:203], a[56:59], v[20:23]
    ds_read_b128 a[72:75], v166 offset:0
    ds_read_b128 a[76:79], v166 offset:2048
    v_mfma_f32_16x16x32_bf16 v[28:31], v[200:203], a[60:63], v[28:31]
    ds_read_b128 a[80:83], v165 offset:0
    ds_read_b64_tr_b16 v[228:229], v195 offset:14336
    v_mfma_f32_16x16x32_bf16 v[116:119], v[204:207], v[144:147], v[116:119]
    ds_read_b128 a[84:87], v165 offset:2048
    buffer_load_dwordx4 v173, s[44:47], s87 offen offset:1024 lds
    ds_read_b64_tr_b16 v[230:231], v195 offset:16128
    v_mfma_f32_16x16x32_bf16 v[32:35], v[208:211], a[48:51], v[32:35]
    ds_read_b64_tr_b16 v[200:201], v193 offset:21568
    ds_read_b128 a[88:91], v167 offset:0
    v_mfma_f32_16x16x32_bf16 v[40:43], v[208:211], a[52:55], v[40:43]
    ds_read_b64_tr_b16 v[202:203], v193 offset:23360
    v_bfe_u32 v232, v255, 4, 1
    v_mfma_f32_16x16x32_bf16 v[48:51], v[208:211], a[56:59], v[48:51]
    s_mov_b32 s3, 8320
    ds_read_b128 a[92:95], v167 offset:2048
    buffer_load_dwordx4 v174, s[44:47], s87 offen offset:2048 lds
    v_mfma_f32_16x16x32_bf16 v[56:59], v[208:211], a[60:63], v[56:59]
    s_waitcnt lgkmcnt(9)
    ds_read_b64_tr_b16 v[204:205], v195 offset:21504
    v_mad_u32_u24 v249, v232, s3, v249
    v_mfma_f32_16x16x32_bf16 v[120:123], v[212:215], v[144:147], v[120:123]
    ds_read_b64_tr_b16 v[206:207], v195 offset:23296
    v_mfma_f32_16x16x32_bf16 v[36:39], v[216:219], a[48:51], v[36:39]
    ds_read_b64_tr_b16 v[208:209], v193 offset:0
    v_bfe_u32 v232, v255, 5, 1
    v_mfma_f32_16x16x32_bf16 v[44:47], v[216:219], a[52:55], v[44:47]
    buffer_load_dwordx4 v175, s[44:47], s87 offen offset:3072 lds
    s_add_u32 s87, s87, 128
    v_mfma_f32_16x16x32_bf16 v[52:55], v[216:219], a[56:59], v[52:55]
    s_cmp_eq_u32 s87, 896
    ds_read_b64_tr_b16 v[210:211], v193 offset:1792
    s_cselect_b32 s87, 0, s87
    v_mfma_f32_16x16x32_bf16 v[60:63], v[216:219], a[60:63], v[60:63]
    v_lshl_add_u32 v249, v232, 10, v249
    v_bfe_u32 v232, v255, 2, 1
    v_mfma_f32_16x16x32_bf16 v[124:127], v[220:223], v[144:147], v[124:127]
    s_waitcnt lgkmcnt(8)
    ds_read_b64_tr_b16 v[212:213], v197 offset:0
    v_lshl_add_u32 v249, v232, 6, v249
    v_mfma_f32_16x16x32_bf16 v[64:67], v[224:227], a[48:51], v[64:67]
    s_add_u32 m0, s92, 133120
    s_nop 0
    buffer_load_dwordx4 v168, s[40:43], s86 offen offset:0 lds
    v_bfe_u32 v232, v255, 0, 2
    v_mfma_f32_16x16x32_bf16 v[72:75], v[224:227], a[52:55], v[72:75]
    ds_read_b64_tr_b16 v[214:215], v197 offset:1792
    v_lshl_add_u32 v249, v232, 3, v249
    v_mfma_f32_16x16x32_bf16 v[80:83], v[224:227], a[56:59], v[80:83]
    v_add_u32 v249, s34, v249
    s_add_u32 s34, s34, 97664
    v_mfma_f32_16x16x32_bf16 v[88:91], v[224:227], a[60:63], v[88:91]
    s_mov_b32 s3, 4128
    v_bfe_u32 v248, v255, 1, 1
    v_mul_u32_u24 v248, s3, v248
    v_mfma_f32_16x16x32_bf16 v[96:99], v[228:231], a[48:51], v[96:99]
    buffer_load_dwordx4 v169, s[40:43], s86 offen offset:1024 lds
    ds_read_b64_tr_b16 v[216:217], v193 offset:7168
    v_mfma_f32_16x16x32_bf16 v[104:107], v[228:231], a[52:55], v[104:107]
    s_waitcnt lgkmcnt(5)
    ds_read_b64_tr_b16 v[218:219], v193 offset:8960
    v_mfma_f32_16x16x32_bf16 v[68:71], v[200:203], a[48:51], v[68:71]
    s_mov_b32 s3, 8320
    v_bfe_u32 v232, v255, 2, 1
    v_mfma_f32_16x16x32_bf16 v[76:79], v[200:203], a[52:55], v[76:79]
    v_mad_u32_u24 v248, v232, s3, v248
    v_bfe_u32 v232, v255, 3, 1
    v_mfma_f32_16x16x32_bf16 v[84:87], v[200:203], a[56:59], v[84:87]
    buffer_load_dwordx4 v170, s[40:43], s86 offen offset:2048 lds
    ds_read_b64_tr_b16 v[220:221], v197 offset:32
    v_mfma_f32_16x16x32_bf16 v[92:95], v[200:203], a[60:63], v[92:95]
    ds_read_b64_tr_b16 v[222:223], v197 offset:1824
    ds_read_b64_tr_b16 v[224:225], v193 offset:32
    v_mfma_f32_16x16x32_bf16 v[100:103], v[204:207], a[48:51], v[100:103]
    ds_read_b64_tr_b16 v[226:227], v193 offset:1824
    v_lshl_add_u32 v248, v232, 10, v248
    v_mfma_f32_16x16x32_bf16 v[108:111], v[204:207], a[52:55], v[108:111]
    s_waitcnt lgkmcnt(6)
    v_bfe_u32 v232, v255, 0, 1
    v_mfma_f32_16x16x32_bf16 v[0:3], v[208:211], a[64:67], v[0:3]
    buffer_load_dwordx4 v171, s[40:43], s86 offen offset:3072 lds
    s_add_u32 s86, s86, 114688
    v_mfma_f32_16x16x32_bf16 v[8:11], v[208:211], a[68:71], v[8:11]
    s_cmp_eq_u32 s86, 1605632
    ds_read_b64_tr_b16 v[228:229], v197 offset:64
    s_cselect_b32 s86, 0, s86
    v_mfma_f32_16x16x32_bf16 v[16:19], v[208:211], a[72:75], v[16:19]
    ds_read_b64_tr_b16 v[230:231], v197 offset:1856
    v_lshl_add_u32 v248, v232, 6, v248
    v_mfma_f32_16x16x32_bf16 v[24:27], v[208:211], a[76:79], v[24:27]
    s_waitcnt vmcnt(20)
    v_bfe_u32 v232, v255, 4, 2
    s_barrier
    v_mfma_f32_16x16x32_bf16 v[112:115], v[212:215], v[144:147], v[112:115]
    s_add_u32 m0, s92, 118784
    s_nop 0
    buffer_load_dwordx4 v168, s[40:43], s86 offen offset:0 lds
    v_mfma_f32_16x16x32_bf16 v[128:131], v[144:147], a[64:67], v[128:131]
    v_lshl_add_u32 v248, v232, 4, v248
    v_add_u32 v248, s34, v248
    v_mfma_f32_16x16x32_bf16 v[136:139], a[64:67], a[64:67], v[136:139]
    ds_read_b64_tr_b16 v[200:201], v193 offset:7200
    v_bfe_u32 v181, v255, 2, 3
    v_mfma_f32_16x16x32_bf16 v[132:135], v[144:147], a[68:71], v[132:135]
    ds_read_b64_tr_b16 v[202:203], v193 offset:8992
    v_lshlrev_b32 v181, 7, v181
    v_mfma_f32_16x16x32_bf16 v[140:143], a[68:71], a[68:71], v[140:143]
    s_waitcnt lgkmcnt(6)
    buffer_load_dwordx4 v169, s[40:43], s86 offen offset:1024 lds
    v_mfma_f32_16x16x32_bf16 v[4:7], v[216:219], a[64:67], v[4:7]
    s_mov_b32 s3, 14336
    v_bfe_u32 v232, v255, 5, 1
    v_mfma_f32_16x16x32_bf16 v[12:15], v[216:219], a[68:71], v[12:15]
    ds_read_b64_tr_b16 v[204:205], v199 offset:0
    v_mad_u32_u24 v181, v232, s3, v181
    v_mfma_f32_16x16x32_bf16 v[20:23], v[216:219], a[72:75], v[20:23]
    ds_read_b64_tr_b16 v[206:207], v199 offset:1792
    ds_read_b64_tr_b16 v[208:209], v193 offset:64
    v_mfma_f32_16x16x32_bf16 v[28:31], v[216:219], a[76:79], v[28:31]
    buffer_load_dwordx4 v170, s[40:43], s86 offen offset:2048 lds
    ds_read_b64_tr_b16 v[210:211], v193 offset:1856
    v_mfma_f32_16x16x32_bf16 v[116:119], v[220:223], v[144:147], v[116:119]
    s_waitcnt lgkmcnt(6)
    v_bfe_u32 v232, v255, 0, 2
    v_mfma_f32_16x16x32_bf16 v[32:35], v[224:227], a[64:67], v[32:35]
    v_lshl_add_u32 v181, v232, 3, v181
    v_bfe_u32 v232, v255, 3, 2
    v_mfma_f32_16x16x32_bf16 v[40:43], v[224:227], a[68:71], v[40:43]
    ds_read_b64_tr_b16 v[212:213], v195 offset:0
    v_lshl_add_u32 v181, v232, 5, v181
    v_mfma_f32_16x16x32_bf16 v[48:51], v[224:227], a[72:75], v[48:51]
    buffer_load_dwordx4 v171, s[40:43], s86 offen offset:3072 lds
    s_add_u32 s86, s86, 114688
    v_mfma_f32_16x16x32_bf16 v[56:59], v[224:227], a[76:79], v[56:59]
    s_cmp_eq_u32 s86, 1605632
    ds_read_b64_tr_b16 v[214:215], v195 offset:1792
    s_cselect_b32 s86, 0, s86
    v_mfma_f32_16x16x32_bf16 v[120:123], v[228:231], v[144:147], v[120:123]
    s_lshl_b32 s3, s26, 6
    ds_read_b64_tr_b16 v[216:217], v193 offset:7232
    s_lshl_b32 s34, s25, 5
    v_mfma_f32_16x16x32_bf16 v[128:131], v[144:147], a[80:83], v[128:131]
    s_add_u32 s3, s3, s34
    ds_read_b64_tr_b16 v[218:219], v193 offset:9024
    v_xor_b32 v181, s3, v181
    v_mfma_f32_16x16x32_bf16 v[136:139], a[80:83], a[80:83], v[136:139]
    v_xor_b32 v182, 32, v181
    v_bfe_u32 v233, v255, 5, 1
    v_mfma_f32_16x16x32_bf16 v[132:135], v[144:147], a[84:87], v[132:135]
    ds_read_b64_tr_b16 v[220:221], v195 offset:7168
    v_lshlrev_b32 v233, 8, v233
    v_mfma_f32_16x16x32_bf16 v[140:143], a[84:87], a[84:87], v[140:143]
    s_waitcnt lgkmcnt(7)
    ds_read_b64_tr_b16 v[222:223], v195 offset:8960
    v_mfma_f32_16x16x32_bf16 v[36:39], v[200:203], a[64:67], v[36:39]
    ds_read_b64_tr_b16 v[224:225], v192 offset:45056
    v_bfe_u32 v232, v255, 0, 4
    v_mfma_f32_16x16x32_bf16 v[44:47], v[200:203], a[68:71], v[44:47]
    ds_read_b64_tr_b16 v[226:227], v192 offset:46848
    v_lshl_add_u32 v233, v232, 4, v233
    v_mfma_f32_16x16x32_bf16 v[52:55], v[200:203], a[72:75], v[52:55]
    v_bfe_u32 v232, v255, 4, 1
    v_lshl_add_u32 v233, v232, 3, v233
    v_mfma_f32_16x16x32_bf16 v[60:63], v[200:203], a[76:79], v[60:63]
    s_mul_i32 s3, s26, 10240
    s_mul_i32 s34, s25, 4608
    v_mfma_f32_16x16x32_bf16 v[124:127], v[204:207], v[144:147], v[124:127]
    s_waitcnt lgkmcnt(6)
    ds_read_b64_tr_b16 v[228:229], v196 offset:45056
    v_mfma_f32_16x16x32_bf16 v[64:67], v[208:211], a[64:67], v[64:67]
    ds_read_b64_tr_b16 v[230:231], v196 offset:46848
    ds_read_b64_tr_b16 v[200:201], v192 offset:52224
    v_mfma_f32_16x16x32_bf16 v[72:75], v[208:211], a[68:71], v[72:75]
    s_add_u32 s3, s3, s34
    ds_read_b64_tr_b16 v[202:203], v192 offset:54016
    v_mfma_f32_16x16x32_bf16 v[80:83], v[208:211], a[72:75], v[80:83]
    v_add_u32 v183, s3, v233
    v_xor_b32 v184, 0x800, v183
    v_mfma_f32_16x16x32_bf16 v[88:91], v[208:211], a[76:79], v[88:91]
    v_xor_b32 v185, 0x200, v183
    v_xor_b32 v186, 0x200, v184
    v_mfma_f32_16x16x32_bf16 v[96:99], v[212:215], a[64:67], v[96:99]
    ds_read_b64_tr_b16 v[204:205], v196 offset:45088
    v_lshlrev_b32 v189, 4, v255
    v_mfma_f32_16x16x32_bf16 v[104:107], v[212:215], a[68:71], v[104:107]
    s_waitcnt lgkmcnt(7)
    ds_read_b64_tr_b16 v[206:207], v196 offset:46880
    ds_read_b64_tr_b16 v[208:209], v192 offset:45088
    v_mfma_f32_16x16x32_bf16 v[68:71], v[216:219], a[64:67], v[68:71]
    s_lshl_b32 s3, s24, 11
    ds_read_b64_tr_b16 v[210:211], v192 offset:46880
    v_mfma_f32_16x16x32_bf16 v[76:79], v[216:219], a[68:71], v[76:79]
    v_add_u32 v187, s3, v189
    v_lshlrev_b32 v189, 4, v255
    v_mfma_f32_16x16x32_bf16 v[84:87], v[216:219], a[72:75], v[84:87]
    v_xor_b32 v188, 0x800, v187
    v_and_b32 v232, 48, v255
    v_mfma_f32_16x16x32_bf16 v[92:95], v[216:219], a[76:79], v[92:95]
    s_mul_i32 s3, s26, 768
    ds_read_b64_tr_b16 v[212:213], v196 offset:45120
    v_mfma_f32_16x16x32_bf16 v[100:103], v[220:223], a[64:67], v[100:103]
    ds_read_b64_tr_b16 v[214:215], v196 offset:46912
    ds_read_b64_tr_b16 v[216:217], v192 offset:52256
    v_mfma_f32_16x16x32_bf16 v[108:111], v[220:223], a[68:71], v[108:111]
    s_waitcnt lgkmcnt(9)
    ds_read_b64_tr_b16 v[218:219], v192 offset:54048
    v_mfma_f32_16x16x32_bf16 v[0:3], v[224:227], a[80:83], v[0:3]
    s_add_u32 s3, s3, 94848
    s_mul_i32 s34, s25, 384
    v_mfma_f32_16x16x32_bf16 v[8:11], v[224:227], a[84:87], v[8:11]
    v_add_u32 v191, s3, v232
    v_add_u32 v190, s34, v191
    v_mfma_f32_16x16x32_bf16 v[16:19], v[224:227], a[88:91], v[16:19]
    s_sub_u32 s34, 384, s34
    ds_read_b64_tr_b16 v[220:221], v198 offset:45056
    v_mfma_f32_16x16x32_bf16 v[24:27], v[224:227], a[92:95], v[24:27]
    s_waitcnt vmcnt(16)
    s_barrier
    ds_read_b64_tr_b16 v[222:223], v198 offset:46848
    v_mfma_f32_16x16x32_bf16 v[112:115], v[228:231], v[144:147], v[112:115]
    s_waitcnt lgkmcnt(8)
    ds_read_b64_tr_b16 v[224:225], v192 offset:45120
    s_add_u32 m0, s93, 88064
    v_mfma_f32_16x16x32_bf16 v[4:7], v[200:203], a[80:83], v[4:7]
    buffer_load_dwordx4 v172, s[44:47], s87 offen offset:0 lds
    ds_read_b64_tr_b16 v[226:227], v192 offset:46912
    v_mfma_f32_16x16x32_bf16 v[12:15], v[200:203], a[84:87], v[12:15]
    ds_read_b128 a[96:99], v160 offset:43008
    ds_read_b128 a[100:103], v160 offset:45056
    v_mfma_f32_16x16x32_bf16 v[20:23], v[200:203], a[88:91], v[20:23]
    ds_read_b128 a[104:107], v162 offset:43008
    ds_read_b128 a[108:111], v162 offset:45056
    v_mfma_f32_16x16x32_bf16 v[28:31], v[200:203], a[92:95], v[28:31]
    ds_read_b128 a[112:115], v161 offset:43008
    s_waitcnt lgkmcnt(9)
    ds_read_b64_tr_b16 v[228:229], v194 offset:45056
    v_mfma_f32_16x16x32_bf16 v[116:119], v[204:207], v[144:147], v[116:119]
    ds_read_b128 a[116:119], v161 offset:45056
    buffer_load_dwordx4 v173, s[44:47], s87 offen offset:1024 lds
    ds_read_b64_tr_b16 v[230:231], v194 offset:46848
    v_mfma_f32_16x16x32_bf16 v[32:35], v[208:211], a[80:83], v[32:35]
    ds_read_b64_tr_b16 v[200:201], v192 offset:52288
    ds_read_b128 a[120:123], v163 offset:43008
    v_mfma_f32_16x16x32_bf16 v[40:43], v[208:211], a[84:87], v[40:43]
    ds_read_b64_tr_b16 v[202:203], v192 offset:54080
    v_add_u32 v246, s34, v191
    v_mfma_f32_16x16x32_bf16 v[48:51], v[208:211], a[88:91], v[48:51]
    s_waitcnt lgkmcnt(9)
    ds_read_b128 a[124:127], v163 offset:45056
    v_bfe_u32 v232, v255, 0, 1
    v_mfma_f32_16x16x32_bf16 v[56:59], v[208:211], a[92:95], v[56:59]
    buffer_load_dwordx4 v174, s[44:47], s87 offen offset:2048 lds
    v_cmp_eq_u32 s[98:99], 1, v232
    v_mfma_f32_16x16x32_bf16 v[120:123], v[212:215], v[144:147], v[120:123]
    ds_read_b64_tr_b16 v[204:205], v194 offset:52224
    ds_read_b64_tr_b16 v[206:207], v194 offset:54016
    v_mfma_f32_16x16x32_bf16 v[36:39], v[216:219], a[80:83], v[36:39]
    ds_read_b64_tr_b16 v[208:209], v192 offset:30720
    v_bfe_u32 v232, v255, 1, 1
    v_mfma_f32_16x16x32_bf16 v[44:47], v[216:219], a[84:87], v[44:47]
    buffer_load_dwordx4 v175, s[44:47], s87 offen offset:3072 lds
    s_add_u32 s87, s87, 128
    v_mfma_f32_16x16x32_bf16 v[52:55], v[216:219], a[88:91], v[52:55]
    s_cmp_eq_u32 s87, 896
    ds_read_b64_tr_b16 v[210:211], v192 offset:32512
    s_cselect_b32 s87, 0, s87
    v_mfma_f32_16x16x32_bf16 v[60:63], v[216:219], a[92:95], v[60:63]
    v_cmp_eq_u32 s[100:101], 1, v232
    v_bfe_u32 v232, v255, 2, 2
    v_mfma_f32_16x16x32_bf16 v[124:127], v[220:223], v[144:147], v[124:127]
    s_waitcnt lgkmcnt(8)
    ds_read_b64_tr_b16 v[212:213], v196 offset:30720
    v_lshrrev_b32 v233, 4, v255
    v_mfma_f32_16x16x32_bf16 v[64:67], v[224:227], a[80:83], v[64:67]
    s_add_u32 m0, s92, 104448
    s_nop 0
    buffer_load_dwordx4 v168, s[40:43], s86 offen offset:0 lds
    v_cmp_eq_u32 vcc, v232, v233
    v_mfma_f32_16x16x32_bf16 v[72:75], v[224:227], a[84:87], v[72:75]
    s_lshl_b32 s3, s28, 1
    ds_read_b64_tr_b16 v[214:215], v196 offset:32512
    s_add_u32 s3, s3, s25
    v_mfma_f32_16x16x32_bf16 v[80:83], v[224:227], a[88:91], v[80:83]
    s_mul_i32 s3, s3, 229376
    s_lshl_b32 s34, s26, 11
    v_mfma_f32_16x16x32_bf16 v[88:91], v[224:227], a[92:95], v[88:91]
    s_add_u32 s54, s3, s34
    s_xor_b32 s34, s34, 0x800
    v_mfma_f32_16x16x32_bf16 v[96:99], v[228:231], a[80:83], v[96:99]
    buffer_load_dwordx4 v169, s[40:43], s86 offen offset:1024 lds
    ds_read_b64_tr_b16 v[216:217], v192 offset:37888
    v_mfma_f32_16x16x32_bf16 v[104:107], v[228:231], a[84:87], v[104:107]
    s_waitcnt lgkmcnt(5)
    ds_read_b64_tr_b16 v[218:219], v192 offset:39680
    v_mfma_f32_16x16x32_bf16 v[68:71], v[200:203], a[80:83], v[68:71]
    s_add_u32 s55, s3, s34
    s_mul_i32 s53, s27, 7
    v_mfma_f32_16x16x32_bf16 v[76:79], v[200:203], a[84:87], v[76:79]
    s_mul_i32 s3, s27, 229376
    s_lshl_b32 s49, s24, 7
    v_mfma_f32_16x16x32_bf16 v[84:87], v[200:203], a[88:91], v[84:87]
    buffer_load_dwordx4 v170, s[40:43], s86 offen offset:2048 lds
    ds_read_b64_tr_b16 v[220:221], v196 offset:30752
    v_mfma_f32_16x16x32_bf16 v[92:95], v[200:203], a[92:95], v[92:95]
    ds_read_b64_tr_b16 v[222:223], v196 offset:32544
    ds_read_b64_tr_b16 v[224:225], v192 offset:30752
    v_mfma_f32_16x16x32_bf16 v[100:103], v[204:207], a[80:83], v[100:103]
    s_add_u32 s49, s49, s3
    ds_read_b64_tr_b16 v[226:227], v192 offset:32544
    v_mfma_f32_16x16x32_bf16 v[108:111], v[204:207], a[84:87], v[108:111]
    s_waitcnt lgkmcnt(6)
    s_mul_i32 s48, s24, 96
    v_mfma_f32_16x16x32_bf16 v[0:3], v[208:211], a[96:99], v[0:3]
    buffer_load_dwordx4 v171, s[40:43], s86 offen offset:3072 lds
    s_add_u32 s86, s86, 114688
    v_mfma_f32_16x16x32_bf16 v[8:11], v[208:211], a[100:103], v[8:11]
    s_cmp_eq_u32 s86, 1605632
    ds_read_b64_tr_b16 v[228:229], v196 offset:30784
    s_cselect_b32 s86, 0, s86
    v_mfma_f32_16x16x32_bf16 v[16:19], v[208:211], a[104:107], v[16:19]
    s_add_u32 s48, s48, s3
    ds_read_b64_tr_b16 v[230:231], v196 offset:32576
    s_add_u32 s48, s48, 512
    v_mfma_f32_16x16x32_bf16 v[24:27], v[208:211], a[108:111], v[24:27]
    s_waitcnt vmcnt(20)
    s_barrier
    v_mfma_f32_16x16x32_bf16 v[112:115], v[212:215], v[144:147], v[112:115]
    s_add_u32 m0, s92, 73728
    s_nop 0
    buffer_load_dwordx4 v168, s[40:43], s86 offen offset:0 lds
    v_mfma_f32_16x16x32_bf16 v[128:131], v[144:147], a[96:99], v[128:131]
    s_lshl_b32 s51, s24, 13
    s_lshl_b32 s52, s24, 14
    v_mfma_f32_16x16x32_bf16 v[136:139], a[96:99], a[96:99], v[136:139]
    s_add_u32 s52, s52, 97664
    ds_read_b64_tr_b16 v[200:201], v192 offset:37920
    v_mfma_f32_16x16x32_bf16 v[132:135], v[144:147], a[100:103], v[132:135]
    s_movk_i32 s29, 10923
    ds_read_b64_tr_b16 v[202:203], v192 offset:39712
    v_mfma_f32_16x16x32_bf16 v[140:143], a[100:103], a[100:103], v[140:143]
    s_waitcnt lgkmcnt(6)
    buffer_load_dwordx4 v169, s[40:43], s86 offen offset:1024 lds
    v_mfma_f32_16x16x32_bf16 v[4:7], v[216:219], a[96:99], v[4:7]
    s_xor_b32 s3, s24, 0
    s_lshl_b32 s34, s28, 2
    v_mfma_f32_16x16x32_bf16 v[12:15], v[216:219], a[100:103], v[12:15]
    s_add_u32 s3, s3, s34
    ds_read_b64_tr_b16 v[204:205], v198 offset:30720
    v_mfma_f32_16x16x32_bf16 v[20:23], v[216:219], a[104:107], v[20:23]
    ds_read_b64_tr_b16 v[206:207], v198 offset:32512
    ds_read_b64_tr_b16 v[208:209], v192 offset:30784
    v_mfma_f32_16x16x32_bf16 v[28:31], v[216:219], a[108:111], v[28:31]
    buffer_load_dwordx4 v170, s[40:43], s86 offen offset:2048 lds
    ds_read_b64_tr_b16 v[210:211], v192 offset:32576
    v_mfma_f32_16x16x32_bf16 v[116:119], v[220:223], v[144:147], v[116:119]
    s_waitcnt lgkmcnt(6)
    s_lshl_b32 s3, s3, 4
    v_mfma_f32_16x16x32_bf16 v[32:35], v[224:227], a[96:99], v[32:35]
    s_add_u32 s3, s3, s27
    s_mul_i32 s3, s3, 28672
    v_mfma_f32_16x16x32_bf16 v[40:43], v[224:227], a[100:103], v[40:43]
    s_add_u32 s3, s3, 8388608
    ds_read_b64_tr_b16 v[212:213], v194 offset:30720
    v_mfma_f32_16x16x32_bf16 v[48:51], v[224:227], a[104:107], v[48:51]
    buffer_load_dwordx4 v171, s[40:43], s86 offen offset:3072 lds
    s_add_u32 s86, s86, 114688
    v_mfma_f32_16x16x32_bf16 v[56:59], v[224:227], a[108:111], v[56:59]
    s_cmp_eq_u32 s86, 1605632
    ds_read_b64_tr_b16 v[214:215], v194 offset:32512
    s_cselect_b32 s86, 0, s86
    v_mfma_f32_16x16x32_bf16 v[120:123], v[228:231], v[144:147], v[120:123]
    s_lshl_b32 s34, s24, 12
    ds_read_b64_tr_b16 v[216:217], v192 offset:37952
    s_add_u32 s60, s3, s34
    v_mfma_f32_16x16x32_bf16 v[128:131], v[144:147], a[112:115], v[128:131]
    s_mul_i32 s34, s24, 3072
    ds_read_b64_tr_b16 v[218:219], v192 offset:39744
    s_add_u32 s3, s3, s34
    v_mfma_f32_16x16x32_bf16 v[136:139], a[112:115], a[112:115], v[136:139]
    s_add_u32 s56, s3, 16384
    s_xor_b32 s3, s24, 1
    v_mfma_f32_16x16x32_bf16 v[132:135], v[144:147], a[116:119], v[132:135]
    s_lshl_b32 s34, s28, 2
    ds_read_b64_tr_b16 v[220:221], v194 offset:37888
    v_mfma_f32_16x16x32_bf16 v[140:143], a[116:119], a[116:119], v[140:143]
    s_waitcnt lgkmcnt(7)
    ds_read_b64_tr_b16 v[222:223], v194 offset:39680
    v_mfma_f32_16x16x32_bf16 v[36:39], v[200:203], a[96:99], v[36:39]
    s_add_u32 s3, s3, s34
    ds_read_b64_tr_b16 v[224:225], v192 offset:0
    v_mfma_f32_16x16x32_bf16 v[44:47], v[200:203], a[100:103], v[44:47]
    s_lshl_b32 s3, s3, 4
    ds_read_b64_tr_b16 v[226:227], v192 offset:1792
    v_mfma_f32_16x16x32_bf16 v[52:55], v[200:203], a[104:107], v[52:55]
    s_add_u32 s3, s3, s27
    s_mul_i32 s3, s3, 28672
    v_mfma_f32_16x16x32_bf16 v[60:63], v[200:203], a[108:111], v[60:63]
    s_add_u32 s3, s3, 8388608
    s_lshl_b32 s34, s24, 12
    v_mfma_f32_16x16x32_bf16 v[124:127], v[204:207], v[144:147], v[124:127]
    s_waitcnt lgkmcnt(6)
    ds_read_b64_tr_b16 v[228:229], v196 offset:0
    v_mfma_f32_16x16x32_bf16 v[64:67], v[208:211], a[96:99], v[64:67]
    ds_read_b64_tr_b16 v[230:231], v196 offset:1792
    ds_read_b64_tr_b16 v[200:201], v192 offset:7168
    v_mfma_f32_16x16x32_bf16 v[72:75], v[208:211], a[100:103], v[72:75]
    s_add_u32 s61, s3, s34
    ds_read_b64_tr_b16 v[202:203], v192 offset:8960
    v_mfma_f32_16x16x32_bf16 v[80:83], v[208:211], a[104:107], v[80:83]
    s_mul_i32 s34, s24, 3072
    s_add_u32 s3, s3, s34
    v_mfma_f32_16x16x32_bf16 v[88:91], v[208:211], a[108:111], v[88:91]
    s_add_u32 s57, s3, 16384
    s_xor_b32 s3, s24, 2
    v_mfma_f32_16x16x32_bf16 v[96:99], v[212:215], a[96:99], v[96:99]
    s_lshl_b32 s34, s28, 2
    ds_read_b64_tr_b16 v[204:205], v196 offset:32
    v_mfma_f32_16x16x32_bf16 v[104:107], v[212:215], a[100:103], v[104:107]
    s_waitcnt lgkmcnt(7)
    ds_read_b64_tr_b16 v[206:207], v196 offset:1824
    ds_read_b64_tr_b16 v[208:209], v192 offset:32
    v_mfma_f32_16x16x32_bf16 v[68:71], v[216:219], a[96:99], v[68:71]
    s_add_u32 s3, s3, s34
    ds_read_b64_tr_b16 v[210:211], v192 offset:1824
    v_mfma_f32_16x16x32_bf16 v[76:79], v[216:219], a[100:103], v[76:79]
    s_lshl_b32 s3, s3, 4
    s_add_u32 s3, s3, s27
    v_mfma_f32_16x16x32_bf16 v[84:87], v[216:219], a[104:107], v[84:87]
    s_mul_i32 s3, s3, 28672
    s_add_u32 s3, s3, 8388608
    v_mfma_f32_16x16x32_bf16 v[92:95], v[216:219], a[108:111], v[92:95]
    s_lshl_b32 s34, s24, 12
    ds_read_b64_tr_b16 v[212:213], v196 offset:64
    v_mfma_f32_16x16x32_bf16 v[100:103], v[220:223], a[96:99], v[100:103]
    ds_read_b64_tr_b16 v[214:215], v196 offset:1856
    ds_read_b64_tr_b16 v[216:217], v192 offset:7200
    v_mfma_f32_16x16x32_bf16 v[108:111], v[220:223], a[100:103], v[108:111]
    s_waitcnt lgkmcnt(9)
    ds_read_b64_tr_b16 v[218:219], v192 offset:8992
    v_mfma_f32_16x16x32_bf16 v[0:3], v[224:227], a[112:115], v[0:3]
    s_add_u32 s62, s3, s34
    s_mul_i32 s34, s24, 3072
    v_mfma_f32_16x16x32_bf16 v[8:11], v[224:227], a[116:119], v[8:11]
    s_add_u32 s3, s3, s34
    s_add_u32 s58, s3, 16384
    v_mfma_f32_16x16x32_bf16 v[16:19], v[224:227], a[120:123], v[16:19]
    s_xor_b32 s3, s24, 3
    ds_read_b64_tr_b16 v[220:221], v198 offset:0
    v_mfma_f32_16x16x32_bf16 v[24:27], v[224:227], a[124:127], v[24:27]
    s_waitcnt vmcnt(16)
    s_barrier
    ds_read_b64_tr_b16 v[222:223], v198 offset:1792
    v_mfma_f32_16x16x32_bf16 v[112:115], v[228:231], v[144:147], v[112:115]
    s_waitcnt lgkmcnt(8)
    ds_read_b64_tr_b16 v[224:225], v192 offset:64
    s_add_u32 m0, s93, 43008
    v_mfma_f32_16x16x32_bf16 v[4:7], v[200:203], a[112:115], v[4:7]
    buffer_load_dwordx4 v172, s[44:47], s87 offen offset:0 lds
    ds_read_b64_tr_b16 v[226:227], v192 offset:1856
    v_mfma_f32_16x16x32_bf16 v[12:15], v[200:203], a[116:119], v[12:15]
    ds_read_b128 a[128:131], v164 offset:59392
    ds_read_b128 a[132:135], v164 offset:61440
    v_mfma_f32_16x16x32_bf16 v[20:23], v[200:203], a[120:123], v[20:23]
    ds_read_b128 a[136:139], v166 offset:59392
    ds_read_b128 a[140:143], v166 offset:61440
    v_mfma_f32_16x16x32_bf16 v[28:31], v[200:203], a[124:127], v[28:31]
    ds_read_b128 a[144:147], v165 offset:59392
    s_waitcnt lgkmcnt(9)
    ds_read_b64_tr_b16 v[228:229], v194 offset:0
    v_mfma_f32_16x16x32_bf16 v[116:119], v[204:207], v[144:147], v[116:119]
    ds_read_b128 a[148:151], v165 offset:61440
    buffer_load_dwordx4 v173, s[44:47], s87 offen offset:1024 lds
    ds_read_b64_tr_b16 v[230:231], v194 offset:1792
    v_mfma_f32_16x16x32_bf16 v[32:35], v[208:211], a[112:115], v[32:35]
    ds_read_b64_tr_b16 v[200:201], v192 offset:7232
    ds_read_b128 a[152:155], v167 offset:59392
    v_mfma_f32_16x16x32_bf16 v[40:43], v[208:211], a[116:119], v[40:43]
    s_lshl_b32 s34, s28, 2
    ds_read_b64_tr_b16 v[202:203], v192 offset:9024
    s_waitcnt lgkmcnt(9)
    ds_read_b128 a[156:159], v167 offset:61440
    v_mfma_f32_16x16x32_bf16 v[48:51], v[208:211], a[120:123], v[48:51]
    s_add_u32 s3, s3, s34
    buffer_load_dwordx4 v174, s[44:47], s87 offen offset:2048 lds
    v_mfma_f32_16x16x32_bf16 v[56:59], v[208:211], a[124:127], v[56:59]
    s_lshl_b32 s3, s3, 4
    ds_read_b64_tr_b16 v[204:205], v194 offset:7168
    v_mfma_f32_16x16x32_bf16 v[120:123], v[212:215], v[144:147], v[120:123]
    ds_read_b64_tr_b16 v[206:207], v194 offset:8960
    v_mfma_f32_16x16x32_bf16 v[36:39], v[216:219], a[112:115], v[36:39]
    s_add_u32 s3, s3, s27
    ds_read_b64_tr_b16 v[208:209], v193 offset:28672
    v_mfma_f32_16x16x32_bf16 v[44:47], v[216:219], a[116:119], v[44:47]
    buffer_load_dwordx4 v175, s[44:47], s87 offen offset:3072 lds
    ds_read_b64_tr_b16 v[210:211], v193 offset:30464
    v_mfma_f32_16x16x32_bf16 v[52:55], v[216:219], a[120:123], v[52:55]
    s_mul_i32 s3, s3, 28672
    s_add_u32 s3, s3, 8388608
    v_mfma_f32_16x16x32_bf16 v[60:63], v[216:219], a[124:127], v[60:63]
    s_lshl_b32 s34, s24, 12
    s_add_u32 s63, s3, s34
    v_mfma_f32_16x16x32_bf16 v[124:127], v[220:223], v[144:147], v[124:127]
    s_waitcnt lgkmcnt(8)
    ds_read_b64_tr_b16 v[212:213], v197 offset:28672
    v_mfma_f32_16x16x32_bf16 v[64:67], v[224:227], a[112:115], v[64:67]
    s_add_u32 m0, s92, 59392
    s_nop 0
    buffer_load_dwordx4 v168, s[40:43], s86 offen offset:0 lds
    ds_read_b64_tr_b16 v[214:215], v197 offset:30464
    v_mfma_f32_16x16x32_bf16 v[72:75], v[224:227], a[116:119], v[72:75]
    s_mul_i32 s34, s24, 3072
    s_add_u32 s3, s3, s34
    v_mfma_f32_16x16x32_bf16 v[80:83], v[224:227], a[120:123], v[80:83]
    s_add_u32 s59, s3, 16384
    s_movk_i32 s3, 896
    v_mfma_f32_16x16x32_bf16 v[88:91], v[224:227], a[124:127], v[88:91]
    v_add_u32 v232, 0, v255
    v_mul_u32_u24 v233, s29, v232
    v_mfma_f32_16x16x32_bf16 v[96:99], v[228:231], a[112:115], v[96:99]
    buffer_load_dwordx4 v169, s[40:43], s86 offen offset:1024 lds
    ds_read_b64_tr_b16 v[216:217], v193 offset:35840
    v_mfma_f32_16x16x32_bf16 v[104:107], v[228:231], a[116:119], v[104:107]
    s_waitcnt lgkmcnt(5)
    ds_read_b64_tr_b16 v[218:219], v193 offset:37632
    v_mfma_f32_16x16x32_bf16 v[68:71], v[200:203], a[112:115], v[68:71]
    v_lshrrev_b32 v233, 16, v233
    v_mul_u32_u24 v234, 6, v233
    v_mfma_f32_16x16x32_bf16 v[76:79], v[200:203], a[116:119], v[76:79]
    v_sub_u32 v232, v232, v234
    v_mul_u32_u24 v233, s3, v233
    v_mfma_f32_16x16x32_bf16 v[84:87], v[200:203], a[120:123], v[84:87]
    buffer_load_dwordx4 v170, s[40:43], s86 offen offset:2048 lds
    ds_read_b64_tr_b16 v[220:221], v197 offset:28704
    v_mfma_f32_16x16x32_bf16 v[92:95], v[200:203], a[124:127], v[92:95]
    ds_read_b64_tr_b16 v[222:223], v197 offset:30496
    ds_read_b64_tr_b16 v[224:225], v193 offset:28704
    v_mfma_f32_16x16x32_bf16 v[100:103], v[204:207], a[112:115], v[100:103]
    ds_read_b64_tr_b16 v[226:227], v193 offset:30496
    v_lshl_add_u32 v251, v232, 4, v233
    v_mfma_f32_16x16x32_bf16 v[108:111], v[204:207], a[116:119], v[108:111]
    s_waitcnt lgkmcnt(6)
    v_add_u32 v232, 64, v255
    v_mfma_f32_16x16x32_bf16 v[0:3], v[208:211], a[128:131], v[0:3]
    buffer_load_dwordx4 v171, s[40:43], s86 offen offset:3072 lds
    s_add_u32 s86, s86, 114688
    v_mfma_f32_16x16x32_bf16 v[8:11], v[208:211], a[132:135], v[8:11]
    s_cmp_eq_u32 s86, 1605632
    ds_read_b64_tr_b16 v[228:229], v197 offset:28736
    s_cselect_b32 s86, 0, s86
    v_mfma_f32_16x16x32_bf16 v[16:19], v[208:211], a[136:139], v[16:19]
    ds_read_b64_tr_b16 v[230:231], v197 offset:30528
    v_mul_u32_u24 v233, s29, v232
    v_mfma_f32_16x16x32_bf16 v[24:27], v[208:211], a[140:143], v[24:27]
    s_waitcnt vmcnt(20)
    v_lshrrev_b32 v233, 16, v233
    s_barrier
    v_mfma_f32_16x16x32_bf16 v[112:115], v[212:215], v[144:147], v[112:115]
    s_add_u32 m0, s92, 28672
    s_nop 0
    buffer_load_dwordx4 v168, s[40:43], s86 offen offset:0 lds
    v_mfma_f32_16x16x32_bf16 v[128:131], v[144:147], a[128:131], v[128:131]
    v_mul_u32_u24 v234, 6, v233
    v_sub_u32 v232, v232, v234
    v_mfma_f32_16x16x32_bf16 v[136:139], a[128:131], a[128:131], v[136:139]
    ds_read_b64_tr_b16 v[200:201], v193 offset:35872
    v_mul_u32_u24 v233, s3, v233
    v_mfma_f32_16x16x32_bf16 v[132:135], v[144:147], a[132:135], v[132:135]
    ds_read_b64_tr_b16 v[202:203], v193 offset:37664
    v_lshl_add_u32 v252, v232, 4, v233
    v_mfma_f32_16x16x32_bf16 v[140:143], a[132:135], a[132:135], v[140:143]
    s_waitcnt lgkmcnt(6)
    buffer_load_dwordx4 v169, s[40:43], s86 offen offset:1024 lds
    v_mfma_f32_16x16x32_bf16 v[4:7], v[216:219], a[128:131], v[4:7]
    v_subrev_u32 v252, 1024, v252
    v_add_u32 v232, 128, v255
    v_mfma_f32_16x16x32_bf16 v[12:15], v[216:219], a[132:135], v[12:15]
    ds_read_b64_tr_b16 v[204:205], v199 offset:28672
    v_mul_u32_u24 v233, s29, v232
    v_mfma_f32_16x16x32_bf16 v[20:23], v[216:219], a[136:139], v[20:23]
    ds_read_b64_tr_b16 v[206:207], v199 offset:30464
    ds_read_b64_tr_b16 v[208:209], v193 offset:28736
    v_mfma_f32_16x16x32_bf16 v[28:31], v[216:219], a[140:143], v[28:31]
    buffer_load_dwordx4 v170, s[40:43], s86 offen offset:2048 lds
    ds_read_b64_tr_b16 v[210:211], v193 offset:30528
    v_mfma_f32_16x16x32_bf16 v[116:119], v[220:223], v[144:147], v[116:119]
    s_waitcnt lgkmcnt(6)
    v_lshrrev_b32 v233, 16, v233
    v_mfma_f32_16x16x32_bf16 v[32:35], v[224:227], a[128:131], v[32:35]
    v_mul_u32_u24 v234, 6, v233
    v_sub_u32 v232, v232, v234
    v_mfma_f32_16x16x32_bf16 v[40:43], v[224:227], a[132:135], v[40:43]
    ds_read_b64_tr_b16 v[212:213], v195 offset:28672
    v_mul_u32_u24 v233, s3, v233
    v_mfma_f32_16x16x32_bf16 v[48:51], v[224:227], a[136:139], v[48:51]
    buffer_load_dwordx4 v171, s[40:43], s86 offen offset:3072 lds
    ds_read_b64_tr_b16 v[214:215], v195 offset:30464
    v_mfma_f32_16x16x32_bf16 v[56:59], v[224:227], a[140:143], v[56:59]
    ds_read_b64_tr_b16 v[216:217], v193 offset:35904
    v_lshl_add_u32 v253, v232, 4, v233
    v_mfma_f32_16x16x32_bf16 v[120:123], v[228:231], v[144:147], v[120:123]
    ds_read_b64_tr_b16 v[218:219], v193 offset:37696
    v_subrev_u32 v253, 2048, v253
    v_mfma_f32_16x16x32_bf16 v[128:131], v[144:147], a[144:147], v[128:131]
    s_mov_b32 s3, 96
    v_bfe_u32 v254, v255, 2, 4
    v_mfma_f32_16x16x32_bf16 v[136:139], a[144:147], a[144:147], v[136:139]
    v_mul_u32_u24 v254, s3, v254
    v_bfe_u32 v232, v255, 0, 2
    v_mfma_f32_16x16x32_bf16 v[132:135], v[144:147], a[148:151], v[132:135]
    ds_read_b64_tr_b16 v[220:221], v195 offset:35840
    v_lshl_add_u32 v254, v232, 3, v254
    v_mfma_f32_16x16x32_bf16 v[140:143], a[148:151], a[148:151], v[140:143]
    s_waitcnt lgkmcnt(7)
    ds_read_b64_tr_b16 v[222:223], v195 offset:37632
    v_mfma_f32_16x16x32_bf16 v[36:39], v[200:203], a[128:131], v[36:39]
    ds_read_b64_tr_b16 v[224:225], v193 offset:14336
    v_add_u32 v254, s50, v254
    v_mfma_f32_16x16x32_bf16 v[44:47], v[200:203], a[132:135], v[44:47]
    ds_read_b64_tr_b16 v[226:227], v193 offset:16128
    v_mfma_f32_16x16x32_bf16 v[52:55], v[200:203], a[136:139], v[52:55]
    v_mfma_f32_16x16x32_bf16 v[60:63], v[200:203], a[140:143], v[60:63]
    v_mfma_f32_16x16x32_bf16 v[124:127], v[204:207], v[144:147], v[124:127]
    s_waitcnt lgkmcnt(6)
    ds_read_b64_tr_b16 v[228:229], v197 offset:14336
    v_mfma_f32_16x16x32_bf16 v[64:67], v[208:211], a[128:131], v[64:67]
    ds_read_b64_tr_b16 v[230:231], v197 offset:16128
    ds_read_b64_tr_b16 v[200:201], v193 offset:21504
    v_mfma_f32_16x16x32_bf16 v[72:75], v[208:211], a[132:135], v[72:75]
    ds_read_b64_tr_b16 v[202:203], v193 offset:23296
    v_mfma_f32_16x16x32_bf16 v[80:83], v[208:211], a[136:139], v[80:83]
    v_mfma_f32_16x16x32_bf16 v[88:91], v[208:211], a[140:143], v[88:91]
    v_mfma_f32_16x16x32_bf16 v[96:99], v[212:215], a[128:131], v[96:99]
    ds_read_b64_tr_b16 v[204:205], v197 offset:14368
    v_mfma_f32_16x16x32_bf16 v[104:107], v[212:215], a[132:135], v[104:107]
    s_waitcnt lgkmcnt(7)
    ds_read_b64_tr_b16 v[206:207], v197 offset:16160
    ds_read_b64_tr_b16 v[208:209], v193 offset:14368
    v_mfma_f32_16x16x32_bf16 v[68:71], v[216:219], a[128:131], v[68:71]
    ds_read_b64_tr_b16 v[210:211], v193 offset:16160
    v_mfma_f32_16x16x32_bf16 v[76:79], v[216:219], a[132:135], v[76:79]
    v_mfma_f32_16x16x32_bf16 v[84:87], v[216:219], a[136:139], v[84:87]
    v_mfma_f32_16x16x32_bf16 v[92:95], v[216:219], a[140:143], v[92:95]
    ds_read_b64_tr_b16 v[212:213], v197 offset:14400
    v_mfma_f32_16x16x32_bf16 v[100:103], v[220:223], a[128:131], v[100:103]
    ds_read_b64_tr_b16 v[214:215], v197 offset:16192
    ds_read_b64_tr_b16 v[216:217], v193 offset:21536
    v_mfma_f32_16x16x32_bf16 v[108:111], v[220:223], a[132:135], v[108:111]
    s_waitcnt lgkmcnt(9)
    ds_read_b64_tr_b16 v[218:219], v193 offset:23328
    v_mfma_f32_16x16x32_bf16 v[0:3], v[224:227], a[144:147], v[0:3]
    v_mfma_f32_16x16x32_bf16 v[8:11], v[224:227], a[148:151], v[8:11]
    v_mfma_f32_16x16x32_bf16 v[16:19], v[224:227], a[152:155], v[16:19]
    ds_read_b64_tr_b16 v[220:221], v199 offset:14336
    v_mfma_f32_16x16x32_bf16 v[24:27], v[224:227], a[156:159], v[24:27]
    s_waitcnt vmcnt(16)
    s_barrier
    ds_read_b64_tr_b16 v[222:223], v199 offset:16128
    v_mfma_f32_16x16x32_bf16 v[112:115], v[228:231], v[144:147], v[112:115]
    s_waitcnt lgkmcnt(8)
    ds_read_b64_tr_b16 v[224:225], v193 offset:14400
    ds_read_b64_tr_b16 v[226:227], v193 offset:16192
    v_mfma_f32_16x16x32_bf16 v[4:7], v[200:203], a[144:147], v[4:7]
    ds_read_b128 a[160:163], v164 offset:0
    ds_read_b128 a[164:167], v164 offset:2048
    v_mfma_f32_16x16x32_bf16 v[12:15], v[200:203], a[148:151], v[12:15]
    ds_read_b128 a[168:171], v166 offset:0
    ds_read_b128 a[172:175], v166 offset:2048
    v_mfma_f32_16x16x32_bf16 v[20:23], v[200:203], a[152:155], v[20:23]
    ds_read_b128 a[176:179], v165 offset:0
    s_waitcnt lgkmcnt(9)
    ds_read_b64_tr_b16 v[228:229], v195 offset:14336
    v_mfma_f32_16x16x32_bf16 v[28:31], v[200:203], a[156:159], v[28:31]
    ds_read_b128 a[180:183], v165 offset:2048
    ds_read_b64_tr_b16 v[230:231], v195 offset:16128
    v_mfma_f32_16x16x32_bf16 v[116:119], v[204:207], v[144:147], v[116:119]
    ds_read_b64_tr_b16 v[200:201], v193 offset:21568
    v_mfma_f32_16x16x32_bf16 v[32:35], v[208:211], a[144:147], v[32:35]
    ds_read_b128 a[184:187], v167 offset:0
    ds_read_b64_tr_b16 v[202:203], v193 offset:23360
    v_mfma_f32_16x16x32_bf16 v[40:43], v[208:211], a[148:151], v[40:43]
    s_waitcnt lgkmcnt(9)
    ds_read_b128 a[188:191], v167 offset:2048
    v_mfma_f32_16x16x32_bf16 v[48:51], v[208:211], a[152:155], v[48:51]
    v_mfma_f32_16x16x32_bf16 v[56:59], v[208:211], a[156:159], v[56:59]
    ds_read_b64_tr_b16 v[204:205], v195 offset:21504
    v_mfma_f32_16x16x32_bf16 v[120:123], v[212:215], v[144:147], v[120:123]
    ds_read_b64_tr_b16 v[206:207], v195 offset:23296
    v_mfma_f32_16x16x32_bf16 v[36:39], v[216:219], a[144:147], v[36:39]
    ds_read_b64_tr_b16 v[208:209], v193 offset:0
    v_mfma_f32_16x16x32_bf16 v[44:47], v[216:219], a[148:151], v[44:47]
    ds_read_b64_tr_b16 v[210:211], v193 offset:1792
    v_mfma_f32_16x16x32_bf16 v[52:55], v[216:219], a[152:155], v[52:55]
    v_mfma_f32_16x16x32_bf16 v[60:63], v[216:219], a[156:159], v[60:63]
    v_mfma_f32_16x16x32_bf16 v[124:127], v[220:223], v[144:147], v[124:127]
    s_waitcnt lgkmcnt(8)
    ds_read_b64_tr_b16 v[212:213], v197 offset:0
    v_mfma_f32_16x16x32_bf16 v[64:67], v[224:227], a[144:147], v[64:67]
    ds_read_b64_tr_b16 v[214:215], v197 offset:1792
    v_mfma_f32_16x16x32_bf16 v[72:75], v[224:227], a[148:151], v[72:75]
    v_mfma_f32_16x16x32_bf16 v[80:83], v[224:227], a[152:155], v[80:83]
    v_mfma_f32_16x16x32_bf16 v[88:91], v[224:227], a[156:159], v[88:91]
    v_mfma_f32_16x16x32_bf16 v[96:99], v[228:231], a[144:147], v[96:99]
    ds_read_b64_tr_b16 v[216:217], v193 offset:7168
    v_mfma_f32_16x16x32_bf16 v[104:107], v[228:231], a[148:151], v[104:107]
    s_waitcnt lgkmcnt(5)
    ds_read_b64_tr_b16 v[218:219], v193 offset:8960
    v_mfma_f32_16x16x32_bf16 v[68:71], v[200:203], a[144:147], v[68:71]
    v_mfma_f32_16x16x32_bf16 v[76:79], v[200:203], a[148:151], v[76:79]
    v_mfma_f32_16x16x32_bf16 v[84:87], v[200:203], a[152:155], v[84:87]
    ds_read_b64_tr_b16 v[220:221], v197 offset:32
    v_mfma_f32_16x16x32_bf16 v[92:95], v[200:203], a[156:159], v[92:95]
    ds_read_b64_tr_b16 v[222:223], v197 offset:1824
    ds_read_b64_tr_b16 v[224:225], v193 offset:32
    v_mfma_f32_16x16x32_bf16 v[100:103], v[204:207], a[144:147], v[100:103]
    ds_read_b64_tr_b16 v[226:227], v193 offset:1824
    v_mfma_f32_16x16x32_bf16 v[108:111], v[204:207], a[148:151], v[108:111]
    s_waitcnt lgkmcnt(6)
    v_mfma_f32_16x16x32_bf16 v[0:3], v[208:211], a[160:163], v[0:3]
    v_mfma_f32_16x16x32_bf16 v[8:11], v[208:211], a[164:167], v[8:11]
    ds_read_b64_tr_b16 v[228:229], v197 offset:64
    v_mfma_f32_16x16x32_bf16 v[16:19], v[208:211], a[168:171], v[16:19]
    ds_read_b64_tr_b16 v[230:231], v197 offset:1856
    v_mfma_f32_16x16x32_bf16 v[24:27], v[208:211], a[172:175], v[24:27]
    s_waitcnt vmcnt(12)
    s_barrier
    v_mfma_f32_16x16x32_bf16 v[112:115], v[212:215], v[144:147], v[112:115]
    s_add_u32 m0, s50, 4294901120
    s_nop 0
    buffer_load_dwordx4 v180, s[88:91], s4 offen offset:0 lds
    v_mfma_f32_16x16x32_bf16 v[128:131], v[144:147], a[160:163], v[128:131]
    v_mfma_f32_16x16x32_bf16 v[136:139], a[160:163], a[160:163], v[136:139]
    ds_read_b64_tr_b16 v[200:201], v193 offset:7200
    v_mfma_f32_16x16x32_bf16 v[132:135], v[144:147], a[164:167], v[132:135]
    ds_read_b64_tr_b16 v[202:203], v193 offset:8992
    v_mfma_f32_16x16x32_bf16 v[140:143], a[164:167], a[164:167], v[140:143]
    s_waitcnt lgkmcnt(6)
    buffer_load_dwordx4 v180, s[88:91], s5 offen offset:1024 lds
    v_mfma_f32_16x16x32_bf16 v[4:7], v[216:219], a[160:163], v[4:7]
    v_mfma_f32_16x16x32_bf16 v[12:15], v[216:219], a[164:167], v[12:15]
    ds_read_b64_tr_b16 v[204:205], v199 offset:0
    v_mfma_f32_16x16x32_bf16 v[20:23], v[216:219], a[168:171], v[20:23]
    ds_read_b64_tr_b16 v[206:207], v199 offset:1792
    ds_read_b64_tr_b16 v[208:209], v193 offset:64
    v_mfma_f32_16x16x32_bf16 v[28:31], v[216:219], a[172:175], v[28:31]
    buffer_load_dwordx4 v180, s[88:91], s6 offen offset:2048 lds
    ds_read_b64_tr_b16 v[210:211], v193 offset:1856
    v_mfma_f32_16x16x32_bf16 v[116:119], v[220:223], v[144:147], v[116:119]
    s_waitcnt lgkmcnt(6)
    v_mfma_f32_16x16x32_bf16 v[32:35], v[224:227], a[160:163], v[32:35]
    v_mfma_f32_16x16x32_bf16 v[40:43], v[224:227], a[164:167], v[40:43]
    ds_read_b64_tr_b16 v[212:213], v195 offset:0
    v_mfma_f32_16x16x32_bf16 v[48:51], v[224:227], a[168:171], v[48:51]
    buffer_load_dwordx4 v180, s[88:91], s7 offen offset:3072 lds
    ds_read_b64_tr_b16 v[214:215], v195 offset:1792
    v_mfma_f32_16x16x32_bf16 v[56:59], v[224:227], a[172:175], v[56:59]
    ds_read_b64_tr_b16 v[216:217], v193 offset:7232
    v_mfma_f32_16x16x32_bf16 v[120:123], v[228:231], v[144:147], v[120:123]
    ds_read_b64_tr_b16 v[218:219], v193 offset:9024
    v_mfma_f32_16x16x32_bf16 v[128:131], v[144:147], a[176:179], v[128:131]
    v_mfma_f32_16x16x32_bf16 v[136:139], a[176:179], a[176:179], v[136:139]
    s_add_u32 m0, s50, 4294905216
    s_nop 0
    buffer_load_dwordx4 v180, s[88:91], s8 offen offset:0 lds
    v_mfma_f32_16x16x32_bf16 v[132:135], v[144:147], a[180:183], v[132:135]
    ds_read_b64_tr_b16 v[220:221], v195 offset:7168
    v_mfma_f32_16x16x32_bf16 v[140:143], a[180:183], a[180:183], v[140:143]
    s_waitcnt lgkmcnt(7)
    ds_read_b64_tr_b16 v[222:223], v195 offset:8960
    v_mfma_f32_16x16x32_bf16 v[36:39], v[200:203], a[160:163], v[36:39]
    ds_read_b64_tr_b16 v[224:225], v192 offset:45056
    v_mfma_f32_16x16x32_bf16 v[44:47], v[200:203], a[164:167], v[44:47]
    buffer_load_dwordx4 v180, s[88:91], s9 offen offset:1024 lds
    ds_read_b64_tr_b16 v[226:227], v192 offset:46848
    v_mfma_f32_16x16x32_bf16 v[52:55], v[200:203], a[168:171], v[52:55]
    v_mfma_f32_16x16x32_bf16 v[60:63], v[200:203], a[172:175], v[60:63]
    v_mfma_f32_16x16x32_bf16 v[124:127], v[204:207], v[144:147], v[124:127]
    s_waitcnt lgkmcnt(6)
    ds_read_b64_tr_b16 v[228:229], v196 offset:45056
    v_mfma_f32_16x16x32_bf16 v[64:67], v[208:211], a[160:163], v[64:67]
    buffer_load_dwordx4 v180, s[88:91], s10 offen offset:2048 lds
    ds_read_b64_tr_b16 v[230:231], v196 offset:46848
    v_mfma_f32_16x16x32_bf16 v[72:75], v[208:211], a[164:167], v[72:75]
    ds_read_b64_tr_b16 v[200:201], v192 offset:52224
    ds_read_b64_tr_b16 v[202:203], v192 offset:54016
    v_mfma_f32_16x16x32_bf16 v[80:83], v[208:211], a[168:171], v[80:83]
    v_mfma_f32_16x16x32_bf16 v[88:91], v[208:211], a[172:175], v[88:91]
    v_mfma_f32_16x16x32_bf16 v[96:99], v[212:215], a[160:163], v[96:99]
    s_mov_b32 s44, s94
    ds_read_b64_tr_b16 v[204:205], v196 offset:45088
    s_mov_b32 s45, s95
    v_mfma_f32_16x16x32_bf16 v[104:107], v[212:215], a[164:167], v[104:107]
    s_waitcnt lgkmcnt(7)
    ds_read_b64_tr_b16 v[206:207], v196 offset:46880
    s_mov_b32 s46, 3670016
    v_mfma_f32_16x16x32_bf16 v[68:71], v[216:219], a[160:163], v[68:71]
    s_mov_b32 s47, 0x00020000
    ds_read_b64_tr_b16 v[208:209], v192 offset:45088
    s_mov_b32 s40, s96
    s_mov_b32 s41, s97
    s_mov_b32 s42, 1605632
    s_mov_b32 s43, 0x00020000
    v_mfma_f32_16x16x32_bf16 v[76:79], v[216:219], a[164:167], v[76:79]
    ds_read_b64_tr_b16 v[210:211], v192 offset:46880
    v_mfma_f32_16x16x32_bf16 v[84:87], v[216:219], a[168:171], v[84:87]
    v_mfma_f32_16x16x32_bf16 v[92:95], v[216:219], a[172:175], v[92:95]
    ds_read_b64_tr_b16 v[212:213], v196 offset:45120
    v_mfma_f32_16x16x32_bf16 v[100:103], v[220:223], a[160:163], v[100:103]
    ds_read_b64_tr_b16 v[214:215], v196 offset:46912
    ds_read_b64_tr_b16 v[216:217], v192 offset:52256
    v_mfma_f32_16x16x32_bf16 v[108:111], v[220:223], a[164:167], v[108:111]
    s_waitcnt lgkmcnt(9)
    ds_read_b64_tr_b16 v[218:219], v192 offset:54048
    v_mfma_f32_16x16x32_bf16 v[0:3], v[224:227], a[176:179], v[0:3]
    v_mfma_f32_16x16x32_bf16 v[8:11], v[224:227], a[180:183], v[8:11]
    v_mfma_f32_16x16x32_bf16 v[16:19], v[224:227], a[184:187], v[16:19]
    ds_read_b64_tr_b16 v[220:221], v198 offset:45056
    v_mfma_f32_16x16x32_bf16 v[24:27], v[224:227], a[188:191], v[24:27]
    s_waitcnt vmcnt(11)
    s_barrier
    ds_read_b64_tr_b16 v[222:223], v198 offset:46848
    v_mfma_f32_16x16x32_bf16 v[112:115], v[228:231], v[144:147], v[112:115]
    s_waitcnt lgkmcnt(8)
    ds_read_b64_tr_b16 v[224:225], v192 offset:45120
    s_add_u32 m0, s50, 68992
    v_mfma_f32_16x16x32_bf16 v[4:7], v[200:203], a[176:179], v[4:7]
    buffer_load_dwordx4 v180, s[88:91], s11 offen offset:0 lds
    ds_read_b64_tr_b16 v[226:227], v192 offset:46912
    v_mfma_f32_16x16x32_bf16 v[12:15], v[200:203], a[180:183], v[12:15]
    ds_read_b128 a[192:195], v160 offset:43008
    ds_read_b128 a[196:199], v160 offset:45056
    v_mfma_f32_16x16x32_bf16 v[20:23], v[200:203], a[184:187], v[20:23]
    ds_read_b128 a[200:203], v162 offset:43008
    ds_read_b128 a[204:207], v162 offset:45056
    v_mfma_f32_16x16x32_bf16 v[28:31], v[200:203], a[188:191], v[28:31]
    ds_read_b128 a[208:211], v161 offset:43008
    s_waitcnt lgkmcnt(9)
    ds_read_b64_tr_b16 v[228:229], v194 offset:45056
    v_mfma_f32_16x16x32_bf16 v[116:119], v[204:207], v[144:147], v[116:119]
    ds_read_b128 a[212:215], v161 offset:45056
    buffer_load_dwordx4 v180, s[88:91], s80 offen offset:1024 lds
    ds_read_b64_tr_b16 v[230:231], v194 offset:46848
    v_mfma_f32_16x16x32_bf16 v[32:35], v[208:211], a[176:179], v[32:35]
    ds_read_b64_tr_b16 v[200:201], v192 offset:52288
    ds_read_b128 a[216:219], v163 offset:43008
    v_mfma_f32_16x16x32_bf16 v[40:43], v[208:211], a[180:183], v[40:43]
    ds_read_b64_tr_b16 v[202:203], v192 offset:54080
    s_waitcnt lgkmcnt(9)
    ds_read_b128 a[220:223], v163 offset:45056
    v_mfma_f32_16x16x32_bf16 v[48:51], v[208:211], a[184:187], v[48:51]
    buffer_load_dwordx4 v180, s[88:91], s81 offen offset:2048 lds
    v_mfma_f32_16x16x32_bf16 v[56:59], v[208:211], a[188:191], v[56:59]
    ds_read_b64_tr_b16 v[204:205], v194 offset:52224
    v_mfma_f32_16x16x32_bf16 v[120:123], v[212:215], v[144:147], v[120:123]
    ds_read_b64_tr_b16 v[206:207], v194 offset:54016
    v_mfma_f32_16x16x32_bf16 v[36:39], v[216:219], a[176:179], v[36:39]
    v_mfma_f32_16x16x32_bf16 v[44:47], v[216:219], a[180:183], v[44:47]
    buffer_load_dwordx4 v180, s[88:91], s82 offen offset:3072 lds
    v_mfma_f32_16x16x32_bf16 v[52:55], v[216:219], a[184:187], v[52:55]
    v_mfma_f32_16x16x32_bf16 v[60:63], v[216:219], a[188:191], v[60:63]
    v_mfma_f32_16x16x32_bf16 v[124:127], v[220:223], v[144:147], v[124:127]
    s_waitcnt lgkmcnt(6)
    v_mfma_f32_16x16x32_bf16 v[64:67], v[224:227], a[176:179], v[64:67]
    s_add_u32 m0, s50, 73088
    s_nop 0
    buffer_load_dwordx4 v180, s[88:91], s83 offen offset:0 lds
    v_mfma_f32_16x16x32_bf16 v[72:75], v[224:227], a[180:183], v[72:75]
    v_mfma_f32_16x16x32_bf16 v[80:83], v[224:227], a[184:187], v[80:83]
    v_mfma_f32_16x16x32_bf16 v[88:91], v[224:227], a[188:191], v[88:91]
    ds_read_b64_tr_b16 v[208:209], v192 offset:30720
    v_mfma_f32_16x16x32_bf16 v[96:99], v[228:231], a[176:179], v[96:99]
    buffer_load_dwordx4 v180, s[88:91], s84 offen offset:1024 lds
    ds_read_b64_tr_b16 v[210:211], v192 offset:32512
    v_mfma_f32_16x16x32_bf16 v[104:107], v[228:231], a[180:183], v[104:107]
    s_waitcnt lgkmcnt(2)
    v_mfma_f32_16x16x32_bf16 v[68:71], v[200:203], a[176:179], v[68:71]
    v_mfma_f32_16x16x32_bf16 v[76:79], v[200:203], a[180:183], v[76:79]
    ds_read_b64_tr_b16 v[212:213], v196 offset:30720
    v_mfma_f32_16x16x32_bf16 v[84:87], v[200:203], a[184:187], v[84:87]
    buffer_load_dwordx4 v180, s[88:91], s85 offen offset:2048 lds
    ds_read_b64_tr_b16 v[214:215], v196 offset:32512
    v_mfma_f32_16x16x32_bf16 v[92:95], v[200:203], a[188:191], v[92:95]
    ds_read_b64_tr_b16 v[216:217], v192 offset:37888
    ds_read_b64_tr_b16 v[218:219], v192 offset:39680
    v_mfma_f32_16x16x32_bf16 v[100:103], v[204:207], a[176:179], v[100:103]
    v_mfma_f32_16x16x32_bf16 v[108:111], v[204:207], a[180:183], v[108:111]
    v_mfma_f32_16x16x32_bf16 v[128:131], v[144:147], a[192:195], v[128:131]
    ds_read_b64_tr_b16 v[220:221], v196 offset:30752
    v_mfma_f32_16x16x32_bf16 v[136:139], a[192:195], a[192:195], v[136:139]
    ds_read_b64_tr_b16 v[222:223], v196 offset:32544
    ds_read_b64_tr_b16 v[224:225], v192 offset:30752
    v_mfma_f32_16x16x32_bf16 v[132:135], v[144:147], a[196:199], v[132:135]
    ds_read_b64_tr_b16 v[226:227], v192 offset:32544
    v_mfma_f32_16x16x32_bf16 v[140:143], a[196:199], a[196:199], v[140:143]
    s_waitcnt vmcnt(14)
    s_barrier
    v_mfma_f32_16x16x32_bf16 v[128:131], v[144:147], a[208:211], v[128:131]
    s_add_u32 m0, s50, 35904
    v_add_u32 v180, 128, v180
    v_mfma_f32_16x16x32_bf16 v[136:139], a[208:211], a[208:211], v[136:139]
    buffer_load_dwordx4 v180, s[88:91], s4 offen offset:0 lds
    ds_read_b64_tr_b16 v[228:229], v196 offset:30784
    v_mfma_f32_16x16x32_bf16 v[132:135], v[144:147], a[212:215], v[132:135]
    ds_read_b64_tr_b16 v[230:231], v196 offset:32576
    ds_read_b64_tr_b16 v[200:201], v192 offset:37920
    v_mfma_f32_16x16x32_bf16 v[140:143], a[212:215], a[212:215], v[140:143]
    s_waitcnt lgkmcnt(9)
    ds_read_b64_tr_b16 v[202:203], v192 offset:39712
    v_mfma_f32_16x16x32_bf16 v[0:3], v[208:211], a[192:195], v[0:3]
    buffer_load_dwordx4 v180, s[88:91], s5 offen offset:1024 lds
    v_mfma_f32_16x16x32_bf16 v[8:11], v[208:211], a[196:199], v[8:11]
    v_mfma_f32_16x16x32_bf16 v[16:19], v[208:211], a[200:203], v[16:19]
    ds_read_b64_tr_b16 v[204:205], v198 offset:30720
    v_cndmask_b32 v136, v136, v137, s[98:99]
    v_mfma_f32_16x16x32_bf16 v[24:27], v[208:211], a[204:207], v[24:27]
    ds_read_b64_tr_b16 v[206:207], v198 offset:32512
    v_cndmask_b32 v138, v138, v139, s[98:99]
    v_mfma_f32_16x16x32_bf16 v[112:115], v[212:215], v[144:147], v[112:115]
    s_waitcnt lgkmcnt(8)
    ds_read_b64_tr_b16 v[208:209], v192 offset:30784
    v_cndmask_b32 v136, v136, v138, s[100:101]
    v_mfma_f32_16x16x32_bf16 v[4:7], v[216:219], a[192:195], v[4:7]
    buffer_load_dwordx4 v180, s[88:91], s6 offen offset:2048 lds
    ds_read_b64_tr_b16 v[210:211], v192 offset:32576
    v_mfma_f32_16x16x32_bf16 v[12:15], v[216:219], a[196:199], v[12:15]
    v_cndmask_b32 v136, 0, v136, vcc
    v_cndmask_b32 v140, v140, v141, s[98:99]
    v_mfma_f32_16x16x32_bf16 v[20:23], v[216:219], a[200:203], v[20:23]
    ds_read_b64_tr_b16 v[212:213], v194 offset:30720
    v_cndmask_b32 v142, v142, v143, s[98:99]
    v_cndmask_b32 v140, v140, v142, s[100:101]
    v_mfma_f32_16x16x32_bf16 v[28:31], v[216:219], a[204:207], v[28:31]
    buffer_load_dwordx4 v180, s[88:91], s7 offen offset:3072 lds
    v_cndmask_b32 v140, 0, v140, vcc
    v_mov_b32 v137, v136
    v_mov_b32 v141, v140
    v_mfma_f32_16x16x32_bf16 v[116:119], v[220:223], v[144:147], v[116:119]
    s_waitcnt lgkmcnt(7)
    ds_read_b64_tr_b16 v[214:215], v194 offset:32512
    v_permlane32_swap_b32 v136, v137
    v_permlane32_swap_b32 v140, v141
    v_mfma_f32_16x16x32_bf16 v[32:35], v[224:227], a[192:195], v[32:35]
    ds_read_b64_tr_b16 v[216:217], v192 offset:37952
    v_add_f32 v136, v136, v137
    v_add_f32 v140, v140, v141
    v_mfma_f32_16x16x32_bf16 v[40:43], v[224:227], a[196:199], v[40:43]
    ds_read_b64_tr_b16 v[218:219], v192 offset:39744
    v_mov_b32 v137, v136
    v_mfma_f32_16x16x32_bf16 v[48:51], v[224:227], a[200:203], v[48:51]
    s_add_u32 m0, s50, 40000
    s_nop 0
    buffer_load_dwordx4 v180, s[88:91], s8 offen offset:0 lds
    v_mov_b32 v141, v140
    v_permlane16_swap_b32 v136, v137
    v_mfma_f32_16x16x32_bf16 v[56:59], v[224:227], a[204:207], v[56:59]
    ds_read_b64_tr_b16 v[220:221], v194 offset:37888
    v_permlane16_swap_b32 v140, v141
    v_add_f32 v136, v136, v137
    v_add_f32 v140, v140, v141
    v_mfma_f32_16x16x32_bf16 v[120:123], v[228:231], v[144:147], v[120:123]
    s_waitcnt lgkmcnt(7)
    ds_read_b64_tr_b16 v[222:223], v194 offset:39680
    v_mul_f32 v232, 0x3b124925, v128
    v_mul_f32 v234, 0x3b124925, v132
    v_mul_f32 v136, 0x3b124925, v136
    v_mfma_f32_16x16x32_bf16 v[36:39], v[200:203], a[192:195], v[36:39]
    ds_read_b64_tr_b16 v[224:225], v196 offset:0
    v_mul_f32 v140, 0x3b124925, v140
    v_fma_f32 v136, -v232, v232, v136
    v_mfma_f32_16x16x32_bf16 v[44:47], v[200:203], a[196:199], v[44:47]
    buffer_load_dwordx4 v180, s[88:91], s9 offen offset:1024 lds
    v_fma_f32 v140, -v234, v234, v140
    v_mfma_f32_16x16x32_bf16 v[52:55], v[200:203], a[200:203], v[52:55]
    ds_read_b64_tr_b16 v[226:227], v196 offset:1792
    ds_read_b64_tr_b16 v[228:229], v196 offset:32
    v_max_f32 v136, 0, v136
    v_max_f32 v140, 0, v140
    v_cvt_pk_bf16_f32 v137, v232, v232
    v_mfma_f32_16x16x32_bf16 v[60:63], v[200:203], a[204:207], v[60:63]
    ds_read_b64_tr_b16 v[230:231], v196 offset:1824
    v_cvt_pk_bf16_f32 v141, v234, v234
    v_lshlrev_b32 v232, 16, v137
    v_lshlrev_b32 v234, 16, v141
    v_mfma_f32_16x16x32_bf16 v[124:127], v[204:207], v[144:147], v[124:127]
    s_waitcnt lgkmcnt(8)
    ds_read_b64_tr_b16 v[200:201], v196 offset:64
    v_cvt_pk_bf16_f32 v137, v136, v136
    v_cvt_pk_bf16_f32 v141, v140, v140
    v_lshlrev_b32 v136, 16, v137
    v_mfma_f32_16x16x32_bf16 v[64:67], v[208:211], a[192:195], v[64:67]
    ds_read_b64_tr_b16 v[202:203], v196 offset:1856
    ds_read_b64_tr_b16 v[204:205], v198 offset:0
    v_lshlrev_b32 v140, 16, v141
    v_add_f32 v136, 0x3727c5ac, v136
    v_add_f32 v140, 0x3727c5ac, v140
    v_mfma_f32_16x16x32_bf16 v[72:75], v[208:211], a[196:199], v[72:75]
    buffer_load_dwordx4 v180, s[88:91], s10 offen offset:2048 lds
    ds_read_b64_tr_b16 v[206:207], v198 offset:1792
    v_cvt_pk_bf16_f32 v137, v136, v136
    v_cvt_pk_bf16_f32 v141, v140, v140
    v_mfma_f32_16x16x32_bf16 v[80:83], v[208:211], a[200:203], v[80:83]
    v_lshlrev_b32 v136, 16, v137
    v_lshlrev_b32 v140, 16, v141
    v_mfma_f32_16x16x32_bf16 v[88:91], v[208:211], a[204:207], v[88:91]
    ds_read_b64_tr_b16 v[208:209], v192 offset:0
    v_sqrt_f32 v233, v136
    v_mfma_f32_16x16x32_bf16 v[96:99], v[212:215], a[192:195], v[96:99]
    ds_read_b64_tr_b16 v[210:211], v192 offset:1792
    v_sqrt_f32 v235, v140
    v_cvt_pk_bf16_f32 v137, v233, v233
    v_mfma_f32_16x16x32_bf16 v[104:107], v[212:215], a[196:199], v[104:107]
    s_waitcnt lgkmcnt(10)
    ds_read_b64_tr_b16 v[212:213], v192 offset:7168
    v_cvt_pk_bf16_f32 v141, v235, v235
    v_lshlrev_b32 v233, 16, v137
    v_lshlrev_b32 v235, 16, v141
    v_mfma_f32_16x16x32_bf16 v[68:71], v[216:219], a[192:195], v[68:71]
    v_and_b32 v240, 15, v255
    v_lshlrev_b32 v240, 4, v240
    v_lshl_add_u32 v240, s24, 8, v240
    v_mfma_f32_16x16x32_bf16 v[76:79], v[216:219], a[196:199], v[76:79]
    v_xor_b32 v241, 0x100, v240
    v_add_u32 v240, 96384, v240
    ds_write_b128 v240, v[232:235]
    ds_read_b64_tr_b16 v[214:215], v192 offset:8960
    v_mfma_f32_16x16x32_bf16 v[84:87], v[216:219], a[200:203], v[84:87]
    v_add_u32 v240, 96384, v241
    v_mfma_f32_16x16x32_bf16 v[92:95], v[216:219], a[204:207], v[92:95]
    ds_read_b64_tr_b16 v[216:217], v192 offset:32
    v_mfma_f32_16x16x32_bf16 v[100:103], v[220:223], a[192:195], v[100:103]
    ds_read_b64_tr_b16 v[218:219], v192 offset:1824
    v_mfma_f32_16x16x32_bf16 v[108:111], v[220:223], a[196:199], v[108:111]
    s_waitcnt lgkmcnt(11)
    ds_read_b64_tr_b16 v[220:221], v192 offset:7200
    v_mfma_f32_16x16x32_bf16 v[112:115], v[224:227], v[144:147], v[112:115]
    ds_read_b64_tr_b16 v[222:223], v192 offset:8992
    v_mfma_f32_16x16x32_bf16 v[116:119], v[228:231], v[144:147], v[116:119]
    s_waitcnt lgkmcnt(9)
    v_mfma_f32_16x16x32_bf16 v[120:123], v[200:203], v[144:147], v[120:123]
    v_mfma_f32_16x16x32_bf16 v[124:127], v[204:207], v[144:147], v[124:127]
    s_waitcnt lgkmcnt(4)
    ds_read_b64_tr_b16 v[224:225], v192 offset:64
    v_mfma_f32_16x16x32_bf16 v[0:3], v[208:211], a[208:211], v[0:3]
    ds_read_b64_tr_b16 v[226:227], v192 offset:1856
    v_mfma_f32_16x16x32_bf16 v[8:11], v[208:211], a[212:215], v[8:11]
    ds_write_b128 v190, v[112:115] offset:0
    v_mfma_f32_16x16x32_bf16 v[16:19], v[208:211], a[216:219], v[16:19]
    ds_write_b128 v190, v[116:119] offset:64
    v_mfma_f32_16x16x32_bf16 v[24:27], v[208:211], a[220:223], v[24:27]
    ds_write_b128 v190, v[120:123] offset:128
    ds_read_b64_tr_b16 v[228:229], v194 offset:0
    v_mfma_f32_16x16x32_bf16 v[4:7], v[212:215], a[208:211], v[4:7]
    ds_write_b128 v190, v[124:127] offset:192
    ds_read_b64_tr_b16 v[230:231], v194 offset:1792
    v_mfma_f32_16x16x32_bf16 v[12:15], v[212:215], a[212:215], v[12:15]
    ds_read_b64_tr_b16 v[200:201], v192 offset:7232
    v_mfma_f32_16x16x32_bf16 v[20:23], v[212:215], a[216:219], v[20:23]
    ds_read_b64_tr_b16 v[202:203], v192 offset:9024
    v_mfma_f32_16x16x32_bf16 v[28:31], v[212:215], a[220:223], v[28:31]
    s_waitcnt lgkmcnt(10)
    s_waitcnt lgkmcnt(3)
    s_waitcnt vmcnt(14)
    v_mfma_f32_16x16x32_bf16 v[32:35], v[216:219], a[208:211], v[32:35]
    s_barrier
    ds_read_b128 v[236:239], v240
    s_add_u32 m0, s50, 0
    v_mfma_f32_16x16x32_bf16 v[40:43], v[216:219], a[212:215], v[40:43]
    buffer_load_dwordx4 v180, s[88:91], s11 offen offset:0 lds
    v_mfma_f32_16x16x32_bf16 v[48:51], v[216:219], a[216:219], v[48:51]
    ds_read_b64_tr_b16 v[204:205], v194 offset:7168
    v_mfma_f32_16x16x32_bf16 v[56:59], v[216:219], a[220:223], v[56:59]
    ds_read_b64_tr_b16 v[206:207], v194 offset:8960
    v_rcp_f32 v168, v233
    v_mfma_f32_16x16x32_bf16 v[36:39], v[220:223], a[208:211], v[36:39]
    ds_read_b64_tr_b16 v[208:209], v181 offset:0
    v_sub_f32 v160, 0, v232
    v_mul_f32 v176, v233, v233
    v_mfma_f32_16x16x32_bf16 v[44:47], v[220:223], a[212:215], v[44:47]
    buffer_load_dwordx4 v180, s[88:91], s80 offen offset:1024 lds
    ds_read_b64_tr_b16 v[210:211], v181 offset:7168
    v_mul_f32 v164, 0x3db8aa3b, v168
    v_mul_f32 v172, v168, v168
    v_mul_f32 v172, v172, v168
    v_mfma_f32_16x16x32_bf16 v[52:55], v[220:223], a[216:219], v[52:55]
    v_mul_f32 v168, 0xc0135761, v168
    v_mul_f32 v172, 0xbdd2d3e8, v172
    v_mfma_f32_16x16x32_bf16 v[60:63], v[220:223], a[220:223], v[60:63]
    s_waitcnt lgkmcnt(7)
    v_rcp_f32 v169, v235
    v_sub_f32 v161, 0, v234
    v_mfma_f32_16x16x32_bf16 v[64:67], v[224:227], a[208:211], v[64:67]
    buffer_load_dwordx4 v180, s[88:91], s81 offen offset:2048 lds
    v_mul_f32 v177, v235, v235
    v_mul_f32 v165, 0x3db8aa3b, v169
    v_mul_f32 v173, v169, v169
    v_mfma_f32_16x16x32_bf16 v[72:75], v[224:227], a[212:215], v[72:75]
    s_waitcnt lgkmcnt(4)
    ds_read_b64_tr_b16 v[212:213], v182 offset:0
    v_mul_f32 v173, v173, v169
    v_mul_f32 v169, 0xc0135761, v169
    v_mfma_f32_16x16x32_bf16 v[80:83], v[224:227], a[216:219], v[80:83]
    ds_read_b64_tr_b16 v[214:215], v182 offset:7168
    v_mul_f32 v173, 0xbdd2d3e8, v173
    v_mfma_f32_16x16x32_bf16 v[88:91], v[224:227], a[220:223], v[88:91]
    v_rcp_f32 v170, v237
    v_sub_f32 v162, 0, v236
    v_mfma_f32_16x16x32_bf16 v[96:99], v[228:231], a[208:211], v[96:99]
    buffer_load_dwordx4 v180, s[88:91], s82 offen offset:3072 lds
    v_mul_f32 v178, v237, v237
    v_mul_f32 v166, 0x3db8aa3b, v170
    v_mul_f32 v174, v170, v170
    v_mfma_f32_16x16x32_bf16 v[104:107], v[228:231], a[212:215], v[104:107]
    s_waitcnt lgkmcnt(4)
    ds_read_b64_tr_b16 v[216:217], v181 offset:1024
    v_mul_f32 v174, v174, v170
    v_mul_f32 v170, 0xc0135761, v170
    v_mul_f32 v174, 0xbdd2d3e8, v174
    v_mfma_f32_16x16x32_bf16 v[68:71], v[200:203], a[208:211], v[68:71]
    ds_read_b64_tr_b16 v[218:219], v181 offset:8192
    v_rcp_f32 v171, v239
    v_mfma_f32_16x16x32_bf16 v[76:79], v[200:203], a[212:215], v[76:79]
    v_sub_f32 v163, 0, v238
    v_mul_f32 v179, v239, v239
    v_mfma_f32_16x16x32_bf16 v[84:87], v[200:203], a[216:219], v[84:87]
    s_add_u32 m0, s50, 4096
    s_nop 0
    buffer_load_dwordx4 v180, s[88:91], s83 offen offset:0 lds
    v_mul_f32 v167, 0x3db8aa3b, v171
    v_mul_f32 v175, v171, v171
    v_mul_f32 v175, v175, v171
    v_mfma_f32_16x16x32_bf16 v[92:95], v[200:203], a[220:223], v[92:95]
    ds_read_b64_tr_b16 v[220:221], v182 offset:1024
    v_mul_f32 v171, 0xc0135761, v171
    v_mul_f32 v175, 0xbdd2d3e8, v175
    v_mfma_f32_16x16x32_bf16 v[100:103], v[204:207], a[208:211], v[100:103]
    ds_read_b64_tr_b16 v[222:223], v182 offset:8192
    v_mfma_f32_16x16x32_bf16 v[108:111], v[204:207], a[212:215], v[108:111]
    s_waitcnt lgkmcnt(4)
    v_mfma_f32_16x16x32_bf16 v[148:151], v[208:211], v[144:147], 0
    buffer_load_dwordx4 v180, s[88:91], s84 offen offset:1024 lds
    v_mfma_f32_16x16x32_bf16 v[112:115], v[208:211], a[0:3], 0
    ds_read_b64_tr_b16 v[224:225], v181 offset:2048
    v_mfma_f32_16x16x32_bf16 v[116:119], v[208:211], a[4:7], 0
    ds_read_b128 v[200:203], v191 offset:0
    ds_read_b64_tr_b16 v[226:227], v181 offset:9216
    v_mfma_f32_16x16x32_bf16 v[120:123], v[208:211], a[8:11], 0
    ds_read_b128 v[204:207], v191 offset:384
    s_waitcnt vmcnt(13)
    v_mfma_f32_16x16x32_bf16 v[124:127], v[208:211], a[12:15], 0
    s_barrier
    buffer_load_dwordx4 v180, s[88:91], s85 offen offset:2048 lds
    s_lshl_b32 s3, s26, 2
    v_mfma_f32_16x16x32_bf16 v[128:131], v[212:215], a[0:3], 0
    s_add_u32 s3, s3, s53
    s_add_u32 s3, s3, 0
    s_lshr_b32 s34, s3, 1
    v_mfma_f32_16x16x32_bf16 v[132:135], v[212:215], a[4:7], 0
    s_lshl_b32 s34, s34, 12
    ds_read_b64_tr_b16 v[228:229], v182 offset:2048
    s_and_b32 s3, s3, 1
    s_lshl_b32 s3, s3, 3
    s_add_u32 s34, s34, s3
    s_add_u32 s86, s34, s54
    s_add_u32 s87, s34, s55
    v_mfma_f32_16x16x32_bf16 v[136:139], v[212:215], a[8:11], 0
    s_waitcnt lgkmcnt(3)
    ds_read_b64_tr_b16 v[230:231], v182 offset:9216
    v_fmac_f32 v0, v200, v160
    v_fmac_f32 v1, v201, v160
    v_mfma_f32_16x16x32_bf16 v[140:143], v[212:215], a[12:15], 0
    s_waitcnt lgkmcnt(2)
    v_fmac_f32 v2, v202, v160
    v_fmac_f32 v3, v203, v160
    v_mfma_f32_16x16x32_bf16 v[148:151], v[216:219], v[144:147], v[148:151]
    s_add_u32 m0, s50, 4294937984
    v_fmac_f32 v4, v204, v160
    v_add_u32 v180, 128, v180
    v_mfma_f32_16x16x32_bf16 v[112:115], v[216:219], a[16:19], v[112:115]
    buffer_load_dwordx4 v180, s[88:91], s4 offen offset:0 lds
    v_fmac_f32 v5, v205, v160
    v_mfma_f32_16x16x32_bf16 v[116:119], v[216:219], a[20:23], v[116:119]
    ds_read_b64_tr_b16 v[208:209], v181 offset:3072
    v_fmac_f32 v6, v206, v160
    v_fmac_f32 v7, v207, v160
    v_mfma_f32_16x16x32_bf16 v[120:123], v[216:219], a[24:27], v[120:123]
    ds_read_b64_tr_b16 v[210:211], v181 offset:10240
    v_fmac_f32 v8, v200, v161
    v_fmac_f32 v9, v201, v161
    v_mfma_f32_16x16x32_bf16 v[124:127], v[216:219], a[28:31], v[124:127]
    v_fmac_f32 v10, v202, v161
    v_fmac_f32 v11, v203, v161
    v_mfma_f32_16x16x32_bf16 v[128:131], v[220:223], a[16:19], v[128:131]
    v_fmac_f32 v12, v204, v161
    v_fmac_f32 v13, v205, v161
    v_mfma_f32_16x16x32_bf16 v[132:135], v[220:223], a[20:23], v[132:135]
    buffer_load_dwordx4 v180, s[88:91], s5 offen offset:1024 lds
    v_fmac_f32 v14, v206, v161
    v_fmac_f32 v15, v207, v161
    v_mfma_f32_16x16x32_bf16 v[136:139], v[220:223], a[24:27], v[136:139]
    ds_read_b64_tr_b16 v[212:213], v182 offset:3072
    v_fmac_f32 v16, v200, v162
    v_fmac_f32 v17, v201, v162
    v_fmac_f32 v18, v202, v162
    v_mfma_f32_16x16x32_bf16 v[140:143], v[220:223], a[28:31], v[140:143]
    s_waitcnt lgkmcnt(3)
    ds_read_b64_tr_b16 v[214:215], v182 offset:10240
    v_fmac_f32 v19, v203, v162
    v_mfma_f32_16x16x32_bf16 v[148:151], v[224:227], v[144:147], v[148:151]
    v_fmac_f32 v20, v204, v162
    v_fmac_f32 v21, v205, v162
    v_mfma_f32_16x16x32_bf16 v[112:115], v[224:227], a[32:35], v[112:115]
    ds_read_b64_tr_b16 v[216:217], v181 offset:4096
    v_fmac_f32 v22, v206, v162
    v_mfma_f32_16x16x32_bf16 v[116:119], v[224:227], a[36:39], v[116:119]
    ds_read_b64_tr_b16 v[218:219], v181 offset:11264
    v_fmac_f32 v23, v207, v162
    v_fmac_f32 v24, v200, v163
    v_mfma_f32_16x16x32_bf16 v[120:123], v[224:227], a[40:43], v[120:123]
    v_fmac_f32 v25, v201, v163
    v_fmac_f32 v26, v202, v163
    v_mfma_f32_16x16x32_bf16 v[124:127], v[224:227], a[44:47], v[124:127]
    buffer_load_dwordx4 v180, s[88:91], s6 offen offset:2048 lds
    v_fmac_f32 v27, v203, v163
    v_mfma_f32_16x16x32_bf16 v[128:131], v[228:231], a[32:35], v[128:131]
    ds_read_b128 v[200:203], v191 offset:64
    v_fmac_f32 v28, v204, v163
    v_fmac_f32 v29, v205, v163
    v_fmac_f32 v30, v206, v163
    v_mfma_f32_16x16x32_bf16 v[132:135], v[228:231], a[36:39], v[132:135]
    v_fmac_f32 v31, v207, v163
    v_mul_f32 v232, v0, v0
    ds_read_b128 v[204:207], v191 offset:448
    v_mfma_f32_16x16x32_bf16 v[136:139], v[228:231], a[40:43], v[136:139]
    ds_read_b64_tr_b16 v[220:221], v182 offset:4096
    v_mul_f32 v233, v1, v1
    v_mfma_f32_16x16x32_bf16 v[140:143], v[228:231], a[44:47], v[140:143]
    s_waitcnt lgkmcnt(5)
    ds_read_b64_tr_b16 v[222:223], v182 offset:11264
    v_mul_f32 v234, v2, v2
    v_mfma_f32_16x16x32_bf16 v[148:151], v[208:211], v[144:147], v[148:151]
    v_mul_f32 v235, v3, v3
    v_fma_f32 v232, v232, v172, v168
    v_mfma_f32_16x16x32_bf16 v[112:115], v[208:211], a[48:51], v[112:115]
    ds_read_b64_tr_b16 v[224:225], v181 offset:5120
    v_fma_f32 v233, v233, v172, v168
    v_mfma_f32_16x16x32_bf16 v[116:119], v[208:211], a[52:55], v[116:119]
    buffer_load_dwordx4 v180, s[88:91], s7 offen offset:3072 lds
    v_fma_f32 v234, v234, v172, v168
    v_fma_f32 v235, v235, v172, v168
    v_mfma_f32_16x16x32_bf16 v[120:123], v[208:211], a[56:59], v[120:123]
    ds_read_b64_tr_b16 v[226:227], v181 offset:12288
    v_mul_f32 v232, v232, v0
    v_mul_f32 v233, v233, v1
    v_mfma_f32_16x16x32_bf16 v[124:127], v[208:211], a[60:63], v[124:127]
    v_mul_f32 v234, v234, v2
    v_mul_f32 v235, v235, v3
    v_mfma_f32_16x16x32_bf16 v[128:131], v[212:215], a[48:51], v[128:131]
    v_exp_f32 v232, v232
    v_mfma_f32_16x16x32_bf16 v[132:135], v[212:215], a[52:55], v[132:135]
    ds_read_b64_tr_b16 v[228:229], v182 offset:5120
    v_exp_f32 v233, v233
    v_mfma_f32_16x16x32_bf16 v[136:139], v[212:215], a[56:59], v[136:139]
    ds_read_b64_tr_b16 v[230:231], v182 offset:12288
    v_exp_f32 v234, v234
    v_mfma_f32_16x16x32_bf16 v[140:143], v[212:215], a[60:63], v[140:143]
    s_waitcnt lgkmcnt(4)
    v_exp_f32 v235, v235
    v_mfma_f32_16x16x32_bf16 v[148:151], v[216:219], v[144:147], v[148:151]
    s_add_u32 m0, s50, 4294942080
    s_nop 0
    buffer_load_dwordx4 v180, s[88:91], s8 offen offset:0 lds
    v_mul_f32 v4, v4, v0
    v_mfma_f32_16x16x32_bf16 v[112:115], v[216:219], a[64:67], v[112:115]
    ds_read_b64_tr_b16 v[208:209], v181 offset:6144
    v_mul_f32 v5, v5, v1
    v_mul_f32 v6, v6, v2
    v_mfma_f32_16x16x32_bf16 v[116:119], v[216:219], a[68:71], v[116:119]
    ds_read_b64_tr_b16 v[210:211], v181 offset:13312
    v_mul_f32 v7, v7, v3
    v_mfma_f32_16x16x32_bf16 v[120:123], v[216:219], a[72:75], v[120:123]
    v_fma_f32 v232, v232, v176, v176
    v_fma_f32 v233, v233, v176, v176
    v_mfma_f32_16x16x32_bf16 v[124:127], v[216:219], a[76:79], v[124:127]
    v_fma_f32 v234, v234, v176, v176
    v_add_u32 v181, 135168, v181
    v_mfma_f32_16x16x32_bf16 v[128:131], v[220:223], a[64:67], v[128:131]
    v_fma_f32 v235, v235, v176, v176
    v_rcp_f32 v232, v232
    v_mfma_f32_16x16x32_bf16 v[132:135], v[220:223], a[68:71], v[132:135]
    ds_read_b64_tr_b16 v[212:213], v182 offset:6144
    v_rcp_f32 v233, v233
    v_mfma_f32_16x16x32_bf16 v[136:139], v[220:223], a[72:75], v[136:139]
    buffer_load_dwordx4 v180, s[88:91], s9 offen offset:1024 lds
    v_rcp_f32 v234, v234
    v_mfma_f32_16x16x32_bf16 v[140:143], v[220:223], a[76:79], v[140:143]
    s_waitcnt lgkmcnt(3)
    ds_read_b64_tr_b16 v[214:215], v182 offset:13312
    v_rcp_f32 v235, v235
    v_mfma_f32_16x16x32_bf16 v[148:151], v[224:227], v[144:147], v[148:151]
    v_add_u32 v182, 135168, v182
    v_mul_f32 v232, v232, v4
    v_mfma_f32_16x16x32_bf16 v[112:115], v[224:227], a[80:83], v[112:115]
    ds_read_b64_tr_b16 v[216:217], v181 offset:0
    v_mul_f32 v233, v233, v5
    v_mfma_f32_16x16x32_bf16 v[116:119], v[224:227], a[84:87], v[116:119]
    ds_read_b64_tr_b16 v[218:219], v181 offset:7168
    v_mul_f32 v234, v234, v6
    v_mfma_f32_16x16x32_bf16 v[120:123], v[224:227], a[88:91], v[120:123]
    v_mul_f32 v235, v235, v7
    v_cvt_pk_bf16_f32 v0, v232, v233
    v_mfma_f32_16x16x32_bf16 v[124:127], v[224:227], a[92:95], v[124:127]
    v_cvt_pk_bf16_f32 v1, v234, v235
    v_mul_f32 v236, v8, v8
    v_mfma_f32_16x16x32_bf16 v[128:131], v[228:231], a[80:83], v[128:131]
    buffer_store_dwordx2 v[0:1], v189, s[20:23], s86 offen offset:0
    v_mul_f32 v237, v9, v9
    v_mfma_f32_16x16x32_bf16 v[132:135], v[228:231], a[84:87], v[132:135]
    buffer_load_dwordx4 v180, s[88:91], s10 offen offset:2048 lds
    v_mul_f32 v238, v10, v10
    v_mul_f32 v239, v11, v11
    v_mfma_f32_16x16x32_bf16 v[136:139], v[228:231], a[88:91], v[136:139]
    ds_read_b64_tr_b16 v[220:221], v182 offset:0
    v_fma_f32 v236, v236, v173, v169
    v_fma_f32 v237, v237, v173, v169
    v_mfma_f32_16x16x32_bf16 v[140:143], v[228:231], a[92:95], v[140:143]
    s_waitcnt lgkmcnt(3)
    ds_read_b64_tr_b16 v[222:223], v182 offset:7168
    v_fma_f32 v238, v238, v173, v169
    v_mfma_f32_16x16x32_bf16 v[148:151], v[208:211], v[144:147], v[148:151]
    v_fma_f32 v239, v239, v173, v169
    v_mul_f32 v236, v236, v8
    v_mfma_f32_16x16x32_bf16 v[112:115], v[208:211], a[96:99], v[112:115]
    ds_read_b64_tr_b16 v[224:225], v181 offset:1024
    v_mul_f32 v237, v237, v9
    v_mul_f32 v238, v238, v10
    v_mfma_f32_16x16x32_bf16 v[116:119], v[208:211], a[100:103], v[116:119]
    ds_read_b64_tr_b16 v[226:227], v181 offset:8192
    v_mul_f32 v239, v239, v11
    v_exp_f32 v236, v236
    v_mfma_f32_16x16x32_bf16 v[120:123], v[208:211], a[104:107], v[120:123]
    v_exp_f32 v237, v237
    v_mfma_f32_16x16x32_bf16 v[124:127], v[208:211], a[108:111], v[124:127]
    v_exp_f32 v238, v238
    v_mfma_f32_16x16x32_bf16 v[128:131], v[212:215], a[96:99], v[128:131]
    v_exp_f32 v239, v239
    v_mfma_f32_16x16x32_bf16 v[132:135], v[212:215], a[100:103], v[132:135]
    ds_read_b64_tr_b16 v[228:229], v182 offset:1024
    v_mul_f32 v12, v12, v8
    v_mfma_f32_16x16x32_bf16 v[136:139], v[212:215], a[104:107], v[136:139]
    ds_read_b64_tr_b16 v[230:231], v182 offset:8192
    v_mul_f32 v13, v13, v9
    v_mul_f32 v14, v14, v10
    v_mul_f32 v15, v15, v11
    v_mfma_f32_16x16x32_bf16 v[140:143], v[212:215], a[108:111], v[140:143]
    s_waitcnt lgkmcnt(4)
    v_fma_f32 v236, v236, v177, v177
    v_fma_f32 v237, v237, v177, v177
    v_mfma_f32_16x16x32_bf16 v[148:151], v[216:219], v[144:147], v[148:151]
    v_fma_f32 v238, v238, v177, v177
    v_fma_f32 v239, v239, v177, v177
    v_mfma_f32_16x16x32_bf16 v[112:115], v[216:219], a[112:115], v[112:115]
    ds_read_b64_tr_b16 v[208:209], v181 offset:2048
    v_rcp_f32 v236, v236
    v_mfma_f32_16x16x32_bf16 v[116:119], v[216:219], a[116:119], v[116:119]
    ds_read_b64_tr_b16 v[210:211], v181 offset:9216
    v_rcp_f32 v237, v237
    v_mfma_f32_16x16x32_bf16 v[120:123], v[216:219], a[120:123], v[120:123]
    s_waitcnt vmcnt(15)
    v_rcp_f32 v238, v238
    v_mfma_f32_16x16x32_bf16 v[124:127], v[216:219], a[124:127], v[124:127]
    s_barrier
    v_rcp_f32 v239, v239
    v_mfma_f32_16x16x32_bf16 v[128:131], v[220:223], a[112:115], v[128:131]
    s_mul_i32 s3, s27, 229376
    s_mul_i32 s34, s28, 14336
    s_add_u32 s3, s3, s34
    v_mfma_f32_16x16x32_bf16 v[132:135], v[220:223], a[116:119], v[132:135]
    s_mul_i32 s34, s24, 3584
    ds_read_b64_tr_b16 v[212:213], v182 offset:2048
    s_add_u32 s3, s3, s34
    v_lshlrev_b32 v247, 7, v255
    buffer_load_dword v247, v247, s[44:47], s3 offen
    v_mfma_f32_16x16x32_bf16 v[136:139], v[220:223], a[120:123], v[136:139]
    ds_read_b64_tr_b16 v[214:215], v182 offset:9216
    v_mul_f32 v236, v236, v12
    v_mul_f32 v237, v237, v13
    v_mfma_f32_16x16x32_bf16 v[140:143], v[220:223], a[124:127], v[140:143]
    s_waitcnt lgkmcnt(4)
    v_mul_f32 v238, v238, v14
    v_mul_f32 v239, v239, v15
    v_mfma_f32_16x16x32_bf16 v[148:151], v[224:227], v[144:147], v[148:151]
    v_cvt_pk_bf16_f32 v8, v236, v237
    v_cvt_pk_bf16_f32 v9, v238, v239
    v_mfma_f32_16x16x32_bf16 v[112:115], v[224:227], a[128:131], v[112:115]
    buffer_store_dwordx2 v[8:9], v189, s[20:23], s86 offen offset:1024
    v_mul_f32 v232, v16, v16
    v_mfma_f32_16x16x32_bf16 v[116:119], v[224:227], a[132:135], v[116:119]
    s_cmp_eq_u32 s25, 0
    ds_read_b64_tr_b16 v[216:217], v181 offset:3072
    v_mul_f32 v233, v17, v17
    v_mfma_f32_16x16x32_bf16 v[120:123], v[224:227], a[136:139], v[120:123]
    s_cselect_b32 s96, s12, s16
    ds_read_b64_tr_b16 v[218:219], v181 offset:10240
    v_mul_f32 v234, v18, v18
    v_mul_f32 v235, v19, v19
    v_mfma_f32_16x16x32_bf16 v[124:127], v[224:227], a[140:143], v[124:127]
    s_cselect_b32 s97, s13, s17
    v_fma_f32 v232, v232, v174, v170
    s_mov_b32 s98, 0x100000
    s_mov_b32 s99, 0x00020000
    s_lshr_b32 s92, s2, 3
    s_lshl_b32 s92, s92, 10
    s_lshl_b32 s3, s26, 19
    s_add_u32 s92, s92, s3
    s_add_u32 s92, s92, 0
    v_mfma_f32_16x16x32_bf16 v[128:131], v[228:231], a[128:131], v[128:131]
    v_fma_f32 v233, v233, v174, v170
    v_fma_f32 v234, v234, v174, v170
    v_mfma_f32_16x16x32_bf16 v[132:135], v[228:231], a[132:135], v[132:135]
    ds_read_b64_tr_b16 v[220:221], v182 offset:3072
    v_fma_f32 v235, v235, v174, v170
    v_mul_f32 v232, v232, v16
    v_mul_f32 v233, v233, v17
    v_mfma_f32_16x16x32_bf16 v[136:139], v[228:231], a[136:139], v[136:139]
    ds_read_b64_tr_b16 v[222:223], v182 offset:10240
    v_mul_f32 v234, v234, v18
    v_mul_f32 v235, v235, v19
    v_mfma_f32_16x16x32_bf16 v[140:143], v[228:231], a[140:143], v[140:143]
    s_waitcnt lgkmcnt(4)
    v_exp_f32 v232, v232
    v_mfma_f32_16x16x32_bf16 v[148:151], v[208:211], v[144:147], v[148:151]
    v_exp_f32 v233, v233
    v_mfma_f32_16x16x32_bf16 v[112:115], v[208:211], a[144:147], v[112:115]
    ds_read_b64_tr_b16 v[224:225], v181 offset:4096
    v_exp_f32 v234, v234
    v_mfma_f32_16x16x32_bf16 v[116:119], v[208:211], a[148:151], v[116:119]
    ds_read_b64_tr_b16 v[226:227], v181 offset:11264
    v_exp_f32 v235, v235
    v_mfma_f32_16x16x32_bf16 v[120:123], v[208:211], a[152:155], v[120:123]
    v_mul_f32 v20, v20, v16
    v_mul_f32 v21, v21, v17
    v_mfma_f32_16x16x32_bf16 v[124:127], v[208:211], a[156:159], v[124:127]
    v_mul_f32 v22, v22, v18
    v_mul_f32 v23, v23, v19
    v_mfma_f32_16x16x32_bf16 v[128:131], v[212:215], a[144:147], v[128:131]
    v_fma_f32 v232, v232, v178, v178
    v_fma_f32 v233, v233, v178, v178
    v_mfma_f32_16x16x32_bf16 v[132:135], v[212:215], a[148:151], v[132:135]
    ds_read_b64_tr_b16 v[228:229], v182 offset:4096
    v_fma_f32 v234, v234, v178, v178
    v_fma_f32 v235, v235, v178, v178
    v_mfma_f32_16x16x32_bf16 v[136:139], v[212:215], a[152:155], v[136:139]
    ds_read_b64_tr_b16 v[230:231], v182 offset:11264
    v_rcp_f32 v232, v232
    v_mfma_f32_16x16x32_bf16 v[140:143], v[212:215], a[156:159], v[140:143]
    s_waitcnt lgkmcnt(4)
    v_rcp_f32 v233, v233
    v_mfma_f32_16x16x32_bf16 v[148:151], v[216:219], v[144:147], v[148:151]
    v_rcp_f32 v234, v234
    v_mfma_f32_16x16x32_bf16 v[112:115], v[216:219], a[160:163], v[112:115]
    ds_read_b64_tr_b16 v[208:209], v181 offset:5120
    v_rcp_f32 v235, v235
    v_mfma_f32_16x16x32_bf16 v[116:119], v[216:219], a[164:167], v[116:119]
    ds_read_b64_tr_b16 v[210:211], v181 offset:12288
    v_mul_f32 v232, v232, v20
    v_mul_f32 v233, v233, v21
    v_mfma_f32_16x16x32_bf16 v[120:123], v[216:219], a[168:171], v[120:123]
    v_mul_f32 v234, v234, v22
    v_mul_f32 v235, v235, v23
    v_mfma_f32_16x16x32_bf16 v[124:127], v[216:219], a[172:175], v[124:127]
    v_cvt_pk_bf16_f32 v16, v232, v233
    v_cvt_pk_bf16_f32 v17, v234, v235
    v_mfma_f32_16x16x32_bf16 v[128:131], v[220:223], a[160:163], v[128:131]
    buffer_store_dwordx2 v[16:17], v189, s[20:23], s87 offen offset:0
    v_mul_f32 v236, v24, v24
    v_mfma_f32_16x16x32_bf16 v[132:135], v[220:223], a[164:167], v[132:135]
    ds_read_b64_tr_b16 v[212:213], v182 offset:5120
    v_mul_f32 v237, v25, v25
    v_mul_f32 v238, v26, v26
    v_mfma_f32_16x16x32_bf16 v[136:139], v[220:223], a[168:171], v[136:139]
    ds_read_b64_tr_b16 v[214:215], v182 offset:12288
    v_mul_f32 v239, v27, v27
    v_fma_f32 v236, v236, v175, v171
    v_fma_f32 v237, v237, v175, v171
    v_mfma_f32_16x16x32_bf16 v[140:143], v[220:223], a[172:175], v[140:143]
    s_waitcnt lgkmcnt(4)
    v_fma_f32 v238, v238, v175, v171
    v_fma_f32 v239, v239, v175, v171
    v_mfma_f32_16x16x32_bf16 v[148:151], v[224:227], v[144:147], v[148:151]
    v_mul_f32 v236, v236, v24
    v_mul_f32 v237, v237, v25
    v_mfma_f32_16x16x32_bf16 v[112:115], v[224:227], a[176:179], v[112:115]
    ds_read_b64_tr_b16 v[216:217], v181 offset:6144
    v_mul_f32 v238, v238, v26
    v_mfma_f32_16x16x32_bf16 v[116:119], v[224:227], a[180:183], v[116:119]
    ds_read_b64_tr_b16 v[218:219], v181 offset:13312
    v_mul_f32 v239, v239, v27
    v_exp_f32 v236, v236
    v_mfma_f32_16x16x32_bf16 v[120:123], v[224:227], a[184:187], v[120:123]
    v_exp_f32 v237, v237
    v_mfma_f32_16x16x32_bf16 v[124:127], v[224:227], a[188:191], v[124:127]
    v_add_u32 v181, 4294934208, v181
    v_mfma_f32_16x16x32_bf16 v[128:131], v[228:231], a[176:179], v[128:131]
    v_exp_f32 v238, v238
    v_mfma_f32_16x16x32_bf16 v[132:135], v[228:231], a[180:183], v[132:135]
    ds_read_b64_tr_b16 v[220:221], v182 offset:6144
    v_exp_f32 v239, v239
    v_mfma_f32_16x16x32_bf16 v[136:139], v[228:231], a[184:187], v[136:139]
    ds_read_b64_tr_b16 v[222:223], v182 offset:13312
    v_mul_f32 v28, v28, v24
    v_mul_f32 v29, v29, v25
    v_mul_f32 v30, v30, v26
    v_mfma_f32_16x16x32_bf16 v[140:143], v[228:231], a[188:191], v[140:143]
    s_waitcnt lgkmcnt(4)
    v_mul_f32 v31, v31, v27
    v_fma_f32 v236, v236, v179, v179
    v_mfma_f32_16x16x32_bf16 v[148:151], v[208:211], v[144:147], v[148:151]
    v_fma_f32 v237, v237, v179, v179
    v_add_u32 v182, 4294934208, v182
    v_mfma_f32_16x16x32_bf16 v[112:115], v[208:211], a[192:195], v[112:115]
    ds_read_b64_tr_b16 v[224:225], v181 offset:0
    v_fma_f32 v238, v238, v179, v179
    v_mfma_f32_16x16x32_bf16 v[116:119], v[208:211], a[196:199], v[116:119]
    ds_read_b64_tr_b16 v[226:227], v181 offset:7168
    v_fma_f32 v239, v239, v179, v179
    v_rcp_f32 v236, v236
    v_mfma_f32_16x16x32_bf16 v[120:123], v[208:211], a[200:203], v[120:123]
    v_rcp_f32 v237, v237
    v_mfma_f32_16x16x32_bf16 v[124:127], v[208:211], a[204:207], v[124:127]
    v_rcp_f32 v238, v238
    v_mfma_f32_16x16x32_bf16 v[128:131], v[212:215], a[192:195], v[128:131]
    v_rcp_f32 v239, v239
    v_mfma_f32_16x16x32_bf16 v[132:135], v[212:215], a[196:199], v[132:135]
    ds_read_b64_tr_b16 v[228:229], v182 offset:0
    v_mul_f32 v236, v236, v28
    v_mfma_f32_16x16x32_bf16 v[136:139], v[212:215], a[200:203], v[136:139]
    ds_read_b64_tr_b16 v[230:231], v182 offset:7168
    v_mul_f32 v237, v237, v29
    v_mul_f32 v238, v238, v30
    v_mul_f32 v239, v239, v31
    v_mfma_f32_16x16x32_bf16 v[140:143], v[212:215], a[204:207], v[140:143]
    s_waitcnt lgkmcnt(4)
    v_cvt_pk_bf16_f32 v24, v236, v237
    v_cvt_pk_bf16_f32 v25, v238, v239
    v_mfma_f32_16x16x32_bf16 v[148:151], v[216:219], v[144:147], v[148:151]
    s_lshl_b32 s3, s26, 2
    buffer_store_dwordx2 v[24:25], v189, s[20:23], s87 offen offset:1024
    s_add_u32 s3, s3, s53
    v_mfma_f32_16x16x32_bf16 v[112:115], v[216:219], a[208:211], v[112:115]
    s_add_u32 s3, s3, 1
    ds_read_b64_tr_b16 v[208:209], v181 offset:1024
    s_lshr_b32 s34, s3, 1
    s_lshl_b32 s34, s34, 12
    s_and_b32 s3, s3, 1
    s_lshl_b32 s3, s3, 3
    s_add_u32 s34, s34, s3
    s_add_u32 s86, s34, s54
    s_add_u32 s87, s34, s55
    v_mfma_f32_16x16x32_bf16 v[116:119], v[216:219], a[212:215], v[116:119]
    ds_read_b64_tr_b16 v[210:211], v181 offset:8192
    v_fmac_f32 v32, v200, v160
    v_fmac_f32 v33, v201, v160
    v_mfma_f32_16x16x32_bf16 v[120:123], v[216:219], a[216:219], v[120:123]
    v_fmac_f32 v34, v202, v160
    v_fmac_f32 v35, v203, v160
    v_mfma_f32_16x16x32_bf16 v[124:127], v[216:219], a[220:223], v[124:127]
    v_fmac_f32 v36, v204, v160
    v_fmac_f32 v37, v205, v160
    v_mfma_f32_16x16x32_bf16 v[128:131], v[220:223], a[208:211], v[128:131]
    ds_write_b128 v190, v[148:151] offset:256
    v_fmac_f32 v38, v206, v160
    v_fmac_f32 v39, v207, v160
    v_mfma_f32_16x16x32_bf16 v[132:135], v[220:223], a[212:215], v[132:135]
    ds_read_b64_tr_b16 v[212:213], v182 offset:1024
    v_fmac_f32 v40, v200, v161
    v_fmac_f32 v41, v201, v161
    v_mfma_f32_16x16x32_bf16 v[136:139], v[220:223], a[216:219], v[136:139]
    ds_read_b64_tr_b16 v[214:215], v182 offset:8192
    v_fmac_f32 v42, v202, v161
    v_fmac_f32 v43, v203, v161
    v_mfma_f32_16x16x32_bf16 v[140:143], v[220:223], a[220:223], v[140:143]
    s_waitcnt lgkmcnt(5)
    v_fmac_f32 v44, v204, v161
    v_fmac_f32 v45, v205, v161
    v_mfma_f32_16x16x32_bf16 v[152:155], v[224:227], v[144:147], 0
    v_fmac_f32 v46, v206, v161
    v_fmac_f32 v47, v207, v161
    v_mfma_f32_16x16x32_bf16 a[224:227], v[224:227], a[0:3], 0
    ds_read_b64_tr_b16 v[216:217], v181 offset:2048
    v_fmac_f32 v48, v200, v162
    v_mfma_f32_16x16x32_bf16 a[228:231], v[224:227], a[4:7], 0
    ds_read_b64_tr_b16 v[218:219], v181 offset:9216
    v_fmac_f32 v49, v201, v162
    v_fmac_f32 v50, v202, v162
    v_mfma_f32_16x16x32_bf16 a[232:235], v[224:227], a[8:11], 0
    s_waitcnt lgkmcnt(4)
    v_fmac_f32 v51, v203, v162
    v_fmac_f32 v52, v204, v162
    v_mfma_f32_16x16x32_bf16 a[236:239], v[224:227], a[12:15], 0
    s_waitcnt vmcnt(12)
    v_fmac_f32 v112, v148, v160
    v_fmac_f32 v53, v205, v162
    v_mfma_f32_16x16x32_bf16 a[240:243], v[228:231], a[0:3], 0
    s_barrier
    ds_read_b128 v[156:159], v246 offset:256
    v_fmac_f32 v54, v206, v162
    v_mfma_f32_16x16x32_bf16 a[244:247], v[228:231], a[4:7], 0
    s_add_u32 m0, s50, 68992
    s_nop 0
    buffer_load_dwordx4 v180, s[88:91], s11 offen offset:0 lds
    v_fmac_f32 v113, v149, v160
    v_mfma_f32_16x16x32_bf16 a[248:251], v[228:231], a[8:11], 0
    ds_read_b64_tr_b16 v[220:221], v182 offset:2048
    v_fmac_f32 v114, v150, v160
    v_mfma_f32_16x16x32_bf16 a[252:255], v[228:231], a[12:15], 0
    s_waitcnt lgkmcnt(4)
    ds_read_b64_tr_b16 v[222:223], v182 offset:9216
    v_fmac_f32 v115, v151, v160
    v_fmac_f32 v55, v207, v162
    v_mfma_f32_16x16x32_bf16 v[152:155], v[208:211], v[144:147], v[152:155]
    v_mul_f32 v112, v164, v112
    v_mul_f32 v113, v164, v113
    v_mfma_f32_16x16x32_bf16 a[224:227], v[208:211], a[16:19], a[224:227]
    ds_read_b64_tr_b16 v[224:225], v181 offset:3072
    v_fmac_f32 v56, v200, v163
    v_mfma_f32_16x16x32_bf16 a[228:231], v[208:211], a[20:23], a[228:231]
    buffer_load_dwordx4 v180, s[88:91], s80 offen offset:1024 lds
    v_mul_f32 v114, v164, v114
    v_mul_f32 v115, v164, v115
    v_mfma_f32_16x16x32_bf16 a[232:235], v[208:211], a[24:27], a[232:235]
    ds_read_b64_tr_b16 v[226:227], v181 offset:10240
    v_cvt_pk_bf16_f32 v112, v112, v113
    v_fmac_f32 v57, v201, v163
    v_mfma_f32_16x16x32_bf16 a[236:239], v[208:211], a[28:31], a[236:239]
    v_fmac_f32 v58, v202, v163
    v_cvt_pk_bf16_f32 v113, v114, v115
    ds_write_b64 v183, v[112:113] offset:0
    v_mfma_f32_16x16x32_bf16 a[240:243], v[212:215], a[16:19], a[240:243]
    v_fmac_f32 v116, v148, v161
    v_fmac_f32 v117, v149, v161
    v_mfma_f32_16x16x32_bf16 a[244:247], v[212:215], a[20:23], a[244:247]
    ds_read_b64_tr_b16 v[228:229], v182 offset:3072
    v_fmac_f32 v59, v203, v163
    v_mfma_f32_16x16x32_bf16 a[248:251], v[212:215], a[24:27], a[248:251]
    ds_read_b64_tr_b16 v[230:231], v182 offset:10240
    v_fmac_f32 v118, v150, v161
    v_fmac_f32 v119, v151, v161
    v_mfma_f32_16x16x32_bf16 a[252:255], v[212:215], a[28:31], a[252:255]
    s_waitcnt lgkmcnt(5)
    v_mul_f32 v116, v165, v116
    v_fmac_f32 v60, v204, v163
    v_mfma_f32_16x16x32_bf16 v[152:155], v[216:219], v[144:147], v[152:155]
    buffer_load_dwordx4 v180, s[88:91], s81 offen offset:2048 lds
    v_mul_f32 v117, v165, v117
    v_mfma_f32_16x16x32_bf16 a[224:227], v[216:219], a[32:35], a[224:227]
    ds_read_b64_tr_b16 v[208:209], v181 offset:4096
    v_mul_f32 v118, v165, v118
    v_fmac_f32 v61, v205, v163
    v_mfma_f32_16x16x32_bf16 a[228:231], v[216:219], a[36:39], a[228:231]
    ds_read_b64_tr_b16 v[210:211], v181 offset:11264
    v_mul_f32 v119, v165, v119
    v_fmac_f32 v62, v206, v163
    v_mfma_f32_16x16x32_bf16 a[232:235], v[216:219], a[40:43], a[232:235]
    v_cvt_pk_bf16_f32 v116, v116, v117
    v_cvt_pk_bf16_f32 v117, v118, v119
    v_mfma_f32_16x16x32_bf16 a[236:239], v[216:219], a[44:47], a[236:239]
    ds_write_b64 v183, v[116:117] offset:1024
    v_fmac_f32 v63, v207, v163
    v_mfma_f32_16x16x32_bf16 a[240:243], v[220:223], a[32:35], a[240:243]
    ds_read_b128 v[200:203], v191 offset:128
    v_fmac_f32 v120, v148, v162
    v_mfma_f32_16x16x32_bf16 a[244:247], v[220:223], a[36:39], a[244:247]
    ds_read_b128 v[204:207], v191 offset:512
    v_fmac_f32 v121, v149, v162
    v_fmac_f32 v122, v150, v162
    v_mfma_f32_16x16x32_bf16 a[248:251], v[220:223], a[40:43], a[248:251]
    ds_read_b64_tr_b16 v[212:213], v182 offset:4096
    v_fmac_f32 v123, v151, v162
    v_mul_f32 v120, v166, v120
    v_mfma_f32_16x16x32_bf16 a[252:255], v[220:223], a[44:47], a[252:255]
    s_waitcnt lgkmcnt(6)
    buffer_load_dwordx4 v180, s[88:91], s82 offen offset:3072 lds
    ds_read_b64_tr_b16 v[214:215], v182 offset:11264
    v_mul_f32 v121, v166, v121
    v_mfma_f32_16x16x32_bf16 v[152:155], v[224:227], v[144:147], v[152:155]
    v_mul_f32 v232, v32, v32
    v_mul_f32 v122, v166, v122
    v_mfma_f32_16x16x32_bf16 a[224:227], v[224:227], a[48:51], a[224:227]
    ds_read_b64_tr_b16 v[216:217], v181 offset:5120
    v_mul_f32 v123, v166, v123
    v_mfma_f32_16x16x32_bf16 a[228:231], v[224:227], a[52:55], a[228:231]
    v_cvt_pk_bf16_f32 v120, v120, v121
    v_mul_f32 v233, v33, v33
    v_mfma_f32_16x16x32_bf16 a[232:235], v[224:227], a[56:59], a[232:235]
    v_cvt_pk_bf16_f32 v121, v122, v123
    v_mul_f32 v234, v34, v34
    ds_write_b64 v184, v[120:121] offset:0
    ds_read_b64_tr_b16 v[218:219], v181 offset:12288
    v_mfma_f32_16x16x32_bf16 a[236:239], v[224:227], a[60:63], a[236:239]
    v_fmac_f32 v124, v148, v163
    v_fmac_f32 v125, v149, v163
    v_mfma_f32_16x16x32_bf16 a[240:243], v[228:231], a[48:51], a[240:243]
    s_add_u32 m0, s50, 73088
    s_nop 0
    buffer_load_dwordx4 v180, s[88:91], s83 offen offset:0 lds
    v_fmac_f32 v126, v150, v163
    v_mfma_f32_16x16x32_bf16 a[244:247], v[228:231], a[52:55], a[244:247]
    ds_read_b64_tr_b16 v[220:221], v182 offset:5120
    v_fmac_f32 v127, v151, v163
    v_mul_f32 v235, v35, v35
    v_mfma_f32_16x16x32_bf16 a[248:251], v[228:231], a[56:59], a[248:251]
    ds_read_b64_tr_b16 v[222:223], v182 offset:12288
    v_fma_f32 v232, v232, v172, v168
    v_mfma_f32_16x16x32_bf16 a[252:255], v[228:231], a[60:63], a[252:255]
    s_waitcnt lgkmcnt(5)
    v_mul_f32 v124, v167, v124
    v_mul_f32 v125, v167, v125
    v_mfma_f32_16x16x32_bf16 v[152:155], v[208:211], v[144:147], v[152:155]
    v_fma_f32 v233, v233, v172, v168
    v_mul_f32 v126, v167, v126
    v_mfma_f32_16x16x32_bf16 a[224:227], v[208:211], a[64:67], a[224:227]
    ds_read_b64_tr_b16 v[224:225], v181 offset:6144
    v_fma_f32 v234, v234, v172, v168
    v_mfma_f32_16x16x32_bf16 a[228:231], v[208:211], a[68:71], a[228:231]
    v_mul_f32 v127, v167, v127
    v_cvt_pk_bf16_f32 v124, v124, v125
    v_mfma_f32_16x16x32_bf16 a[232:235], v[208:211], a[72:75], a[232:235]
    buffer_load_dwordx4 v180, s[88:91], s84 offen offset:1024 lds
    v_cvt_pk_bf16_f32 v125, v126, v127
    v_fma_f32 v235, v235, v172, v168
    ds_write_b64 v184, v[124:125] offset:1024
    ds_read_b64_tr_b16 v[226:227], v181 offset:13312
    v_mfma_f32_16x16x32_bf16 a[236:239], v[208:211], a[76:79], a[236:239]
    v_add_u32 v181, 4294931392, v181
    v_mul_f32 v232, v232, v32
    v_mfma_f32_16x16x32_bf16 a[240:243], v[212:215], a[64:67], a[240:243]
    v_fmac_f32 v128, v156, v160
    v_fmac_f32 v129, v157, v160
    v_mfma_f32_16x16x32_bf16 a[244:247], v[212:215], a[68:71], a[244:247]
    ds_read_b64_tr_b16 v[228:229], v182 offset:6144
    v_fmac_f32 v130, v158, v160
    v_mfma_f32_16x16x32_bf16 a[248:251], v[212:215], a[72:75], a[248:251]
    ds_read_b64_tr_b16 v[230:231], v182 offset:13312
    v_fmac_f32 v131, v159, v160
    v_mul_f32 v233, v233, v33
    v_mfma_f32_16x16x32_bf16 a[252:255], v[212:215], a[76:79], a[252:255]
    s_waitcnt lgkmcnt(5)
    v_mul_f32 v128, v164, v128
    v_mul_f32 v234, v234, v34
    v_mfma_f32_16x16x32_bf16 v[152:155], v[216:219], v[144:147], v[152:155]
    v_mul_f32 v129, v164, v129
    v_add_u32 v182, 4294931392, v182
    v_mfma_f32_16x16x32_bf16 a[224:227], v[216:219], a[80:83], a[224:227]
    buffer_load_dwordx4 v180, s[88:91], s85 offen offset:2048 lds
    v_mul_f32 v235, v235, v35
    v_mfma_f32_16x16x32_bf16 a[228:231], v[216:219], a[84:87], a[228:231]
    ds_read_b64_tr_b16 v[208:209], v181 offset:0
    v_mul_f32 v130, v164, v130
    v_mul_f32 v131, v164, v131
    v_mfma_f32_16x16x32_bf16 a[232:235], v[216:219], a[88:91], a[232:235]
    ds_read_b64_tr_b16 v[210:211], v181 offset:7168
    v_exp_f32 v232, v232
    v_mfma_f32_16x16x32_bf16 a[236:239], v[216:219], a[92:95], a[236:239]
    v_cvt_pk_bf16_f32 v128, v128, v129
    v_cvt_pk_bf16_f32 v129, v130, v131
    ds_write_b64 v185, v[128:129] offset:0
    v_mfma_f32_16x16x32_bf16 a[240:243], v[220:223], a[80:83], a[240:243]
    v_fmac_f32 v132, v156, v161
    v_fmac_f32 v133, v157, v161
    v_mfma_f32_16x16x32_bf16 a[244:247], v[220:223], a[84:87], a[244:247]
    ds_read_b64_tr_b16 v[212:213], v182 offset:0
    v_exp_f32 v233, v233
    v_mfma_f32_16x16x32_bf16 a[248:251], v[220:223], a[88:91], a[248:251]
    ds_read_b64_tr_b16 v[214:215], v182 offset:7168
    v_fmac_f32 v134, v158, v161
    v_fmac_f32 v135, v159, v161
    v_mfma_f32_16x16x32_bf16 a[252:255], v[220:223], a[92:95], a[252:255]
    s_waitcnt lgkmcnt(5)
    v_mul_f32 v132, v165, v132
    v_mul_f32 v133, v165, v133
    v_mfma_f32_16x16x32_bf16 v[152:155], v[224:227], v[144:147], v[152:155]
    v_mul_f32 v134, v165, v134
    v_mfma_f32_16x16x32_bf16 a[224:227], v[224:227], a[96:99], a[224:227]
    ds_read_b64_tr_b16 v[216:217], v181 offset:1024
    v_exp_f32 v234, v234
    v_mfma_f32_16x16x32_bf16 a[228:231], v[224:227], a[100:103], a[228:231]
    v_mul_f32 v135, v165, v135
    v_cvt_pk_bf16_f32 v132, v132, v133
    v_mfma_f32_16x16x32_bf16 a[232:235], v[224:227], a[104:107], a[232:235]
    v_cvt_pk_bf16_f32 v133, v134, v135
    ds_write_b64 v185, v[132:133] offset:1024
    ds_read_b64_tr_b16 v[218:219], v181 offset:8192
    v_mfma_f32_16x16x32_bf16 a[236:239], v[224:227], a[108:111], a[236:239]
    v_exp_f32 v235, v235
    v_mfma_f32_16x16x32_bf16 a[240:243], v[228:231], a[96:99], a[240:243]
    v_fmac_f32 v136, v156, v162
    v_fmac_f32 v137, v157, v162
    v_mfma_f32_16x16x32_bf16 a[244:247], v[228:231], a[100:103], a[244:247]
    ds_read_b64_tr_b16 v[220:221], v182 offset:1024
    v_fmac_f32 v138, v158, v162
    v_fmac_f32 v139, v159, v162
    v_mfma_f32_16x16x32_bf16 a[248:251], v[228:231], a[104:107], a[248:251]
    ds_read_b64_tr_b16 v[222:223], v182 offset:8192
    v_mul_f32 v136, v166, v136
    v_mul_f32 v137, v166, v137
    v_mfma_f32_16x16x32_bf16 a[252:255], v[228:231], a[108:111], a[252:255]
    s_waitcnt lgkmcnt(5)
    v_mul_f32 v138, v166, v138
    v_mul_f32 v36, v36, v32
    v_mfma_f32_16x16x32_bf16 v[152:155], v[208:211], v[144:147], v[152:155]
    v_mul_f32 v139, v166, v139
    v_cvt_pk_bf16_f32 v136, v136, v137
    v_mfma_f32_16x16x32_bf16 a[224:227], v[208:211], a[112:115], a[224:227]
    v_mul_f32 v37, v37, v33
    v_cvt_pk_bf16_f32 v137, v138, v139
    ds_write_b64 v186, v[136:137] offset:0
    v_mfma_f32_16x16x32_bf16 a[228:231], v[208:211], a[116:119], a[228:231]
    ds_read_b64_tr_b16 v[224:225], v181 offset:2048
    v_mul_f32 v38, v38, v34
    v_mfma_f32_16x16x32_bf16 a[232:235], v[208:211], a[120:123], a[232:235]
    ds_read_b64_tr_b16 v[226:227], v181 offset:9216
    v_fmac_f32 v140, v156, v163
    v_mfma_f32_16x16x32_bf16 a[236:239], v[208:211], a[124:127], a[236:239]
    s_waitcnt vmcnt(11)
    v_fmac_f32 v141, v157, v163
    v_mul_f32 v39, v39, v35
    v_mfma_f32_16x16x32_bf16 a[240:243], v[212:215], a[112:115], a[240:243]
    s_barrier
    v_fma_f32 v232, v232, v176, v176
    s_add_u32 m0, s50, 35904
    v_mfma_f32_16x16x32_bf16 a[244:247], v[212:215], a[116:119], a[244:247]
    ds_read_b64_tr_b16 v[228:229], v182 offset:2048
    v_add_u32 v180, 128, v180
    buffer_load_dwordx4 v180, s[88:91], s4 offen offset:0 lds
    v_mfma_f32_16x16x32_bf16 a[248:251], v[212:215], a[120:123], a[248:251]
    ds_read_b64_tr_b16 v[230:231], v182 offset:9216
    v_fmac_f32 v142, v158, v163
    v_fmac_f32 v143, v159, v163
    v_mfma_f32_16x16x32_bf16 a[252:255], v[212:215], a[124:127], a[252:255]
    s_waitcnt lgkmcnt(5)
    v_mul_f32 v140, v167, v140
    v_fma_f32 v233, v233, v176, v176
    v_mfma_f32_16x16x32_bf16 v[152:155], v[216:219], v[144:147], v[152:155]
    v_mul_f32 v141, v167, v141
    v_fma_f32 v234, v234, v176, v176
    v_mfma_f32_16x16x32_bf16 a[224:227], v[216:219], a[128:131], a[224:227]
    ds_read_b64_tr_b16 v[208:209], v181 offset:3072
    v_mul_f32 v142, v167, v142
    v_mfma_f32_16x16x32_bf16 a[228:231], v[216:219], a[132:135], a[228:231]
    buffer_load_dwordx4 v180, s[88:91], s5 offen offset:1024 lds
    v_mul_f32 v143, v167, v143
    v_cvt_pk_bf16_f32 v140, v140, v141
    v_fma_f32 v235, v235, v176, v176
    v_mfma_f32_16x16x32_bf16 a[232:235], v[216:219], a[136:139], a[232:235]
    ds_read_b64_tr_b16 v[210:211], v181 offset:10240
    v_cvt_pk_bf16_f32 v141, v142, v143
    v_mfma_f32_16x16x32_bf16 a[236:239], v[216:219], a[140:143], a[236:239]
    ds_write_b64 v186, v[140:141] offset:1024
    v_rcp_f32 v232, v232
    v_mfma_f32_16x16x32_bf16 a[240:243], v[220:223], a[128:131], a[240:243]
    v_rcp_f32 v233, v233
    v_mfma_f32_16x16x32_bf16 a[244:247], v[220:223], a[132:135], a[244:247]
    ds_read_b64_tr_b16 v[212:213], v182 offset:3072
    v_rcp_f32 v234, v234
    v_mfma_f32_16x16x32_bf16 a[248:251], v[220:223], a[136:139], a[248:251]
    ds_read_b64_tr_b16 v[214:215], v182 offset:10240
    v_rcp_f32 v235, v235
    v_mfma_f32_16x16x32_bf16 a[252:255], v[220:223], a[140:143], a[252:255]
    s_waitcnt lgkmcnt(5)
    v_mul_f32 v232, v232, v36
    v_mul_f32 v233, v233, v37
    v_mfma_f32_16x16x32_bf16 v[152:155], v[224:227], v[144:147], v[152:155]
    buffer_load_dwordx4 v180, s[88:91], s6 offen offset:2048 lds
    v_mul_f32 v234, v234, v38
    v_mfma_f32_16x16x32_bf16 a[224:227], v[224:227], a[144:147], a[224:227]
    ds_read_b64_tr_b16 v[216:217], v181 offset:4096
    v_mul_f32 v235, v235, v39
    v_mfma_f32_16x16x32_bf16 a[228:231], v[224:227], a[148:151], a[228:231]
    ds_read_b64_tr_b16 v[218:219], v181 offset:11264
    v_cvt_pk_bf16_f32 v32, v232, v233
    v_cvt_pk_bf16_f32 v33, v234, v235
    v_mfma_f32_16x16x32_bf16 a[232:235], v[224:227], a[152:155], a[232:235]
    buffer_store_dwordx2 v[32:33], v189, s[20:23], s86 offen offset:0
    v_mul_f32 v236, v40, v40
    v_mfma_f32_16x16x32_bf16 a[236:239], v[224:227], a[156:159], a[236:239]
    v_mul_f32 v237, v41, v41
    v_mul_f32 v238, v42, v42
    v_mfma_f32_16x16x32_bf16 a[240:243], v[228:231], a[144:147], a[240:243]
    v_mul_f32 v239, v43, v43
    v_fma_f32 v236, v236, v173, v169
    v_mfma_f32_16x16x32_bf16 a[244:247], v[228:231], a[148:151], a[244:247]
    ds_read_b64_tr_b16 v[220:221], v182 offset:4096
    v_fma_f32 v237, v237, v173, v169
    v_fma_f32 v238, v238, v173, v169
    v_mfma_f32_16x16x32_bf16 a[248:251], v[228:231], a[152:155], a[248:251]
    buffer_load_dwordx4 v180, s[88:91], s7 offen offset:3072 lds
    v_fma_f32 v239, v239, v173, v169
    v_mul_f32 v236, v236, v40
    v_mul_f32 v237, v237, v41
    v_mfma_f32_16x16x32_bf16 a[252:255], v[228:231], a[156:159], a[252:255]
    s_waitcnt lgkmcnt(3)
    ds_read_b64_tr_b16 v[222:223], v182 offset:11264
    v_mul_f32 v238, v238, v42
    v_mfma_f32_16x16x32_bf16 v[152:155], v[208:211], v[144:147], v[152:155]
    v_mul_f32 v239, v239, v43
    v_mfma_f32_16x16x32_bf16 a[224:227], v[208:211], a[160:163], a[224:227]
    ds_read_b64_tr_b16 v[224:225], v181 offset:5120
    v_exp_f32 v236, v236
    v_mfma_f32_16x16x32_bf16 a[228:231], v[208:211], a[164:167], a[228:231]
    ds_read_b64_tr_b16 v[226:227], v181 offset:12288
    v_exp_f32 v237, v237
    v_mfma_f32_16x16x32_bf16 a[232:235], v[208:211], a[168:171], a[232:235]
    v_exp_f32 v238, v238
    v_mfma_f32_16x16x32_bf16 a[236:239], v[208:211], a[172:175], a[236:239]
    v_exp_f32 v239, v239
    v_mfma_f32_16x16x32_bf16 a[240:243], v[212:215], a[160:163], a[240:243]
    s_add_u32 m0, s50, 40000
    s_nop 0
    buffer_load_dwordx4 v180, s[88:91], s8 offen offset:0 lds
    v_mul_f32 v44, v44, v40
    v_mul_f32 v45, v45, v41
    v_mfma_f32_16x16x32_bf16 a[244:247], v[212:215], a[164:167], a[244:247]
    ds_read_b64_tr_b16 v[228:229], v182 offset:5120
    v_mul_f32 v46, v46, v42
    v_mul_f32 v47, v47, v43
    v_mfma_f32_16x16x32_bf16 a[248:251], v[212:215], a[168:171], a[248:251]
    ds_read_b64_tr_b16 v[230:231], v182 offset:12288
    v_fma_f32 v236, v236, v177, v177
    v_mfma_f32_16x16x32_bf16 a[252:255], v[212:215], a[172:175], a[252:255]
    s_waitcnt lgkmcnt(4)
    v_fma_f32 v237, v237, v177, v177
    v_fma_f32 v238, v238, v177, v177
    v_mfma_f32_16x16x32_bf16 v[152:155], v[216:219], v[144:147], v[152:155]
    v_fma_f32 v239, v239, v177, v177
    v_mfma_f32_16x16x32_bf16 a[224:227], v[216:219], a[176:179], a[224:227]
    ds_read_b64_tr_b16 v[208:209], v181 offset:6144
    v_rcp_f32 v236, v236
    v_mfma_f32_16x16x32_bf16 a[228:231], v[216:219], a[180:183], a[228:231]
    ds_read_b64_tr_b16 v[210:211], v181 offset:13312
    v_rcp_f32 v237, v237
    v_mfma_f32_16x16x32_bf16 a[232:235], v[216:219], a[184:187], a[232:235]
    buffer_load_dwordx4 v180, s[88:91], s9 offen offset:1024 lds
    v_rcp_f32 v238, v238
    v_mfma_f32_16x16x32_bf16 a[236:239], v[216:219], a[188:191], a[236:239]
    v_rcp_f32 v239, v239
    v_mfma_f32_16x16x32_bf16 a[240:243], v[220:223], a[176:179], a[240:243]
    v_add_u32 v181, 4294937984, v181
    v_mul_f32 v236, v236, v44
    v_mfma_f32_16x16x32_bf16 a[244:247], v[220:223], a[180:183], a[244:247]
    ds_read_b64_tr_b16 v[212:213], v182 offset:6144
    v_mul_f32 v237, v237, v45
    v_mul_f32 v238, v238, v46
    v_mfma_f32_16x16x32_bf16 a[248:251], v[220:223], a[184:187], a[248:251]
    ds_read_b64_tr_b16 v[214:215], v182 offset:13312
    v_mul_f32 v239, v239, v47
    v_cvt_pk_bf16_f32 v40, v236, v237
    v_mfma_f32_16x16x32_bf16 a[252:255], v[220:223], a[188:191], a[252:255]
    s_waitcnt lgkmcnt(4)
    v_cvt_pk_bf16_f32 v41, v238, v239
    v_mul_f32 v232, v48, v48
    buffer_store_dwordx2 v[40:41], v189, s[20:23], s86 offen offset:1024
    v_mfma_f32_16x16x32_bf16 v[152:155], v[224:227], v[144:147], v[152:155]
    v_add_u32 v182, 4294937984, v182
    v_mul_f32 v233, v49, v49
    v_mfma_f32_16x16x32_bf16 a[224:227], v[224:227], a[192:195], a[224:227]
    buffer_load_dwordx4 v180, s[88:91], s10 offen offset:2048 lds
    v_mul_f32 v234, v50, v50
    v_mfma_f32_16x16x32_bf16 a[228:231], v[224:227], a[196:199], a[228:231]
    ds_read_b64_tr_b16 v[216:217], v181 offset:0
    v_mul_f32 v235, v51, v51
    v_fma_f32 v232, v232, v174, v170
    v_mfma_f32_16x16x32_bf16 a[232:235], v[224:227], a[200:203], a[232:235]
    ds_read_b64_tr_b16 v[218:219], v181 offset:7168
    v_fma_f32 v233, v233, v174, v170
    v_mfma_f32_16x16x32_bf16 a[236:239], v[224:227], a[204:207], a[236:239]
    v_fma_f32 v234, v234, v174, v170
    v_fma_f32 v235, v235, v174, v170
    v_mfma_f32_16x16x32_bf16 a[240:243], v[228:231], a[192:195], a[240:243]
    v_mul_f32 v232, v232, v48
    v_mul_f32 v233, v233, v49
    v_mfma_f32_16x16x32_bf16 a[244:247], v[228:231], a[196:199], a[244:247]
    ds_read_b64_tr_b16 v[220:221], v182 offset:0
    v_mul_f32 v234, v234, v50
    v_mul_f32 v235, v235, v51
    v_mfma_f32_16x16x32_bf16 a[248:251], v[228:231], a[200:203], a[248:251]
    ds_read_b64_tr_b16 v[222:223], v182 offset:7168
    v_exp_f32 v232, v232
    v_mfma_f32_16x16x32_bf16 a[252:255], v[228:231], a[204:207], a[252:255]
    s_waitcnt lgkmcnt(4)
    v_exp_f32 v233, v233
    v_mfma_f32_16x16x32_bf16 v[152:155], v[208:211], v[144:147], v[152:155]
    v_exp_f32 v234, v234
    v_mfma_f32_16x16x32_bf16 a[224:227], v[208:211], a[208:211], a[224:227]
    ds_read_b64_tr_b16 v[224:225], v181 offset:1024
    v_exp_f32 v235, v235
    v_mfma_f32_16x16x32_bf16 a[228:231], v[208:211], a[212:215], a[228:231]
    ds_read_b64_tr_b16 v[226:227], v181 offset:8192
    v_mul_f32 v52, v52, v48
    v_mul_f32 v53, v53, v49
    v_mfma_f32_16x16x32_bf16 a[232:235], v[208:211], a[216:219], a[232:235]
    v_mul_f32 v54, v54, v50
    v_mul_f32 v55, v55, v51
    v_mfma_f32_16x16x32_bf16 a[236:239], v[208:211], a[220:223], a[236:239]
    v_fma_f32 v232, v232, v178, v178
    v_fma_f32 v233, v233, v178, v178
    v_mfma_f32_16x16x32_bf16 a[240:243], v[212:215], a[208:211], a[240:243]
    ds_write_b128 v190, v[152:155] offset:320
    v_fma_f32 v234, v234, v178, v178
    v_mfma_f32_16x16x32_bf16 a[244:247], v[212:215], a[212:215], a[244:247]
    ds_read_b64_tr_b16 v[228:229], v182 offset:1024
    v_fma_f32 v235, v235, v178, v178
    v_rcp_f32 v232, v232
    v_mfma_f32_16x16x32_bf16 a[248:251], v[212:215], a[216:219], a[248:251]
    ds_read_b64_tr_b16 v[230:231], v182 offset:8192
    v_rcp_f32 v233, v233
    v_mfma_f32_16x16x32_bf16 a[252:255], v[212:215], a[220:223], a[252:255]
    s_waitcnt lgkmcnt(5)
    v_rcp_f32 v234, v234
    v_mfma_f32_16x16x32_bf16 v[148:151], v[216:219], v[144:147], 0
    v_rcp_f32 v235, v235
    v_mfma_f32_16x16x32_bf16 v[112:115], v[216:219], a[0:3], 0
    ds_read_b64_tr_b16 v[208:209], v181 offset:2048
    v_mul_f32 v232, v232, v52
    v_mfma_f32_16x16x32_bf16 v[116:119], v[216:219], a[4:7], 0
    ds_read_b64_tr_b16 v[210:211], v181 offset:9216
    v_mul_f32 v233, v233, v53
    v_mul_f32 v234, v234, v54
    v_mfma_f32_16x16x32_bf16 v[120:123], v[216:219], a[8:11], 0
    s_waitcnt lgkmcnt(4)
    v_mul_f32 v235, v235, v55
    v_accvgpr_read_b32 v240, a224
    v_mfma_f32_16x16x32_bf16 v[124:127], v[216:219], a[12:15], 0
    s_waitcnt vmcnt(9)
    v_cvt_pk_bf16_f32 v48, v232, v233
    v_cvt_pk_bf16_f32 v49, v234, v235
    v_mfma_f32_16x16x32_bf16 v[128:131], v[220:223], a[0:3], 0
    s_barrier
    ds_read_b128 v[156:159], v246 offset:320
    s_add_u32 m0, s50, 0
    v_mfma_f32_16x16x32_bf16 v[132:135], v[220:223], a[4:7], 0
    buffer_load_dwordx4 v180, s[88:91], s11 offen offset:0 lds
    v_accvgpr_read_b32 v241, a225
    v_mfma_f32_16x16x32_bf16 v[136:139], v[220:223], a[8:11], 0
    buffer_store_dwordx2 v[48:49], v189, s[20:23], s87 offen offset:0
    ds_read_b64_tr_b16 v[212:213], v182 offset:2048
    v_accvgpr_read_b32 v242, a226
    v_mfma_f32_16x16x32_bf16 v[140:143], v[220:223], a[12:15], 0
    s_waitcnt lgkmcnt(4)
    ds_read_b64_tr_b16 v[214:215], v182 offset:9216
    v_accvgpr_read_b32 v243, a227
    v_mfma_f32_16x16x32_bf16 v[148:151], v[224:227], v[144:147], v[148:151]
    v_fmac_f32 v240, v152, v160
    v_mul_f32 v236, v56, v56
    v_mfma_f32_16x16x32_bf16 v[112:115], v[224:227], a[16:19], v[112:115]
    ds_read_b64_tr_b16 v[216:217], v181 offset:3072
    v_fmac_f32 v241, v153, v160
    v_mfma_f32_16x16x32_bf16 v[116:119], v[224:227], a[20:23], v[116:119]
    buffer_load_dwordx4 v180, s[88:91], s80 offen offset:1024 lds
    v_fmac_f32 v242, v154, v160
    v_fmac_f32 v243, v155, v160
    v_mul_f32 v237, v57, v57
    v_mfma_f32_16x16x32_bf16 v[120:123], v[224:227], a[24:27], v[120:123]
    ds_read_b64_tr_b16 v[218:219], v181 offset:10240
    v_mul_f32 v240, v164, v240
    v_mul_f32 v238, v58, v58
    v_mfma_f32_16x16x32_bf16 v[124:127], v[224:227], a[28:31], v[124:127]
    v_mul_f32 v241, v164, v241
    v_mul_f32 v242, v164, v242
    v_mfma_f32_16x16x32_bf16 v[128:131], v[228:231], a[16:19], v[128:131]
    v_mul_f32 v239, v59, v59
    v_mul_f32 v243, v164, v243
    v_mfma_f32_16x16x32_bf16 v[132:135], v[228:231], a[20:23], v[132:135]
    v_cvt_pk_bf16_f32 v244, v240, v241
    v_cvt_pk_bf16_f32 v245, v242, v243
    ds_write_b64 v183, v[244:245] offset:16384
    v_mfma_f32_16x16x32_bf16 v[136:139], v[228:231], a[24:27], v[136:139]
    ds_read_b64_tr_b16 v[220:221], v182 offset:3072
    v_fma_f32 v236, v236, v175, v171
    v_mfma_f32_16x16x32_bf16 v[140:143], v[228:231], a[28:31], v[140:143]
    s_waitcnt lgkmcnt(4)
    ds_read_b64_tr_b16 v[222:223], v182 offset:10240
    v_accvgpr_read_b32 v240, a228
    v_mfma_f32_16x16x32_bf16 v[148:151], v[208:211], v[144:147], v[148:151]
    buffer_load_dwordx4 v180, s[88:91], s81 offen offset:2048 lds
    v_accvgpr_read_b32 v241, a229
    v_fma_f32 v237, v237, v175, v171
    v_mfma_f32_16x16x32_bf16 v[112:115], v[208:211], a[32:35], v[112:115]
    ds_read_b64_tr_b16 v[224:225], v181 offset:4096
    v_accvgpr_read_b32 v242, a230
    v_fma_f32 v238, v238, v175, v171
    v_mfma_f32_16x16x32_bf16 v[116:119], v[208:211], a[36:39], v[116:119]
    ds_read_b64_tr_b16 v[226:227], v181 offset:11264
    v_accvgpr_read_b32 v243, a231
    v_mfma_f32_16x16x32_bf16 v[120:123], v[208:211], a[40:43], v[120:123]
    v_fmac_f32 v240, v152, v161
    v_fma_f32 v239, v239, v175, v171
    v_mfma_f32_16x16x32_bf16 v[124:127], v[208:211], a[44:47], v[124:127]
    v_fmac_f32 v241, v153, v161
    v_fmac_f32 v242, v154, v161
    v_mfma_f32_16x16x32_bf16 v[128:131], v[212:215], a[32:35], v[128:131]
    v_fmac_f32 v243, v155, v161
    v_mul_f32 v236, v236, v56
    v_mfma_f32_16x16x32_bf16 v[132:135], v[212:215], a[36:39], v[132:135]
    ds_read_b64_tr_b16 v[228:229], v182 offset:4096
    v_mul_f32 v240, v165, v240
    v_mul_f32 v241, v165, v241
    v_mfma_f32_16x16x32_bf16 v[136:139], v[212:215], a[40:43], v[136:139]
    buffer_load_dwordx4 v180, s[88:91], s82 offen offset:3072 lds
    v_mul_f32 v242, v165, v242
    v_mul_f32 v243, v165, v243
    v_mul_f32 v237, v237, v57
    v_mfma_f32_16x16x32_bf16 v[140:143], v[212:215], a[44:47], v[140:143]
    s_waitcnt lgkmcnt(3)
    ds_read_b64_tr_b16 v[230:231], v182 offset:11264
    v_cvt_pk_bf16_f32 v244, v240, v241
    v_mul_f32 v238, v238, v58
    v_mfma_f32_16x16x32_bf16 v[148:151], v[216:219], v[144:147], v[148:151]
    v_cvt_pk_bf16_f32 v245, v242, v243
    v_mul_f32 v239, v239, v59
    v_mfma_f32_16x16x32_bf16 v[112:115], v[216:219], a[48:51], v[112:115]
    ds_write_b64 v183, v[244:245] offset:17408
    v_accvgpr_read_b32 v240, a232
    v_mfma_f32_16x16x32_bf16 v[116:119], v[216:219], a[52:55], v[116:119]
    ds_read_b64_tr_b16 v[208:209], v181 offset:5120
    v_accvgpr_read_b32 v241, a233
    v_mfma_f32_16x16x32_bf16 v[120:123], v[216:219], a[56:59], v[120:123]
    ds_read_b64_tr_b16 v[210:211], v181 offset:12288
    v_exp_f32 v236, v236
    v_mfma_f32_16x16x32_bf16 v[124:127], v[216:219], a[60:63], v[124:127]
    v_accvgpr_read_b32 v242, a234
    v_accvgpr_read_b32 v243, a235
    v_mfma_f32_16x16x32_bf16 v[128:131], v[220:223], a[48:51], v[128:131]
    s_add_u32 m0, s50, 4096
    s_nop 0
    buffer_load_dwordx4 v180, s[88:91], s83 offen offset:0 lds
    v_fmac_f32 v240, v152, v162
    v_mfma_f32_16x16x32_bf16 v[132:135], v[220:223], a[52:55], v[132:135]
    ds_read_b64_tr_b16 v[212:213], v182 offset:5120
    v_fmac_f32 v241, v153, v162
    v_fmac_f32 v242, v154, v162
    v_exp_f32 v237, v237
    v_mfma_f32_16x16x32_bf16 v[136:139], v[220:223], a[56:59], v[136:139]
    ds_read_b64_tr_b16 v[214:215], v182 offset:12288
    v_fmac_f32 v243, v155, v162
    v_mfma_f32_16x16x32_bf16 v[140:143], v[220:223], a[60:63], v[140:143]
    s_waitcnt lgkmcnt(5)
    v_mul_f32 v240, v166, v240
    v_mfma_f32_16x16x32_bf16 v[148:151], v[224:227], v[144:147], v[148:151]
    v_exp_f32 v238, v238
    v_mfma_f32_16x16x32_bf16 v[112:115], v[224:227], a[64:67], v[112:115]
    ds_read_b64_tr_b16 v[216:217], v181 offset:6144
    v_mul_f32 v241, v166, v241
    v_mfma_f32_16x16x32_bf16 v[116:119], v[224:227], a[68:71], v[116:119]
    ds_read_b64_tr_b16 v[218:219], v181 offset:13312
    v_mul_f32 v242, v166, v242
    v_mul_f32 v243, v166, v243
    v_mfma_f32_16x16x32_bf16 v[120:123], v[224:227], a[72:75], v[120:123]
    buffer_load_dwordx4 v180, s[88:91], s84 offen offset:1024 lds
    v_cvt_pk_bf16_f32 v244, v240, v241
    v_mfma_f32_16x16x32_bf16 v[124:127], v[224:227], a[76:79], v[124:127]
    v_cvt_pk_bf16_f32 v245, v242, v243
    v_exp_f32 v239, v239
    v_mfma_f32_16x16x32_bf16 v[128:131], v[228:231], a[64:67], v[128:131]
    ds_write_b64 v184, v[244:245] offset:16384
    v_add_u32 v181, 98304, v181
    v_mfma_f32_16x16x32_bf16 v[132:135], v[228:231], a[68:71], v[132:135]
    ds_read_b64_tr_b16 v[220:221], v182 offset:6144
    v_accvgpr_read_b32 v240, a236
    v_mfma_f32_16x16x32_bf16 v[136:139], v[228:231], a[72:75], v[136:139]
    ds_read_b64_tr_b16 v[222:223], v182 offset:13312
    v_accvgpr_read_b32 v241, a237
    v_accvgpr_read_b32 v242, a238
    v_mul_f32 v60, v60, v56
    v_mfma_f32_16x16x32_bf16 v[140:143], v[228:231], a[76:79], v[140:143]
    s_waitcnt lgkmcnt(5)
    v_accvgpr_read_b32 v243, a239
    v_fmac_f32 v240, v152, v163
    v_mfma_f32_16x16x32_bf16 v[148:151], v[208:211], v[144:147], v[148:151]
    v_mul_f32 v61, v61, v57
    v_add_u32 v182, 98304, v182
    v_mfma_f32_16x16x32_bf16 v[112:115], v[208:211], a[80:83], v[112:115]
    buffer_load_dwordx4 v180, s[88:91], s85 offen offset:2048 lds
    v_fmac_f32 v241, v153, v163
    v_mfma_f32_16x16x32_bf16 v[116:119], v[208:211], a[84:87], v[116:119]
    ds_read_b64_tr_b16 v[224:225], v181 offset:0
    v_fmac_f32 v242, v154, v163
    v_mul_f32 v62, v62, v58
    v_mfma_f32_16x16x32_bf16 v[120:123], v[208:211], a[88:91], v[120:123]
    ds_read_b64_tr_b16 v[226:227], v181 offset:7168
    v_fmac_f32 v243, v155, v163
    v_mfma_f32_16x16x32_bf16 v[124:127], v[208:211], a[92:95], v[124:127]
    v_mul_f32 v63, v63, v59
    v_mul_f32 v240, v167, v240
    v_mfma_f32_16x16x32_bf16 v[128:131], v[212:215], a[80:83], v[128:131]
    v_mul_f32 v241, v167, v241
    v_fma_f32 v236, v236, v179, v179
    v_mfma_f32_16x16x32_bf16 v[132:135], v[212:215], a[84:87], v[132:135]
    v_mul_f32 v242, v167, v242
    v_mul_f32 v243, v167, v243
    v_mfma_f32_16x16x32_bf16 v[136:139], v[212:215], a[88:91], v[136:139]
    v_cvt_pk_bf16_f32 v244, v240, v241
    v_cvt_pk_bf16_f32 v245, v242, v243
    v_fma_f32 v237, v237, v179, v179
    ds_write_b64 v184, v[244:245] offset:17408
    ds_read_b64_tr_b16 v[228:229], v182 offset:0
    v_mfma_f32_16x16x32_bf16 v[140:143], v[212:215], a[92:95], v[140:143]
    s_waitcnt lgkmcnt(4)
    ds_read_b64_tr_b16 v[230:231], v182 offset:7168
    v_accvgpr_read_b32 v240, a240
    v_mfma_f32_16x16x32_bf16 v[148:151], v[216:219], v[144:147], v[148:151]
    v_fma_f32 v238, v238, v179, v179
    v_accvgpr_read_b32 v241, a241
    v_mfma_f32_16x16x32_bf16 v[112:115], v[216:219], a[96:99], v[112:115]
    ds_read_b64_tr_b16 v[208:209], v181 offset:1024
    v_accvgpr_read_b32 v242, a242
    v_mfma_f32_16x16x32_bf16 v[116:119], v[216:219], a[100:103], v[116:119]
    ds_read_b64_tr_b16 v[210:211], v181 offset:8192
    v_accvgpr_read_b32 v243, a243
    v_fma_f32 v239, v239, v179, v179
    v_mfma_f32_16x16x32_bf16 v[120:123], v[216:219], a[104:107], v[120:123]
    v_fmac_f32 v240, v156, v160
    v_rcp_f32 v236, v236
    v_mfma_f32_16x16x32_bf16 v[124:127], v[216:219], a[108:111], v[124:127]
    v_fmac_f32 v241, v157, v160
    v_fmac_f32 v242, v158, v160
    v_mfma_f32_16x16x32_bf16 v[128:131], v[220:223], a[96:99], v[128:131]
    v_fmac_f32 v243, v159, v160
    v_mul_f32 v240, v164, v240
    v_mfma_f32_16x16x32_bf16 v[132:135], v[220:223], a[100:103], v[132:135]
    ds_read_b64_tr_b16 v[212:213], v182 offset:1024
    v_mul_f32 v241, v164, v241
    v_mfma_f32_16x16x32_bf16 v[136:139], v[220:223], a[104:107], v[136:139]
    ds_read_b64_tr_b16 v[214:215], v182 offset:8192
    v_mul_f32 v242, v164, v242
    v_mul_f32 v243, v164, v243
    v_rcp_f32 v237, v237
    v_mfma_f32_16x16x32_bf16 v[140:143], v[220:223], a[108:111], v[140:143]
    s_waitcnt lgkmcnt(4)
    v_cvt_pk_bf16_f32 v244, v240, v241
    v_cvt_pk_bf16_f32 v245, v242, v243
    v_mfma_f32_16x16x32_bf16 v[148:151], v[224:227], v[144:147], v[148:151]
    ds_write_b64 v185, v[244:245] offset:16384
    v_mfma_f32_16x16x32_bf16 v[112:115], v[224:227], a[112:115], v[112:115]
    ds_read_b64_tr_b16 v[216:217], v181 offset:2048
    v_rcp_f32 v238, v238
    v_mfma_f32_16x16x32_bf16 v[116:119], v[224:227], a[116:119], v[116:119]
    ds_read_b64_tr_b16 v[218:219], v181 offset:9216
    v_accvgpr_read_b32 v240, a244
    v_accvgpr_read_b32 v241, a245
    v_mfma_f32_16x16x32_bf16 v[120:123], v[224:227], a[120:123], v[120:123]
    s_waitcnt vmcnt(8)
    v_accvgpr_read_b32 v242, a246
    v_accvgpr_read_b32 v243, a247
    v_mfma_f32_16x16x32_bf16 v[124:127], v[224:227], a[124:127], v[124:127]
    s_barrier
    v_rcp_f32 v239, v239
    v_mfma_f32_16x16x32_bf16 v[128:131], v[228:231], a[112:115], v[128:131]
    s_lshl_b32 s3, s2, 2
    s_add_u32 s3, s3, s24
    s_mul_i32 s3, s3, 1568
    v_mfma_f32_16x16x32_bf16 v[132:135], v[228:231], a[116:119], v[132:135]
    ds_read_b64_tr_b16 v[220:221], v182 offset:2048
    v_lshlrev_b32 v247, 5, v255
    buffer_load_dword v247, v247, s[40:43], s3 offen
    v_mfma_f32_16x16x32_bf16 v[136:139], v[228:231], a[120:123], v[136:139]
    ds_read_b64_tr_b16 v[222:223], v182 offset:9216
    v_fmac_f32 v240, v156, v161
    v_fmac_f32 v241, v157, v161
    v_mfma_f32_16x16x32_bf16 v[140:143], v[228:231], a[124:127], v[140:143]
    s_waitcnt lgkmcnt(5)
    v_fmac_f32 v242, v158, v161
    v_mul_f32 v236, v236, v60
    v_mfma_f32_16x16x32_bf16 v[148:151], v[208:211], v[144:147], v[148:151]
    v_fmac_f32 v243, v159, v161
    v_mul_f32 v240, v165, v240
    v_mfma_f32_16x16x32_bf16 v[112:115], v[208:211], a[128:131], v[112:115]
    ds_read_b64_tr_b16 v[224:225], v181 offset:3072
    v_mul_f32 v237, v237, v61
    v_mfma_f32_16x16x32_bf16 v[116:119], v[208:211], a[132:135], v[116:119]
    ds_read_b64_tr_b16 v[226:227], v181 offset:10240
    v_mul_f32 v241, v165, v241
    v_mul_f32 v242, v165, v242
    v_mfma_f32_16x16x32_bf16 v[120:123], v[208:211], a[136:139], v[120:123]
    v_mul_f32 v243, v165, v243
    v_mul_f32 v238, v238, v62
    v_mfma_f32_16x16x32_bf16 v[124:127], v[208:211], a[140:143], v[124:127]
    v_cvt_pk_bf16_f32 v244, v240, v241
    v_cvt_pk_bf16_f32 v245, v242, v243
    ds_write_b64 v185, v[244:245] offset:17408
    v_mfma_f32_16x16x32_bf16 v[128:131], v[212:215], a[128:131], v[128:131]
    v_mul_f32 v239, v239, v63
    v_accvgpr_read_b32 v240, a248
    v_mfma_f32_16x16x32_bf16 v[132:135], v[212:215], a[132:135], v[132:135]
    ds_read_b64_tr_b16 v[228:229], v182 offset:3072
    v_accvgpr_read_b32 v241, a249
    v_cvt_pk_bf16_f32 v56, v236, v237
    v_mfma_f32_16x16x32_bf16 v[136:139], v[212:215], a[136:139], v[136:139]
    ds_read_b64_tr_b16 v[230:231], v182 offset:10240
    v_accvgpr_read_b32 v242, a250
    v_accvgpr_read_b32 v243, a251
    v_mfma_f32_16x16x32_bf16 v[140:143], v[212:215], a[140:143], v[140:143]
    s_waitcnt lgkmcnt(5)
    v_fmac_f32 v240, v156, v162
    v_cvt_pk_bf16_f32 v57, v238, v239
    v_mfma_f32_16x16x32_bf16 v[148:151], v[216:219], v[144:147], v[148:151]
    buffer_store_dwordx2 v[56:57], v189, s[20:23], s87 offen offset:1024
    v_fmac_f32 v241, v157, v162
    v_mfma_f32_16x16x32_bf16 v[112:115], v[216:219], a[144:147], v[112:115]
    s_lshl_b32 s3, s26, 2
    ds_read_b64_tr_b16 v[208:209], v181 offset:4096
    v_fmac_f32 v242, v158, v162
    v_mfma_f32_16x16x32_bf16 v[116:119], v[216:219], a[148:151], v[116:119]
    s_add_u32 s3, s3, s53
    ds_read_b64_tr_b16 v[210:211], v181 offset:11264
    v_fmac_f32 v243, v159, v162
    v_mul_f32 v240, v166, v240
    v_mfma_f32_16x16x32_bf16 v[120:123], v[216:219], a[152:155], v[120:123]
    s_add_u32 s3, s3, 2
    v_mul_f32 v241, v166, v241
    s_lshr_b32 s34, s3, 1
    s_lshl_b32 s34, s34, 12
    s_and_b32 s3, s3, 1
    s_lshl_b32 s3, s3, 3
    s_add_u32 s34, s34, s3
    s_add_u32 s86, s34, s54
    s_add_u32 s87, s34, s55
    v_mfma_f32_16x16x32_bf16 v[124:127], v[216:219], a[156:159], v[124:127]
    v_mul_f32 v242, v166, v242
    v_mul_f32 v243, v166, v243
    v_mfma_f32_16x16x32_bf16 v[128:131], v[220:223], a[144:147], v[128:131]
    v_cvt_pk_bf16_f32 v244, v240, v241
    v_cvt_pk_bf16_f32 v245, v242, v243
    ds_write_b64 v186, v[244:245] offset:16384
    v_mfma_f32_16x16x32_bf16 v[132:135], v[220:223], a[148:151], v[132:135]
    ds_read_b64_tr_b16 v[212:213], v182 offset:4096
    v_fmac_f32 v64, v200, v160
    v_mfma_f32_16x16x32_bf16 v[136:139], v[220:223], a[152:155], v[136:139]
    ds_read_b64_tr_b16 v[214:215], v182 offset:11264
    v_accvgpr_read_b32 v240, a252
    v_accvgpr_read_b32 v241, a253
    v_mfma_f32_16x16x32_bf16 v[140:143], v[220:223], a[156:159], v[140:143]
    s_waitcnt lgkmcnt(5)
    v_accvgpr_read_b32 v242, a254
    v_fmac_f32 v65, v201, v160
    v_mfma_f32_16x16x32_bf16 v[148:151], v[224:227], v[144:147], v[148:151]
    v_accvgpr_read_b32 v243, a255
    v_fmac_f32 v240, v156, v163
    v_mfma_f32_16x16x32_bf16 v[112:115], v[224:227], a[160:163], v[112:115]
    ds_read_b64_tr_b16 v[216:217], v181 offset:5120
    v_fmac_f32 v66, v202, v160
    v_mfma_f32_16x16x32_bf16 v[116:119], v[224:227], a[164:167], v[116:119]
    ds_read_b64_tr_b16 v[218:219], v181 offset:12288
    v_fmac_f32 v241, v157, v163
    v_fmac_f32 v242, v158, v163
    v_fmac_f32 v67, v203, v160
    v_mfma_f32_16x16x32_bf16 v[120:123], v[224:227], a[168:171], v[120:123]
    v_fmac_f32 v243, v159, v163
    v_mul_f32 v240, v167, v240
    v_mfma_f32_16x16x32_bf16 v[124:127], v[224:227], a[172:175], v[124:127]
    v_fmac_f32 v68, v204, v160
    v_mul_f32 v241, v167, v241
    v_mfma_f32_16x16x32_bf16 v[128:131], v[228:231], a[160:163], v[128:131]
    v_mul_f32 v242, v167, v242
    v_mul_f32 v243, v167, v243
    v_mfma_f32_16x16x32_bf16 v[132:135], v[228:231], a[164:167], v[132:135]
    v_cvt_pk_bf16_f32 v244, v240, v241
    v_fmac_f32 v69, v205, v160
    v_cvt_pk_bf16_f32 v245, v242, v243
    ds_write_b64 v186, v[244:245] offset:17408
    v_mfma_f32_16x16x32_bf16 v[136:139], v[228:231], a[168:171], v[136:139]
    ds_read_b64_tr_b16 v[220:221], v182 offset:5120
    v_fmac_f32 v70, v206, v160
    v_mfma_f32_16x16x32_bf16 v[140:143], v[228:231], a[172:175], v[140:143]
    s_waitcnt lgkmcnt(4)
    ds_read_b64_tr_b16 v[222:223], v182 offset:12288
    v_fmac_f32 v71, v207, v160
    v_mfma_f32_16x16x32_bf16 v[148:151], v[208:211], v[144:147], v[148:151]
    v_fmac_f32 v72, v200, v161
    v_fmac_f32 v73, v201, v161
    v_mfma_f32_16x16x32_bf16 v[112:115], v[208:211], a[176:179], v[112:115]
    ds_read_b64_tr_b16 v[224:225], v181 offset:6144
    v_fmac_f32 v74, v202, v161
    v_mfma_f32_16x16x32_bf16 v[116:119], v[208:211], a[180:183], v[116:119]
    ds_read_b64_tr_b16 v[226:227], v181 offset:13312
    v_fmac_f32 v75, v203, v161
    v_fmac_f32 v76, v204, v161
    v_fmac_f32 v77, v205, v161
    v_mfma_f32_16x16x32_bf16 v[120:123], v[208:211], a[184:187], v[120:123]
    v_fmac_f32 v78, v206, v161
    v_fmac_f32 v79, v207, v161
    v_mfma_f32_16x16x32_bf16 v[124:127], v[208:211], a[188:191], v[124:127]
    v_fmac_f32 v80, v200, v162
    v_add_u32 v181, 4294934208, v181
    v_mfma_f32_16x16x32_bf16 v[128:131], v[212:215], a[176:179], v[128:131]
    v_fmac_f32 v81, v201, v162
    v_fmac_f32 v82, v202, v162
    v_mfma_f32_16x16x32_bf16 v[132:135], v[212:215], a[180:183], v[132:135]
    ds_read_b64_tr_b16 v[228:229], v182 offset:6144
    v_fmac_f32 v83, v203, v162
    v_fmac_f32 v84, v204, v162
    v_mfma_f32_16x16x32_bf16 v[136:139], v[212:215], a[184:187], v[136:139]
    ds_read_b64_tr_b16 v[230:231], v182 offset:13312
    v_fmac_f32 v85, v205, v162
    v_fmac_f32 v86, v206, v162
    v_fmac_f32 v87, v207, v162
    v_mfma_f32_16x16x32_bf16 v[140:143], v[212:215], a[188:191], v[140:143]
    s_waitcnt lgkmcnt(4)
    v_fmac_f32 v88, v200, v163
    v_fmac_f32 v89, v201, v163
    v_mfma_f32_16x16x32_bf16 v[148:151], v[216:219], v[144:147], v[148:151]
    v_fmac_f32 v90, v202, v163
    v_add_u32 v182, 4294934208, v182
    v_mfma_f32_16x16x32_bf16 v[112:115], v[216:219], a[192:195], v[112:115]
    ds_read_b64_tr_b16 v[208:209], v181 offset:0
    v_fmac_f32 v91, v203, v163
    v_mfma_f32_16x16x32_bf16 v[116:119], v[216:219], a[196:199], v[116:119]
    ds_read_b128 v[200:203], v191 offset:192
    v_fmac_f32 v92, v204, v163
    v_fmac_f32 v93, v205, v163
    v_mfma_f32_16x16x32_bf16 v[120:123], v[216:219], a[200:203], v[120:123]
    ds_read_b64_tr_b16 v[210:211], v181 offset:7168
    v_fmac_f32 v94, v206, v163
    v_mfma_f32_16x16x32_bf16 v[124:127], v[216:219], a[204:207], v[124:127]
    v_fmac_f32 v95, v207, v163
    v_mul_f32 v232, v64, v64
    ds_read_b128 v[204:207], v191 offset:576
    v_mfma_f32_16x16x32_bf16 v[128:131], v[220:223], a[192:195], v[128:131]
    v_mul_f32 v233, v65, v65
    v_mul_f32 v234, v66, v66
    v_mfma_f32_16x16x32_bf16 v[132:135], v[220:223], a[196:199], v[132:135]
    ds_read_b64_tr_b16 v[212:213], v182 offset:0
    v_mul_f32 v235, v67, v67
    v_mfma_f32_16x16x32_bf16 v[136:139], v[220:223], a[200:203], v[136:139]
    ds_read_b64_tr_b16 v[214:215], v182 offset:7168
    v_fma_f32 v232, v232, v172, v168
    v_fma_f32 v233, v233, v172, v168
    v_fma_f32 v234, v234, v172, v168
    v_mfma_f32_16x16x32_bf16 v[140:143], v[220:223], a[204:207], v[140:143]
    s_waitcnt lgkmcnt(6)
    v_fma_f32 v235, v235, v172, v168
    v_mul_f32 v232, v232, v64
    v_mfma_f32_16x16x32_bf16 v[148:151], v[224:227], v[144:147], v[148:151]
    v_mul_f32 v233, v233, v65
    v_mul_f32 v234, v234, v66
    v_mfma_f32_16x16x32_bf16 v[112:115], v[224:227], a[208:211], v[112:115]
    v_mul_f32 v235, v235, v67
    v_mfma_f32_16x16x32_bf16 v[116:119], v[224:227], a[212:215], v[116:119]
    ds_read_b64_tr_b16 v[216:217], v181 offset:1024
    v_exp_f32 v232, v232
    v_mfma_f32_16x16x32_bf16 v[120:123], v[224:227], a[216:219], v[120:123]
    ds_read_b64_tr_b16 v[218:219], v181 offset:8192
    v_exp_f32 v233, v233
    v_exp_f32 v234, v234
    v_mfma_f32_16x16x32_bf16 v[124:127], v[224:227], a[220:223], v[124:127]
    v_exp_f32 v235, v235
    v_mfma_f32_16x16x32_bf16 v[128:131], v[228:231], a[208:211], v[128:131]
    ds_write_b128 v190, v[148:151] offset:256
    v_mul_f32 v68, v68, v64
    v_mfma_f32_16x16x32_bf16 v[132:135], v[228:231], a[212:215], v[132:135]
    v_mul_f32 v69, v69, v65
    v_mul_f32 v70, v70, v66
    v_mfma_f32_16x16x32_bf16 v[136:139], v[228:231], a[216:219], v[136:139]
    ds_read_b64_tr_b16 v[220:221], v182 offset:1024
    v_mul_f32 v71, v71, v67
    v_mfma_f32_16x16x32_bf16 v[140:143], v[228:231], a[220:223], v[140:143]
    s_waitcnt lgkmcnt(4)
    ds_read_b64_tr_b16 v[222:223], v182 offset:8192
    v_fma_f32 v232, v232, v176, v176
    v_fma_f32 v233, v233, v176, v176
    v_mfma_f32_16x16x32_bf16 v[192:195], v[208:211], v[144:147], 0
    v_fma_f32 v234, v234, v176, v176
    v_fma_f32 v235, v235, v176, v176
    v_mfma_f32_16x16x32_bf16 v[0:3], v[208:211], a[0:3], 0
    v_rcp_f32 v232, v232
    v_mfma_f32_16x16x32_bf16 v[4:7], v[208:211], a[4:7], 0
    v_rcp_f32 v233, v233
    v_mfma_f32_16x16x32_bf16 v[8:11], v[208:211], a[8:11], 0
    s_waitcnt lgkmcnt(2)
    v_rcp_f32 v234, v234
    v_mfma_f32_16x16x32_bf16 v[12:15], v[208:211], a[12:15], 0
    s_waitcnt vmcnt(2)
    s_barrier
    ds_read_b64_tr_b16 v[224:225], v181 offset:2048
    v_fmac_f32 v112, v148, v160
    v_fmac_f32 v113, v149, v160
    v_mfma_f32_16x16x32_bf16 v[196:199], v[212:215], v[144:147], 0
    s_add_u32 m0, s35, 130752
    ds_read_b128 v[156:159], v246 offset:256
    ds_read_b64_tr_b16 v[226:227], v181 offset:9216
    v_rcp_f32 v235, v235
    v_mfma_f32_16x16x32_bf16 v[16:19], v[212:215], a[0:3], 0
    s_add_u32 s32, s30, s31
    buffer_load_dwordx4 v250, s[12:15], s32 offen offset:0 lds
    v_fmac_f32 v114, v150, v160
    v_mfma_f32_16x16x32_bf16 v[20:23], v[212:215], a[4:7], 0
    v_fmac_f32 v115, v151, v160
    v_mul_f32 v112, v164, v112
    v_mfma_f32_16x16x32_bf16 v[24:27], v[212:215], a[8:11], 0
    ds_read_b64_tr_b16 v[228:229], v182 offset:2048
    v_mul_f32 v113, v164, v113
    v_mul_f32 v232, v232, v68
    v_mfma_f32_16x16x32_bf16 v[28:31], v[212:215], a[12:15], 0
    s_waitcnt lgkmcnt(4)
    ds_read_b64_tr_b16 v[230:231], v182 offset:9216
    v_mul_f32 v114, v164, v114
    v_mul_f32 v115, v164, v115
    v_mfma_f32_16x16x32_bf16 v[192:195], v[216:219], v[144:147], v[192:195]
    ds_read_b128 a[0:3], v187 offset:0
    v_cvt_pk_bf16_f32 v112, v112, v113
    v_mul_f32 v233, v233, v69
    v_mfma_f32_16x16x32_bf16 v[0:3], v[216:219], a[16:19], v[0:3]
    s_add_u32 s30, s30, 16384
    ds_read_b128 a[4:7], v187 offset:1024
    v_mul_f32 v234, v234, v70
    v_mfma_f32_16x16x32_bf16 v[4:7], v[216:219], a[20:23], v[4:7]
    buffer_load_dwordx4 v250, s[12:15], s32 offen offset:1024 lds
    v_mul_f32 v235, v235, v71
    v_mfma_f32_16x16x32_bf16 v[8:11], v[216:219], a[24:27], v[8:11]
    ds_read_b128 a[8:11], v188 offset:0
    ds_read_b128 a[12:15], v188 offset:1024
    v_mfma_f32_16x16x32_bf16 v[12:15], v[216:219], a[28:31], v[12:15]
    ds_read_b64_tr_b16 v[208:209], v181 offset:3072
    v_cvt_pk_bf16_f32 v64, v232, v233
    v_mfma_f32_16x16x32_bf16 v[196:199], v[220:223], v[144:147], v[196:199]
    v_cvt_pk_bf16_f32 v113, v114, v115
    v_cvt_pk_bf16_f32 v65, v234, v235
    ds_write_b64 v183, v[112:113] offset:33280
    ds_read_b64_tr_b16 v[210:211], v181 offset:10240
    v_mfma_f32_16x16x32_bf16 v[16:19], v[220:223], a[16:19], v[16:19]
    buffer_store_dwordx2 v[64:65], v189, s[20:23], s86 offen offset:0
    v_fmac_f32 v116, v148, v161
    v_mfma_f32_16x16x32_bf16 v[20:23], v[220:223], a[20:23], v[20:23]
    v_fmac_f32 v117, v149, v161
    v_fmac_f32 v118, v150, v161
    v_mfma_f32_16x16x32_bf16 v[24:27], v[220:223], a[24:27], v[24:27]
    s_and_b32 s30, s30, 0x7ffff
    buffer_load_dwordx4 v250, s[12:15], s32 offen offset:2048 lds
    v_fmac_f32 v119, v151, v161
    v_mfma_f32_16x16x32_bf16 v[28:31], v[220:223], a[28:31], v[28:31]
    s_waitcnt lgkmcnt(7)
    ds_read_b64_tr_b16 v[212:213], v182 offset:3072
    v_mul_f32 v116, v165, v116
    v_mul_f32 v117, v165, v117
    v_mul_f32 v236, v72, v72
    v_mfma_f32_16x16x32_bf16 v[192:195], v[224:227], v[144:147], v[192:195]
    ds_read_b64_tr_b16 v[214:215], v182 offset:10240
    v_mul_f32 v237, v73, v73
    v_mfma_f32_16x16x32_bf16 v[0:3], v[224:227], a[32:35], v[0:3]
    ds_read_b128 a[16:19], v187 offset:8192
    ds_read_b128 a[20:23], v187 offset:9216
    v_mfma_f32_16x16x32_bf16 v[4:7], v[224:227], a[36:39], v[4:7]
    ds_read_b128 a[24:27], v188 offset:8192
    ds_read_b128 a[28:31], v188 offset:9216
    v_mfma_f32_16x16x32_bf16 v[8:11], v[224:227], a[40:43], v[8:11]
    ds_read_b64_tr_b16 v[216:217], v181 offset:4096
    v_mul_f32 v238, v74, v74
    v_mfma_f32_16x16x32_bf16 v[12:15], v[224:227], a[44:47], v[12:15]
    ds_read_b64_tr_b16 v[218:219], v181 offset:11264
    v_mul_f32 v118, v165, v118
    v_mul_f32 v119, v165, v119
    v_mfma_f32_16x16x32_bf16 v[196:199], v[228:231], v[144:147], v[196:199]
    buffer_load_dwordx4 v250, s[12:15], s32 offen offset:3072 lds
    v_cvt_pk_bf16_f32 v116, v116, v117
    v_mul_f32 v239, v75, v75
    v_mfma_f32_16x16x32_bf16 v[16:19], v[228:231], a[32:35], v[16:19]
    v_cvt_pk_bf16_f32 v117, v118, v119
    v_fma_f32 v236, v236, v173, v169
    s_waitcnt lgkmcnt(9)
    ds_write_b64 v183, v[116:117] offset:34304
    v_mfma_f32_16x16x32_bf16 v[20:23], v[228:231], a[36:39], v[20:23]
    v_fmac_f32 v120, v148, v162
    v_fmac_f32 v121, v149, v162
    v_mfma_f32_16x16x32_bf16 v[24:27], v[228:231], a[40:43], v[24:27]
    ds_read_b64_tr_b16 v[220:221], v182 offset:4096
    v_fma_f32 v237, v237, v173, v169
    v_mfma_f32_16x16x32_bf16 v[28:31], v[228:231], a[44:47], v[28:31]
    s_waitcnt lgkmcnt(8)
    ds_read_b64_tr_b16 v[222:223], v182 offset:11264
    v_fmac_f32 v122, v150, v162
    v_fmac_f32 v123, v151, v162
    v_mfma_f32_16x16x32_bf16 v[192:195], v[208:211], v[144:147], v[192:195]
    ds_read_b128 a[32:35], v187 offset:16384
    v_mul_f32 v120, v166, v120
    v_fma_f32 v238, v238, v173, v169
    v_mfma_f32_16x16x32_bf16 v[0:3], v[208:211], a[48:51], v[0:3]
    ds_read_b128 a[36:39], v187 offset:17408
    v_fma_f32 v239, v239, v173, v169
    v_mfma_f32_16x16x32_bf16 v[4:7], v[208:211], a[52:55], v[4:7]
    s_add_u32 m0, s35, 134880
    ds_read_b128 a[40:43], v188 offset:16384
    ds_read_b128 a[44:47], v188 offset:17408
    v_mfma_f32_16x16x32_bf16 v[8:11], v[208:211], a[56:59], v[8:11]
    s_add_u32 s32, s32, 4096
    buffer_load_dwordx4 v250, s[12:15], s32 offen offset:0 lds
    v_mul_f32 v236, v236, v72
    v_mfma_f32_16x16x32_bf16 v[12:15], v[208:211], a[60:63], v[12:15]
    ds_read_b64_tr_b16 v[224:225], v181 offset:5120
    v_mul_f32 v121, v166, v121
    v_mfma_f32_16x16x32_bf16 v[196:199], v[212:215], v[144:147], v[196:199]
    ds_read_b64_tr_b16 v[226:227], v181 offset:12288
    v_mul_f32 v237, v237, v73
    v_mfma_f32_16x16x32_bf16 v[16:19], v[212:215], a[48:51], v[16:19]
    v_mul_f32 v122, v166, v122
    v_mul_f32 v238, v238, v74
    v_mfma_f32_16x16x32_bf16 v[20:23], v[212:215], a[52:55], v[20:23]
    v_mul_f32 v123, v166, v123
    v_cvt_pk_bf16_f32 v120, v120, v121
    v_cvt_pk_bf16_f32 v121, v122, v123
    s_waitcnt lgkmcnt(9)
    ds_write_b64 v184, v[120:121] offset:33280
    v_mfma_f32_16x16x32_bf16 v[24:27], v[212:215], a[56:59], v[24:27]
    ds_read_b64_tr_b16 v[228:229], v182 offset:5120
    v_mul_f32 v239, v239, v75
    v_mfma_f32_16x16x32_bf16 v[28:31], v[212:215], a[60:63], v[28:31]
    s_waitcnt lgkmcnt(8)
    buffer_load_dwordx4 v250, s[12:15], s32 offen offset:1024 lds
    v_fmac_f32 v124, v148, v163
    v_fmac_f32 v125, v149, v163
    v_mfma_f32_16x16x32_bf16 v[192:195], v[216:219], v[144:147], v[192:195]
    ds_read_b64_tr_b16 v[230:231], v182 offset:12288
    v_fmac_f32 v126, v150, v163
    v_exp_f32 v236, v236
    v_mfma_f32_16x16x32_bf16 v[0:3], v[216:219], a[64:67], v[0:3]
    ds_read_b128 a[48:51], v187 offset:24576
    ds_read_b128 a[52:55], v187 offset:25600
    v_mfma_f32_16x16x32_bf16 v[4:7], v[216:219], a[68:71], v[4:7]
    ds_read_b128 a[56:59], v188 offset:24576
    ds_read_b128 a[60:63], v188 offset:25600
    v_mfma_f32_16x16x32_bf16 v[8:11], v[216:219], a[72:75], v[8:11]
    ds_read_b64_tr_b16 v[208:209], v181 offset:6144
    v_exp_f32 v237, v237
    v_mfma_f32_16x16x32_bf16 v[12:15], v[216:219], a[76:79], v[12:15]
    ds_read_b64_tr_b16 v[210:211], v181 offset:13312
    v_fmac_f32 v127, v151, v163
    v_mul_f32 v124, v167, v124
    v_mfma_f32_16x16x32_bf16 v[196:199], v[220:223], v[144:147], v[196:199]
    v_mul_f32 v125, v167, v125
    v_mul_f32 v126, v167, v126
    v_mfma_f32_16x16x32_bf16 v[16:19], v[220:223], a[64:67], v[16:19]
    buffer_load_dwordx4 v250, s[12:15], s32 offen offset:2048 lds
    v_add_u32 v181, 4294931392, v181
    v_mfma_f32_16x16x32_bf16 v[20:23], v[220:223], a[68:71], v[20:23]
    v_mul_f32 v127, v167, v127
    v_exp_f32 v238, v238
    v_mfma_f32_16x16x32_bf16 v[24:27], v[220:223], a[72:75], v[24:27]
    v_cvt_pk_bf16_f32 v124, v124, v125
    v_cvt_pk_bf16_f32 v125, v126, v127
    s_waitcnt lgkmcnt(9)
    ds_write_b64 v184, v[124:125] offset:34304
    v_mfma_f32_16x16x32_bf16 v[28:31], v[220:223], a[76:79], v[28:31]
    s_waitcnt lgkmcnt(7)
    ds_read_b64_tr_b16 v[212:213], v182 offset:6144
    v_fmac_f32 v128, v156, v160
    v_mfma_f32_16x16x32_bf16 v[192:195], v[224:227], v[144:147], v[192:195]
    ds_read_b64_tr_b16 v[214:215], v182 offset:13312
    v_exp_f32 v239, v239
    v_mfma_f32_16x16x32_bf16 v[0:3], v[224:227], a[80:83], v[0:3]
    v_add_u32 v182, 4294931392, v182
    v_fmac_f32 v129, v157, v160
    v_mfma_f32_16x16x32_bf16 v[4:7], v[224:227], a[84:87], v[4:7]
    v_fmac_f32 v130, v158, v160
    v_fmac_f32 v131, v159, v160
    v_mfma_f32_16x16x32_bf16 v[8:11], v[224:227], a[88:91], v[8:11]
    buffer_load_dwordx4 v250, s[12:15], s32 offen offset:3072 lds
    v_mul_f32 v128, v164, v128
    v_mfma_f32_16x16x32_bf16 v[12:15], v[224:227], a[92:95], v[12:15]
    ds_read_b64_tr_b16 v[216:217], v181 offset:0
    v_mul_f32 v129, v164, v129
    v_mul_f32 v76, v76, v72
    v_mfma_f32_16x16x32_bf16 v[196:199], v[228:231], v[144:147], v[196:199]
    ds_read_b64_tr_b16 v[218:219], v181 offset:7168
    v_mul_f32 v130, v164, v130
    v_mfma_f32_16x16x32_bf16 v[16:19], v[228:231], a[80:83], v[16:19]
    v_mul_f32 v77, v77, v73
    v_mul_f32 v131, v164, v131
    v_mfma_f32_16x16x32_bf16 v[20:23], v[228:231], a[84:87], v[20:23]
    v_cvt_pk_bf16_f32 v128, v128, v129
    v_mul_f32 v78, v78, v74
    v_cvt_pk_bf16_f32 v129, v130, v131
    ds_write_b64 v185, v[128:129] offset:33280
    v_mfma_f32_16x16x32_bf16 v[24:27], v[228:231], a[88:91], v[24:27]
    ds_read_b64_tr_b16 v[220:221], v182 offset:0
    v_fmac_f32 v132, v156, v161
    v_mfma_f32_16x16x32_bf16 v[28:31], v[228:231], a[92:95], v[28:31]
    s_waitcnt lgkmcnt(4)
    ds_read_b64_tr_b16 v[222:223], v182 offset:7168
    v_fmac_f32 v133, v157, v161
    v_mul_f32 v79, v79, v75
    v_mfma_f32_16x16x32_bf16 v[192:195], v[208:211], v[144:147], v[192:195]
    v_fmac_f32 v134, v158, v161
    v_fma_f32 v236, v236, v177, v177
    v_mfma_f32_16x16x32_bf16 v[0:3], v[208:211], a[96:99], v[0:3]
    v_fmac_f32 v135, v159, v161
    v_mul_f32 v132, v165, v132
    v_mfma_f32_16x16x32_bf16 v[4:7], v[208:211], a[100:103], v[4:7]
    v_mul_f32 v133, v165, v133
    v_mul_f32 v134, v165, v134
    v_mfma_f32_16x16x32_bf16 v[8:11], v[208:211], a[104:107], v[8:11]
    ds_read_b64_tr_b16 v[224:225], v181 offset:1024
    v_fma_f32 v237, v237, v177, v177
    v_mfma_f32_16x16x32_bf16 v[12:15], v[208:211], a[108:111], v[12:15]
    v_mul_f32 v135, v165, v135
    v_cvt_pk_bf16_f32 v132, v132, v133
    v_fma_f32 v238, v238, v177, v177
    v_mfma_f32_16x16x32_bf16 v[196:199], v[212:215], v[144:147], v[196:199]
    v_cvt_pk_bf16_f32 v133, v134, v135
    v_fma_f32 v239, v239, v177, v177
    ds_write_b64 v185, v[132:133] offset:34304
    ds_read_b64_tr_b16 v[226:227], v181 offset:8192
    v_mfma_f32_16x16x32_bf16 v[16:19], v[212:215], a[96:99], v[16:19]
    v_fmac_f32 v136, v156, v162
    v_fmac_f32 v137, v157, v162
    v_mfma_f32_16x16x32_bf16 v[20:23], v[212:215], a[100:103], v[20:23]
    v_fmac_f32 v138, v158, v162
    v_fmac_f32 v139, v159, v162
    v_mfma_f32_16x16x32_bf16 v[24:27], v[212:215], a[104:107], v[24:27]
    ds_read_b64_tr_b16 v[228:229], v182 offset:1024
    v_rcp_f32 v236, v236
    v_mfma_f32_16x16x32_bf16 v[28:31], v[212:215], a[108:111], v[28:31]
    s_waitcnt lgkmcnt(4)
    ds_read_b64_tr_b16 v[230:231], v182 offset:8192
    v_mul_f32 v136, v166, v136
    v_mul_f32 v137, v166, v137
    v_mfma_f32_16x16x32_bf16 v[192:195], v[216:219], v[144:147], v[192:195]
    v_mul_f32 v138, v166, v138
    v_mfma_f32_16x16x32_bf16 v[0:3], v[216:219], a[112:115], v[0:3]
    v_rcp_f32 v237, v237
    v_mfma_f32_16x16x32_bf16 v[4:7], v[216:219], a[116:119], v[4:7]
    v_mul_f32 v139, v166, v139
    v_cvt_pk_bf16_f32 v136, v136, v137
    v_cvt_pk_bf16_f32 v137, v138, v139
    ds_write_b64 v186, v[136:137] offset:33280
    v_mfma_f32_16x16x32_bf16 v[8:11], v[216:219], a[120:123], v[8:11]
    s_barrier
    ds_read_b64_tr_b16 v[208:209], v181 offset:2048
    v_fmac_f32 v140, v156, v163
    v_mfma_f32_16x16x32_bf16 v[12:15], v[216:219], a[124:127], v[12:15]
    s_add_u32 m0, s35, 97664
    ds_read_b64_tr_b16 v[210:211], v181 offset:9216
    v_fmac_f32 v141, v157, v163
    v_mfma_f32_16x16x32_bf16 v[196:199], v[220:223], v[144:147], v[196:199]
    s_add_u32 s32, s30, s31
    buffer_load_dwordx4 v250, s[12:15], s32 offen offset:0 lds
    v_rcp_f32 v238, v238
    v_mfma_f32_16x16x32_bf16 v[16:19], v[220:223], a[112:115], v[16:19]
    v_fmac_f32 v142, v158, v163
    v_fmac_f32 v143, v159, v163
    v_mfma_f32_16x16x32_bf16 v[20:23], v[220:223], a[116:119], v[20:23]
    v_mul_f32 v140, v167, v140
    v_mul_f32 v141, v167, v141
    v_mfma_f32_16x16x32_bf16 v[24:27], v[220:223], a[120:123], v[24:27]
    ds_read_b64_tr_b16 v[212:213], v182 offset:2048
    v_rcp_f32 v239, v239
    v_mfma_f32_16x16x32_bf16 v[28:31], v[220:223], a[124:127], v[28:31]
    s_waitcnt lgkmcnt(4)
    ds_read_b64_tr_b16 v[214:215], v182 offset:9216
    v_mul_f32 v142, v167, v142
    v_mul_f32 v143, v167, v143
    v_mfma_f32_16x16x32_bf16 v[192:195], v[224:227], v[144:147], v[192:195]
    v_cvt_pk_bf16_f32 v140, v140, v141
    v_cvt_pk_bf16_f32 v141, v142, v143
    v_mfma_f32_16x16x32_bf16 v[0:3], v[224:227], a[128:131], v[0:3]
    s_add_u32 s30, s30, 16384
    ds_write_b64 v186, v[140:141] offset:34304
    v_mul_f32 v236, v236, v76
    v_mfma_f32_16x16x32_bf16 v[4:7], v[224:227], a[132:135], v[4:7]
    buffer_load_dwordx4 v250, s[12:15], s32 offen offset:1024 lds
    v_mul_f32 v237, v237, v77
    v_mfma_f32_16x16x32_bf16 v[8:11], v[224:227], a[136:139], v[8:11]
    ds_read_b64_tr_b16 v[216:217], v181 offset:3072
    v_mul_f32 v238, v238, v78
    v_mfma_f32_16x16x32_bf16 v[12:15], v[224:227], a[140:143], v[12:15]
    ds_read_b64_tr_b16 v[218:219], v181 offset:10240
    v_mul_f32 v239, v239, v79
    v_cvt_pk_bf16_f32 v72, v236, v237
    v_mfma_f32_16x16x32_bf16 v[196:199], v[228:231], v[144:147], v[196:199]
    v_cvt_pk_bf16_f32 v73, v238, v239
    v_mul_f32 v232, v80, v80
    v_mfma_f32_16x16x32_bf16 v[16:19], v[228:231], a[128:131], v[16:19]
    buffer_store_dwordx2 v[72:73], v189, s[20:23], s86 offen offset:1024
    v_mul_f32 v233, v81, v81
    v_mfma_f32_16x16x32_bf16 v[20:23], v[228:231], a[132:135], v[20:23]
    v_mul_f32 v234, v82, v82
    v_mul_f32 v235, v83, v83
    v_mfma_f32_16x16x32_bf16 v[24:27], v[228:231], a[136:139], v[24:27]
    s_and_b32 s30, s30, 0x7ffff
    buffer_load_dwordx4 v250, s[12:15], s32 offen offset:2048 lds
    v_fma_f32 v232, v232, v174, v170
    v_fma_f32 v233, v233, v174, v170
    v_mfma_f32_16x16x32_bf16 v[28:31], v[228:231], a[140:143], v[28:31]
    s_waitcnt lgkmcnt(3)
    ds_read_b64_tr_b16 v[220:221], v182 offset:3072
    v_fma_f32 v234, v234, v174, v170
    v_fma_f32 v235, v235, v174, v170
    v_mul_f32 v232, v232, v80
    v_mfma_f32_16x16x32_bf16 v[192:195], v[208:211], v[144:147], v[192:195]
    ds_read_b64_tr_b16 v[222:223], v182 offset:10240
    v_mul_f32 v233, v233, v81
    v_mfma_f32_16x16x32_bf16 v[0:3], v[208:211], a[144:147], v[0:3]
    v_mul_f32 v234, v234, v82
    v_mul_f32 v235, v235, v83
    v_mfma_f32_16x16x32_bf16 v[4:7], v[208:211], a[148:151], v[4:7]
    v_exp_f32 v232, v232
    v_mfma_f32_16x16x32_bf16 v[8:11], v[208:211], a[152:155], v[8:11]
    ds_read_b64_tr_b16 v[224:225], v181 offset:4096
    v_exp_f32 v233, v233
    v_mfma_f32_16x16x32_bf16 v[12:15], v[208:211], a[156:159], v[12:15]
    ds_read_b64_tr_b16 v[226:227], v181 offset:11264
    v_exp_f32 v234, v234
    v_mfma_f32_16x16x32_bf16 v[196:199], v[212:215], v[144:147], v[196:199]
    buffer_load_dwordx4 v250, s[12:15], s32 offen offset:3072 lds
    v_exp_f32 v235, v235
    v_mfma_f32_16x16x32_bf16 v[16:19], v[212:215], a[144:147], v[16:19]
    v_mul_f32 v84, v84, v80
    v_mul_f32 v85, v85, v81
    v_mfma_f32_16x16x32_bf16 v[20:23], v[212:215], a[148:151], v[20:23]
    v_mul_f32 v86, v86, v82
    v_mul_f32 v87, v87, v83
    v_mfma_f32_16x16x32_bf16 v[24:27], v[212:215], a[152:155], v[24:27]
    ds_read_b64_tr_b16 v[228:229], v182 offset:4096
    v_fma_f32 v232, v232, v178, v178
    v_mfma_f32_16x16x32_bf16 v[28:31], v[212:215], a[156:159], v[28:31]
    s_waitcnt lgkmcnt(3)
    ds_read_b64_tr_b16 v[230:231], v182 offset:11264
    v_fma_f32 v233, v233, v178, v178
    v_fma_f32 v234, v234, v178, v178
    v_mfma_f32_16x16x32_bf16 v[192:195], v[216:219], v[144:147], v[192:195]
    v_fma_f32 v235, v235, v178, v178
    v_rcp_f32 v232, v232
    v_mfma_f32_16x16x32_bf16 v[0:3], v[216:219], a[160:163], v[0:3]
    v_rcp_f32 v233, v233
    v_mfma_f32_16x16x32_bf16 v[4:7], v[216:219], a[164:167], v[4:7]
    s_add_u32 m0, s35, 101792
    v_rcp_f32 v234, v234
    v_mfma_f32_16x16x32_bf16 v[8:11], v[216:219], a[168:171], v[8:11]
    s_add_u32 s32, s32, 4096
    buffer_load_dwordx4 v250, s[12:15], s32 offen offset:0 lds
    v_mfma_f32_16x16x32_bf16 v[12:15], v[216:219], a[172:175], v[12:15]
    ds_read_b64_tr_b16 v[208:209], v181 offset:5120
    v_rcp_f32 v235, v235
    v_mfma_f32_16x16x32_bf16 v[196:199], v[220:223], v[144:147], v[196:199]
    ds_read_b64_tr_b16 v[210:211], v181 offset:12288
    v_mul_f32 v232, v232, v84
    v_mfma_f32_16x16x32_bf16 v[16:19], v[220:223], a[160:163], v[16:19]
    v_mul_f32 v233, v233, v85
    v_mul_f32 v234, v234, v86
    v_mfma_f32_16x16x32_bf16 v[20:23], v[220:223], a[164:167], v[20:23]
    v_mul_f32 v235, v235, v87
    v_cvt_pk_bf16_f32 v80, v232, v233
    v_mfma_f32_16x16x32_bf16 v[24:27], v[220:223], a[168:171], v[24:27]
    ds_read_b64_tr_b16 v[212:213], v182 offset:5120
    v_cvt_pk_bf16_f32 v81, v234, v235
    v_mul_f32 v236, v88, v88
    buffer_store_dwordx2 v[80:81], v189, s[20:23], s87 offen offset:0
    v_mfma_f32_16x16x32_bf16 v[28:31], v[220:223], a[172:175], v[28:31]
    s_waitcnt lgkmcnt(3)
    buffer_load_dwordx4 v250, s[12:15], s32 offen offset:1024 lds
    v_mul_f32 v237, v89, v89
    v_mul_f32 v238, v90, v90
    v_mfma_f32_16x16x32_bf16 v[192:195], v[224:227], v[144:147], v[192:195]
    ds_read_b64_tr_b16 v[214:215], v182 offset:12288
    v_mul_f32 v239, v91, v91
    v_fma_f32 v236, v236, v175, v171
    v_mfma_f32_16x16x32_bf16 v[0:3], v[224:227], a[176:179], v[0:3]
    v_fma_f32 v237, v237, v175, v171
    v_fma_f32 v238, v238, v175, v171
    v_mfma_f32_16x16x32_bf16 v[4:7], v[224:227], a[180:183], v[4:7]
    v_fma_f32 v239, v239, v175, v171
    v_mul_f32 v236, v236, v88
    v_mfma_f32_16x16x32_bf16 v[8:11], v[224:227], a[184:187], v[8:11]
    ds_read_b64_tr_b16 v[216:217], v181 offset:6144
    v_mul_f32 v237, v237, v89
    v_mul_f32 v238, v238, v90
    v_mfma_f32_16x16x32_bf16 v[12:15], v[224:227], a[188:191], v[12:15]
    ds_read_b64_tr_b16 v[218:219], v181 offset:13312
    v_mul_f32 v239, v239, v91
    v_exp_f32 v236, v236
    v_mfma_f32_16x16x32_bf16 v[196:199], v[228:231], v[144:147], v[196:199]
    v_exp_f32 v237, v237
    v_mfma_f32_16x16x32_bf16 v[16:19], v[228:231], a[176:179], v[16:19]
    buffer_load_dwordx4 v250, s[12:15], s32 offen offset:2048 lds
    v_mfma_f32_16x16x32_bf16 v[20:23], v[228:231], a[180:183], v[20:23]
    v_exp_f32 v238, v238
    v_exp_f32 v239, v239
    v_mfma_f32_16x16x32_bf16 v[24:27], v[228:231], a[184:187], v[24:27]
    ds_read_b64_tr_b16 v[220:221], v182 offset:6144
    v_mul_f32 v92, v92, v88
    v_mfma_f32_16x16x32_bf16 v[28:31], v[228:231], a[188:191], v[28:31]
    s_waitcnt lgkmcnt(3)
    ds_read_b64_tr_b16 v[222:223], v182 offset:13312
    v_mul_f32 v93, v93, v89
    v_mul_f32 v94, v94, v90
    v_mfma_f32_16x16x32_bf16 v[192:195], v[208:211], v[144:147], v[192:195]
    v_mul_f32 v95, v95, v91
    v_fma_f32 v236, v236, v179, v179
    v_mfma_f32_16x16x32_bf16 v[0:3], v[208:211], a[192:195], v[0:3]
    v_fma_f32 v237, v237, v179, v179
    v_fma_f32 v238, v238, v179, v179
    v_mfma_f32_16x16x32_bf16 v[4:7], v[208:211], a[196:199], v[4:7]
    s_waitcnt vmcnt(9)
    v_fma_f32 v239, v239, v179, v179
    s_barrier
    v_mfma_f32_16x16x32_bf16 v[8:11], v[208:211], a[200:203], v[8:11]
    ds_read_b128 a[64:67], v187 offset:33280
    v_rcp_f32 v236, v236
    v_mfma_f32_16x16x32_bf16 v[12:15], v[208:211], a[204:207], v[12:15]
    ds_read_b128 a[68:71], v187 offset:34304
    v_rcp_f32 v237, v237
    ds_read_b128 v[224:227], v248 offset:33088
    v_mfma_f32_16x16x32_bf16 v[196:199], v[212:215], v[144:147], v[196:199]
    buffer_load_dwordx4 v250, s[12:15], s32 offen offset:3072 lds
    ds_read_b128 a[72:75], v188 offset:33280
    ds_read_b128 a[76:79], v188 offset:34304
    ds_read_b128 a[80:83], v187 offset:41472
    v_mfma_f32_16x16x32_bf16 v[16:19], v[212:215], a[192:195], v[16:19]
    ds_read_b128 a[84:87], v187 offset:42496
    ds_read_b128 a[88:91], v188 offset:41472
    ds_read_b128 a[92:95], v188 offset:42496
    v_mfma_f32_16x16x32_bf16 v[20:23], v[212:215], a[196:199], v[20:23]
    ds_read_b128 v[208:211], v248 offset:35136
    v_rcp_f32 v238, v238
    v_mfma_f32_16x16x32_bf16 v[24:27], v[212:215], a[200:203], v[24:27]
    v_rcp_f32 v239, v239
    v_mfma_f32_16x16x32_bf16 v[28:31], v[212:215], a[204:207], v[28:31]
    s_waitcnt lgkmcnt(10)
    v_mul_f32 v236, v236, v92
    v_mul_f32 v237, v237, v93
    v_mfma_f32_16x16x32_bf16 v[192:195], v[216:219], v[144:147], v[192:195]
    s_add_u32 m0, s35, 0
    v_mul_f32 v238, v238, v94
    v_mul_f32 v239, v239, v95
    v_mfma_f32_16x16x32_bf16 v[0:3], v[216:219], a[208:211], v[0:3]
    s_add_u32 s33, s39, s31
    buffer_load_dwordx4 v250, s[16:19], s33 offen offset:0 lds
    v_cvt_pk_bf16_f32 v88, v236, v237
    v_mfma_f32_16x16x32_bf16 v[4:7], v[216:219], a[212:215], v[4:7]
    s_mov_b32 s3, 0
    ds_read_b128 v[212:215], v248 offset:33216
    v_cvt_pk_bf16_f32 v89, v238, v239
    v_mfma_f32_16x16x32_bf16 v[8:11], v[216:219], a[216:219], v[8:11]
    s_add_u32 s3, s3, s53
    buffer_store_dwordx2 v[88:89], v189, s[20:23], s87 offen offset:1024
    s_add_u32 s3, s3, 3
    v_mfma_f32_16x16x32_bf16 v[12:15], v[216:219], a[220:223], v[12:15]
    s_lshr_b32 s34, s3, 1
    s_lshl_b32 s34, s34, 12
    s_and_b32 s3, s3, 1
    s_lshl_b32 s3, s3, 3
    s_add_u32 s34, s34, s3
    s_add_u32 s86, s34, s54
    s_add_u32 s87, s34, s55
    v_fmac_f32 v96, v200, v160
    v_mfma_f32_16x16x32_bf16 v[196:199], v[220:223], v[144:147], v[196:199]
    ds_read_b128 v[216:219], v248 offset:35264
    v_fmac_f32 v97, v201, v160
    v_fmac_f32 v98, v202, v160
    v_mfma_f32_16x16x32_bf16 v[16:19], v[220:223], a[208:211], v[16:19]
    v_fmac_f32 v99, v203, v160
    v_fmac_f32 v100, v204, v160
    v_fmac_f32 v101, v205, v160
    v_mfma_f32_16x16x32_bf16 v[20:23], v[220:223], a[212:215], v[20:23]
    s_add_u32 s39, s39, 16384
    buffer_load_dwordx4 v250, s[16:19], s33 offen offset:1024 lds
    v_fmac_f32 v102, v206, v160
    v_fmac_f32 v103, v207, v160
    v_mfma_f32_16x16x32_bf16 v[24:27], v[220:223], a[216:219], v[24:27]
    v_fmac_f32 v104, v200, v161
    v_fmac_f32 v105, v201, v161
    v_mfma_f32_16x16x32_bf16 v[28:31], v[220:223], a[220:223], v[28:31]
    s_waitcnt lgkmcnt(2)
    ds_read_b128 v[220:223], v248 offset:33344
    v_fmac_f32 v106, v202, v161
    v_mfma_f32_16x16x32_bf16 v[32:35], v[224:227], a[0:3], 0
    v_fmac_f32 v107, v203, v161
    v_fmac_f32 v108, v204, v161
    v_fmac_f32 v109, v205, v161
    v_mfma_f32_16x16x32_bf16 v[36:39], v[224:227], a[4:7], 0
    v_fmac_f32 v110, v206, v161
    v_fmac_f32 v111, v207, v161
    v_mfma_f32_16x16x32_bf16 v[40:43], v[224:227], a[8:11], 0
    v_mul_f32 v232, v96, v96
    v_mul_f32 v233, v97, v97
    v_mfma_f32_16x16x32_bf16 v[44:47], v[224:227], a[12:15], 0
    ds_read_b128 v[224:227], v248 offset:35392
    v_mul_f32 v234, v98, v98
    v_mul_f32 v235, v99, v99
    v_mfma_f32_16x16x32_bf16 v[48:51], v[208:211], a[0:3], 0
    s_and_b32 s39, s39, 0x7ffff
    buffer_load_dwordx4 v250, s[16:19], s33 offen offset:2048 lds
    v_fmac_f32 v0, v192, v160
    v_fmac_f32 v1, v193, v160
    v_fmac_f32 v2, v194, v160
    v_mfma_f32_16x16x32_bf16 v[52:55], v[208:211], a[4:7], 0
    v_fmac_f32 v3, v195, v160
    v_mul_f32 v0, v164, v0
    v_mul_f32 v1, v164, v1
    v_fma_f32 v232, v232, v172, v168
    v_mfma_f32_16x16x32_bf16 v[56:59], v[208:211], a[8:11], 0
    v_mul_f32 v2, v164, v2
    v_mul_f32 v3, v164, v3
    v_mfma_f32_16x16x32_bf16 v[60:63], v[208:211], a[12:15], 0
    s_waitcnt lgkmcnt(2)
    v_cvt_pk_bf16_f32 v0, v0, v1
    v_cvt_pk_bf16_f32 v1, v2, v3
    v_fma_f32 v233, v233, v172, v168
    ds_write_b64 v183, v[0:1] offset:49664
    v_mfma_f32_16x16x32_bf16 v[32:35], v[212:215], a[16:19], v[32:35]
    ds_read_b128 v[208:211], v248 offset:33472
    v_fmac_f32 v4, v192, v161
    v_fmac_f32 v5, v193, v161
    v_fma_f32 v234, v234, v172, v168
    v_mfma_f32_16x16x32_bf16 v[36:39], v[212:215], a[20:23], v[36:39]
    v_fmac_f32 v6, v194, v161
    v_fmac_f32 v7, v195, v161
    v_mul_f32 v4, v165, v4
    v_mfma_f32_16x16x32_bf16 v[40:43], v[212:215], a[24:27], v[40:43]
    v_mul_f32 v5, v165, v5
    v_mul_f32 v6, v165, v6
    v_mul_f32 v7, v165, v7
    v_fma_f32 v235, v235, v172, v168
    v_cvt_pk_bf16_f32 v4, v4, v5
    v_cvt_pk_bf16_f32 v5, v6, v7
    ds_write_b64 v183, v[4:5] offset:50688
    v_mfma_f32_16x16x32_bf16 v[44:47], v[212:215], a[28:31], v[44:47]
    buffer_load_dwordx4 v250, s[16:19], s33 offen offset:3072 lds
    v_fmac_f32 v8, v192, v162
    v_mfma_f32_16x16x32_bf16 v[48:51], v[216:219], a[16:19], v[48:51]
    ds_read_b128 v[212:215], v248 offset:35520
    v_fmac_f32 v9, v193, v162
    v_fmac_f32 v10, v194, v162
    v_mul_f32 v232, v232, v96
    v_mfma_f32_16x16x32_bf16 v[52:55], v[216:219], a[20:23], v[52:55]
    v_fmac_f32 v11, v195, v162
    v_mul_f32 v8, v166, v8
    v_mfma_f32_16x16x32_bf16 v[56:59], v[216:219], a[24:27], v[56:59]
    v_mul_f32 v9, v166, v9
    v_mul_f32 v10, v166, v10
    v_mul_f32 v11, v166, v11
    v_mul_f32 v233, v233, v97
    v_cvt_pk_bf16_f32 v8, v8, v9
    v_cvt_pk_bf16_f32 v9, v10, v11
    ds_write_b64 v184, v[8:9] offset:49664
    v_mfma_f32_16x16x32_bf16 v[60:63], v[216:219], a[28:31], v[60:63]
    s_waitcnt lgkmcnt(5)
    ds_read_b128 v[216:219], v248 offset:33600
    v_mul_f32 v234, v234, v98
    v_mfma_f32_16x16x32_bf16 v[32:35], v[220:223], a[32:35], v[32:35]
    v_fmac_f32 v12, v192, v163
    v_fmac_f32 v13, v193, v163
    v_fmac_f32 v14, v194, v163
    v_mfma_f32_16x16x32_bf16 v[36:39], v[220:223], a[36:39], v[36:39]
    v_fmac_f32 v15, v195, v163
    v_mul_f32 v12, v167, v12
    v_mul_f32 v13, v167, v13
    v_mul_f32 v235, v235, v99
    v_mfma_f32_16x16x32_bf16 v[40:43], v[220:223], a[40:43], v[40:43]
    s_add_u32 m0, s35, 4128
    s_add_u32 s33, s33, 4096
    v_mul_f32 v14, v167, v14
    v_mul_f32 v15, v167, v15
    v_cvt_pk_bf16_f32 v12, v12, v13
    v_cvt_pk_bf16_f32 v13, v14, v15
    ds_write_b64 v184, v[12:13] offset:50688
    v_mfma_f32_16x16x32_bf16 v[44:47], v[220:223], a[44:47], v[44:47]
    buffer_load_dwordx4 v250, s[16:19], s33 offen offset:0 lds
    v_fmac_f32 v16, v196, v160
    v_exp_f32 v232, v232
    v_mfma_f32_16x16x32_bf16 v[48:51], v[224:227], a[32:35], v[48:51]
    ds_read_b128 v[220:223], v248 offset:35648
    v_fmac_f32 v17, v197, v160
    v_mfma_f32_16x16x32_bf16 v[52:55], v[224:227], a[36:39], v[52:55]
    v_fmac_f32 v18, v198, v160
    v_fmac_f32 v19, v199, v160
    v_mul_f32 v16, v164, v16
    v_mfma_f32_16x16x32_bf16 v[56:59], v[224:227], a[40:43], v[56:59]
    v_mul_f32 v17, v164, v17
    v_mul_f32 v18, v164, v18
    v_mul_f32 v19, v164, v19
    v_exp_f32 v233, v233
    v_cvt_pk_bf16_f32 v16, v16, v17
    v_cvt_pk_bf16_f32 v17, v18, v19
    ds_write_b64 v185, v[16:17] offset:49664
    v_mfma_f32_16x16x32_bf16 v[60:63], v[224:227], a[44:47], v[60:63]
    s_waitcnt lgkmcnt(5)
    ds_read_b128 v[224:227], v248 offset:33728
    v_fmac_f32 v20, v196, v161
    v_mfma_f32_16x16x32_bf16 v[32:35], v[208:211], a[48:51], v[32:35]
    v_fmac_f32 v21, v197, v161
    v_fmac_f32 v22, v198, v161
    v_mfma_f32_16x16x32_bf16 v[36:39], v[208:211], a[52:55], v[36:39]
    buffer_load_dwordx4 v250, s[16:19], s33 offen offset:1024 lds
    v_fmac_f32 v23, v199, v161
    v_mul_f32 v20, v165, v20
    v_mul_f32 v21, v165, v21
    v_mfma_f32_16x16x32_bf16 v[40:43], v[208:211], a[56:59], v[40:43]
    v_mul_f32 v22, v165, v22
    v_mul_f32 v23, v165, v23
    v_cvt_pk_bf16_f32 v20, v20, v21
    v_exp_f32 v234, v234
    v_cvt_pk_bf16_f32 v21, v22, v23
    ds_write_b64 v185, v[20:21] offset:50688
    v_mfma_f32_16x16x32_bf16 v[44:47], v[208:211], a[60:63], v[44:47]
    ds_read_b128 v[208:211], v248 offset:35776
    v_fmac_f32 v24, v196, v162
    v_mfma_f32_16x16x32_bf16 v[48:51], v[212:215], a[48:51], v[48:51]
    v_fmac_f32 v25, v197, v162
    v_fmac_f32 v26, v198, v162
    v_mfma_f32_16x16x32_bf16 v[52:55], v[212:215], a[52:55], v[52:55]
    v_fmac_f32 v27, v199, v162
    v_mul_f32 v24, v166, v24
    v_mul_f32 v25, v166, v25
    v_exp_f32 v235, v235
    v_mfma_f32_16x16x32_bf16 v[56:59], v[212:215], a[56:59], v[56:59]
    v_mul_f32 v26, v166, v26
    v_mul_f32 v27, v166, v27
    v_cvt_pk_bf16_f32 v24, v24, v25
    v_cvt_pk_bf16_f32 v25, v26, v27
    ds_write_b64 v186, v[24:25] offset:49664
    v_mfma_f32_16x16x32_bf16 v[60:63], v[212:215], a[60:63], v[60:63]
    s_waitcnt lgkmcnt(5)
    ds_read_b128 v[212:215], v248 offset:33856
    v_fmac_f32 v28, v196, v163
    v_mfma_f32_16x16x32_bf16 v[32:35], v[216:219], a[64:67], v[32:35]
    buffer_load_dwordx4 v250, s[16:19], s33 offen offset:2048 lds
    v_fmac_f32 v29, v197, v163
    v_fmac_f32 v30, v198, v163
    v_fmac_f32 v31, v199, v163
    v_mfma_f32_16x16x32_bf16 v[36:39], v[216:219], a[68:71], v[36:39]
    v_mul_f32 v28, v167, v28
    v_mul_f32 v29, v167, v29
    v_mul_f32 v30, v167, v30
    v_mul_f32 v100, v100, v96
    v_mfma_f32_16x16x32_bf16 v[40:43], v[216:219], a[72:75], v[40:43]
    v_mul_f32 v31, v167, v31
    v_cvt_pk_bf16_f32 v28, v28, v29
    v_cvt_pk_bf16_f32 v29, v30, v31
    ds_write_b64 v186, v[28:29] offset:50688
    v_mfma_f32_16x16x32_bf16 v[44:47], v[216:219], a[76:79], v[44:47]
    s_waitcnt lgkmcnt(0)
    v_mul_f32 v101, v101, v97
    v_mul_f32 v102, v102, v98
    v_mfma_f32_16x16x32_bf16 v[48:51], v[220:223], a[64:67], v[48:51]
    s_waitcnt vmcnt(8)
    s_barrier
    ds_read_b128 a[96:99], v187 offset:49664
    ds_read_b128 a[100:103], v187 offset:50688
    ds_read_b128 a[104:107], v188 offset:49664
    ds_read_b128 a[108:111], v188 offset:50688
    ds_read_b128 v[216:219], v248 offset:35904
    v_mfma_f32_16x16x32_bf16 v[52:55], v[220:223], a[68:71], v[52:55]
    ds_read_b128 a[112:115], v187 offset:57856
    ds_read_b128 a[116:119], v187 offset:58880
    ds_read_b128 a[120:123], v188 offset:57856
    ds_read_b128 a[124:127], v188 offset:58880
    v_mfma_f32_16x16x32_bf16 v[56:59], v[220:223], a[72:75], v[56:59]
    v_mul_f32 v103, v103, v99
    v_fma_f32 v232, v232, v176, v176
    v_mfma_f32_16x16x32_bf16 v[60:63], v[220:223], a[76:79], v[60:63]
    buffer_load_dwordx4 v250, s[16:19], s33 offen offset:3072 lds
    v_fma_f32 v233, v233, v176, v176
    v_mfma_f32_16x16x32_bf16 v[32:35], v[224:227], a[80:83], v[32:35]
    ds_read_b128 v[220:223], v248 offset:33984
    v_fma_f32 v234, v234, v176, v176
    v_fma_f32 v235, v235, v176, v176
    v_rcp_f32 v232, v232
    v_mfma_f32_16x16x32_bf16 v[36:39], v[224:227], a[84:87], v[36:39]
    v_rcp_f32 v233, v233
    v_mfma_f32_16x16x32_bf16 v[40:43], v[224:227], a[88:91], v[40:43]
    v_rcp_f32 v234, v234
    v_mfma_f32_16x16x32_bf16 v[44:47], v[224:227], a[92:95], v[44:47]
    ds_read_b128 v[224:227], v248 offset:36032
    v_rcp_f32 v235, v235
    v_mfma_f32_16x16x32_bf16 v[48:51], v[208:211], a[80:83], v[48:51]
    v_mul_f32 v232, v232, v100
    v_mul_f32 v233, v233, v101
    v_mfma_f32_16x16x32_bf16 v[52:55], v[208:211], a[84:87], v[52:55]
    v_mul_f32 v234, v234, v102
    v_mul_f32 v235, v235, v103
    v_mfma_f32_16x16x32_bf16 v[56:59], v[208:211], a[88:91], v[56:59]
    v_cvt_pk_bf16_f32 v96, v232, v233
    v_cvt_pk_bf16_f32 v97, v234, v235
    v_mfma_f32_16x16x32_bf16 v[60:63], v[208:211], a[92:95], v[60:63]
    s_waitcnt lgkmcnt(6)
    buffer_store_dwordx2 v[96:97], v189, s[20:23], s86 offen offset:0
    v_mul_f32 v236, v104, v104
    v_mfma_f32_16x16x32_bf16 v[32:35], v[212:215], a[96:99], v[32:35]
    ds_read_b128 v[208:211], v248 offset:0
    v_mul_f32 v237, v105, v105
    v_mul_f32 v238, v106, v106
    v_mfma_f32_16x16x32_bf16 v[36:39], v[212:215], a[100:103], v[36:39]
    v_mul_f32 v239, v107, v107
    v_fma_f32 v236, v236, v173, v169
    v_mfma_f32_16x16x32_bf16 v[40:43], v[212:215], a[104:107], v[40:43]
    v_fma_f32 v237, v237, v173, v169
    v_fma_f32 v238, v238, v173, v169
    v_fma_f32 v239, v239, v173, v169
    v_mfma_f32_16x16x32_bf16 v[44:47], v[212:215], a[108:111], v[44:47]
    ds_read_b128 v[212:215], v248 offset:128
    v_mul_f32 v236, v236, v104
    v_mul_f32 v237, v237, v105
    v_mfma_f32_16x16x32_bf16 v[48:51], v[216:219], a[96:99], v[48:51]
    v_mul_f32 v238, v238, v106
    v_mul_f32 v239, v239, v107
    v_exp_f32 v236, v236
    v_mfma_f32_16x16x32_bf16 v[52:55], v[216:219], a[100:103], v[52:55]
    v_exp_f32 v237, v237
    v_mfma_f32_16x16x32_bf16 v[56:59], v[216:219], a[104:107], v[56:59]
    v_exp_f32 v238, v238
    v_mfma_f32_16x16x32_bf16 v[60:63], v[216:219], a[108:111], v[60:63]
    s_waitcnt lgkmcnt(2)
    ds_read_b128 v[216:219], v248 offset:256
    v_exp_f32 v239, v239
    v_mfma_f32_16x16x32_bf16 v[32:35], v[220:223], a[112:115], v[32:35]
    v_mul_f32 v108, v108, v104
    v_mul_f32 v109, v109, v105
    v_mul_f32 v110, v110, v106
    v_mfma_f32_16x16x32_bf16 v[36:39], v[220:223], a[116:119], v[36:39]
    v_mul_f32 v111, v111, v107
    v_fma_f32 v236, v236, v177, v177
    v_mfma_f32_16x16x32_bf16 v[40:43], v[220:223], a[120:123], v[40:43]
    v_fma_f32 v237, v237, v177, v177
    v_fma_f32 v238, v238, v177, v177
    v_mfma_f32_16x16x32_bf16 v[44:47], v[220:223], a[124:127], v[44:47]
    ds_read_b128 v[220:223], v248 offset:384
    v_fma_f32 v239, v239, v177, v177
    v_rcp_f32 v236, v236
    v_mfma_f32_16x16x32_bf16 v[48:51], v[224:227], a[112:115], v[48:51]
    v_rcp_f32 v237, v237
    v_mfma_f32_16x16x32_bf16 v[52:55], v[224:227], a[116:119], v[52:55]
    v_rcp_f32 v238, v238
    v_rcp_f32 v239, v239
    v_mfma_f32_16x16x32_bf16 v[56:59], v[224:227], a[120:123], v[56:59]
    v_mul_f32 v236, v236, v108
    v_mul_f32 v237, v237, v109
    v_mfma_f32_16x16x32_bf16 v[60:63], v[224:227], a[124:127], v[60:63]
    s_waitcnt lgkmcnt(2)
    v_mul_f32 v238, v238, v110
    v_mul_f32 v239, v239, v111
    v_mfma_f32_16x16x32_bf16 v[128:131], v[208:211], a[0:3], 0
    v_cvt_pk_bf16_f32 v104, v236, v237
    v_cvt_pk_bf16_f32 v105, v238, v239
    buffer_store_dwordx2 v[104:105], v189, s[20:23], s86 offen offset:1024
    s_barrier
    ds_read_b128 v[224:227], v248 offset:512
    v_mfma_f32_16x16x32_bf16 v[132:135], v[208:211], a[4:7], 0
    s_add_u32 m0, s35, 130752
    v_and_b32 v64, 15, v255
    s_add_u32 s32, s30, s31
    v_mfma_f32_16x16x32_bf16 v[136:139], v[208:211], a[8:11], 0
    s_add_u32 s30, s30, 16384
    buffer_load_dwordx4 v250, s[12:15], s32 offen offset:0 lds
    v_lshlrev_b32 v64, 4, v64
    v_mfma_f32_16x16x32_bf16 v[140:143], v[208:211], a[12:15], 0
    buffer_load_dwordx4 v250, s[12:15], s32 offen offset:1024 lds
    v_lshl_add_u32 v64, s24, 8, v64
    v_add_u32 v64, 96384, v64
    v_max3_f32 v236, v32, v33, v34
    v_mfma_f32_16x16x32_bf16 v[128:131], v[212:215], a[16:19], v[128:131]
    s_and_b32 s30, s30, 0x7ffff
    ds_read_b128 v[228:231], v248 offset:640
    v_max3_f32 v237, v36, v37, v38
    v_max3_f32 v238, v40, v41, v42
    v_mfma_f32_16x16x32_bf16 v[132:135], v[212:215], a[20:23], v[132:135]
    buffer_load_dwordx4 v250, s[12:15], s32 offen offset:2048 lds
    v_max3_f32 v239, v44, v45, v46
    v_max3_f32 v236, v236, v35, v48
    v_max3_f32 v237, v237, v39, v52
    v_mfma_f32_16x16x32_bf16 v[136:139], v[212:215], a[24:27], v[136:139]
    buffer_load_dwordx4 v250, s[12:15], s32 offen offset:3072 lds
    v_max3_f32 v238, v238, v43, v56
    v_max3_f32 v239, v239, v47, v60
    v_mfma_f32_16x16x32_bf16 v[140:143], v[212:215], a[28:31], v[140:143]
    s_waitcnt lgkmcnt(2)
    ds_read_b128 v[208:211], v248 offset:768
    v_max3_f32 v236, v236, v49, v50
    v_max3_f32 v237, v237, v53, v54
    v_max3_f32 v238, v238, v57, v58
    v_max3_f32 v239, v239, v61, v62
    v_mfma_f32_16x16x32_bf16 v[128:131], v[216:219], a[32:35], v[128:131]
    s_add_u32 m0, s35, 134880
    v_max_f32 v236, v236, v51
    v_max_f32 v237, v237, v55
    v_max_f32 v238, v238, v59
    v_mfma_f32_16x16x32_bf16 v[132:135], v[216:219], a[36:39], v[132:135]
    s_add_u32 s32, s32, 4096
    buffer_load_dwordx4 v250, s[12:15], s32 offen offset:0 lds
    v_max_f32 v239, v239, v63
    v_mov_b32 v240, v236
    v_mfma_f32_16x16x32_bf16 v[136:139], v[216:219], a[40:43], v[136:139]
    buffer_load_dwordx4 v250, s[12:15], s32 offen offset:1024 lds
    v_mov_b32 v241, v237
    v_mfma_f32_16x16x32_bf16 v[140:143], v[216:219], a[44:47], v[140:143]
    ds_read_b128 v[212:215], v248 offset:896
    v_mov_b32 v242, v238
    v_mov_b32 v243, v239
    v_permlane32_swap_b32 v236, v240
    v_permlane32_swap_b32 v237, v241
    v_mfma_f32_16x16x32_bf16 v[128:131], v[220:223], a[48:51], v[128:131]
    buffer_load_dwordx4 v250, s[12:15], s32 offen offset:2048 lds
    v_permlane32_swap_b32 v238, v242
    v_permlane32_swap_b32 v239, v243
    v_max_f32 v236, v236, v240
    v_mfma_f32_16x16x32_bf16 v[132:135], v[220:223], a[52:55], v[132:135]
    v_max_f32 v237, v237, v241
    v_max_f32 v238, v238, v242
    v_max_f32 v239, v239, v243
    v_mfma_f32_16x16x32_bf16 v[136:139], v[220:223], a[56:59], v[136:139]
    buffer_load_dwordx4 v250, s[12:15], s32 offen offset:3072 lds
    v_mov_b32 v240, v236
    v_mov_b32 v241, v237
    v_mov_b32 v242, v238
    v_mov_b32 v243, v239
    v_permlane16_swap_b32 v236, v240
    v_permlane16_swap_b32 v237, v241
    v_permlane16_swap_b32 v238, v242
    v_permlane16_swap_b32 v239, v243
    v_max_f32 v236, v236, v240
    v_max_f32 v237, v237, v241
    v_max_f32 v238, v238, v242
    v_max_f32 v239, v239, v243
    ds_write_b128 v64, v[236:239]
    v_mfma_f32_16x16x32_bf16 v[140:143], v[220:223], a[60:63], v[140:143]
    s_waitcnt lgkmcnt(3)
    ds_read_b128 v[216:219], v248 offset:2048
    v_subrev_u32 v64, 96384, v64
    v_mfma_f32_16x16x32_bf16 v[128:131], v[224:227], a[64:67], v[128:131]
    v_xor_b32 v64, 0x100, v64
    v_add_u32 v64, 96384, v64
    v_mfma_f32_16x16x32_bf16 v[132:135], v[224:227], a[68:71], v[132:135]
    s_waitcnt lgkmcnt(1)
    v_lshrrev_b32_e64 v65, 23, s38
    v_sub_u32 v65, 191, v65
    v_mfma_f32_16x16x32_bf16 v[136:139], v[224:227], a[72:75], v[136:139]
    s_waitcnt vmcnt(10)
    v_cvt_f32_u32 v65, v65
    s_barrier
    v_mfma_f32_16x16x32_bf16 v[140:143], v[224:227], a[76:79], v[140:143]
    s_add_u32 m0, s35, 33088
    ds_read_b128 v[68:71], v64
    s_add_u32 s33, s39, s31
    v_mfma_f32_16x16x32_bf16 v[128:131], v[228:231], a[80:83], v[128:131]
    s_add_u32 s39, s39, 16384
    buffer_load_dwordx4 v250, s[16:19], s33 offen offset:0 lds
    buffer_load_dwordx4 v250, s[16:19], s33 offen offset:1024 lds
    ds_read_b128 v[220:223], v248 offset:2176
    v_mfma_f32_16x16x32_bf16 v[132:135], v[228:231], a[84:87], v[132:135]
    s_and_b32 s39, s39, 0x7ffff
    buffer_load_dwordx4 v250, s[16:19], s33 offen offset:2048 lds
    buffer_load_dwordx4 v250, s[16:19], s33 offen offset:3072 lds
    v_mfma_f32_16x16x32_bf16 v[136:139], v[228:231], a[88:91], v[136:139]
    s_add_u32 m0, s35, 37216
    s_add_u32 s33, s33, 4096
    s_waitcnt lgkmcnt(1)
    v_mfma_f32_16x16x32_bf16 v[140:143], v[228:231], a[92:95], v[140:143]
    buffer_load_dwordx4 v250, s[16:19], s33 offen offset:0 lds
    v_max_f32 v236, v236, v70
    v_mfma_f32_16x16x32_bf16 v[128:131], v[208:211], a[96:99], v[128:131]
    buffer_load_dwordx4 v250, s[16:19], s33 offen offset:1024 lds
    v_max_f32 v237, v237, v71
    v_max_f32 v238, v238, v68
    ds_read_b128 v[224:227], v248 offset:2304
    v_mfma_f32_16x16x32_bf16 v[132:135], v[208:211], a[100:103], v[132:135]
    buffer_load_dwordx4 v250, s[16:19], s33 offen offset:2048 lds
    v_max_f32 v239, v239, v69
    v_mfma_f32_16x16x32_bf16 v[136:139], v[208:211], a[104:107], v[136:139]
    buffer_load_dwordx4 v250, s[16:19], s33 offen offset:3072 lds
    v_sub_f32_e64 v192, -v65, v236
    v_sub_f32_e64 v193, -v65, v236
    v_sub_f32_e64 v194, -v65, v236
    v_mfma_f32_16x16x32_bf16 v[140:143], v[208:211], a[108:111], v[140:143]
    ds_read_b128 v[228:231], v248 offset:2432
    v_sub_f32_e64 v195, -v65, v236
    v_sub_f32_e64 v196, -v65, v237
    v_sub_f32_e64 v197, -v65, v237
    v_sub_f32_e64 v198, -v65, v237
    v_mfma_f32_16x16x32_bf16 v[128:131], v[212:215], a[112:115], v[128:131]
    v_sub_f32_e64 v199, -v65, v237
    v_sub_f32_e64 v200, -v65, v238
    v_sub_f32_e64 v201, -v65, v238
    v_sub_f32_e64 v202, -v65, v238
    v_mfma_f32_16x16x32_bf16 v[132:135], v[212:215], a[116:119], v[132:135]
    v_sub_f32_e64 v203, -v65, v238
    v_sub_f32_e64 v204, -v65, v239
    v_sub_f32_e64 v205, -v65, v239
    v_mfma_f32_16x16x32_bf16 v[136:139], v[212:215], a[120:123], v[136:139]
    v_sub_f32_e64 v206, -v65, v239
    v_sub_f32_e64 v207, -v65, v239
    v_mfma_f32_16x16x32_bf16 v[140:143], v[212:215], a[124:127], v[140:143]
    s_waitcnt lgkmcnt(2)
    ds_read_b128 v[208:211], v248 offset:2560
    v_add_f32 v32, v32, v192
    v_mfma_f32_16x16x32_bf16 v[144:147], v[216:219], a[0:3], v[192:195]
    v_add_f32 v33, v33, v193
    v_add_f32 v34, v34, v194
    v_mfma_f32_16x16x32_bf16 v[148:151], v[216:219], a[4:7], v[196:199]
    v_add_f32 v35, v35, v195
    v_mfma_f32_16x16x32_bf16 v[152:155], v[216:219], a[8:11], v[200:203]
    v_exp_f32 v240, v32
    v_exp_f32 v241, v33
    v_mfma_f32_16x16x32_bf16 v[156:159], v[216:219], a[12:15], v[204:207]
    ds_read_b128 v[212:215], v248 offset:2688
    v_exp_f32 v242, v34
    v_exp_f32 v243, v35
    v_add_f32 v48, v48, v192
    v_mfma_f32_16x16x32_bf16 v[144:147], v[220:223], a[16:19], v[144:147]
    v_add_f32 v49, v49, v193
    v_add_f32 v50, v50, v194
    v_add_f32 v51, v51, v195
    v_exp_f32 v244, v48
    v_mfma_f32_16x16x32_bf16 v[148:151], v[220:223], a[20:23], v[148:151]
    v_cvt_pk_bf16_f32 v160, v240, v241
    v_add_f32 v240, v240, v241
    v_exp_f32 v245, v49
    v_mfma_f32_16x16x32_bf16 v[152:155], v[220:223], a[24:27], v[152:155]
    v_cvt_pk_bf16_f32 v161, v242, v243
    v_add_f32 v242, v242, v243
    v_exp_f32 v246, v50
    v_add_f32 v232, v240, v242
    v_mfma_f32_16x16x32_bf16 v[156:159], v[220:223], a[28:31], v[156:159]
    s_waitcnt lgkmcnt(2)
    ds_read_b128 v[216:219], v248 offset:2816
    v_exp_f32 v247, v51
    v_add_f32 v36, v36, v196
    v_add_f32 v37, v37, v197
    v_add_f32 v38, v38, v198
    v_mfma_f32_16x16x32_bf16 v[144:147], v[224:227], a[32:35], v[144:147]
    s_mov_b32 m0, 97408
    v_add_f32 v39, v39, v199
    v_exp_f32 v240, v36
    v_cvt_pk_bf16_f32 v162, v244, v245
    v_add_f32 v244, v244, v245
    v_mfma_f32_16x16x32_bf16 v[148:151], v[224:227], a[36:39], v[148:151]
    s_add_u32 s92, s92, 32768
    buffer_load_dword v250, s[96:99], s92 offen lds
    v_mfma_f32_16x16x32_bf16 v[152:155], v[224:227], a[40:43], v[152:155]
    v_exp_f32 v241, v37
    v_cvt_pk_bf16_f32 v163, v246, v247
    v_add_f32 v246, v246, v247
    v_mfma_f32_16x16x32_bf16 v[156:159], v[224:227], a[44:47], v[156:159]
    ds_read_b128 v[220:223], v248 offset:2944
    v_exp_f32 v242, v38
    v_add_f32 v244, v244, v246
    v_add_f32 v232, v232, v244
    v_mfma_f32_16x16x32_bf16 v[144:147], v[228:231], a[48:51], v[144:147]
    v_exp_f32 v243, v39
    v_add_f32 v52, v52, v196
    v_add_f32 v53, v53, v197
    v_add_f32 v54, v54, v198
    v_mfma_f32_16x16x32_bf16 v[148:151], v[228:231], a[52:55], v[148:151]
    v_add_f32 v55, v55, v199
    v_exp_f32 v244, v52
    v_cvt_pk_bf16_f32 v164, v240, v241
    v_mfma_f32_16x16x32_bf16 v[152:155], v[228:231], a[56:59], v[152:155]
    v_add_f32 v240, v240, v241
    v_exp_f32 v245, v53
    v_cvt_pk_bf16_f32 v165, v242, v243
    v_add_f32 v242, v242, v243
    v_mfma_f32_16x16x32_bf16 v[156:159], v[228:231], a[60:63], v[156:159]
    s_waitcnt lgkmcnt(2)
    ds_read_b64_tr_b16 v[224:225], v249 offset:0
    v_exp_f32 v246, v54
    v_add_f32 v233, v240, v242
    v_exp_f32 v247, v55
    v_mfma_f32_16x16x32_bf16 v[144:147], v[208:211], a[64:67], v[144:147]
    ds_read_b64_tr_b16 v[226:227], v249 offset:2048
    v_add_f32 v40, v40, v200
    v_add_f32 v41, v41, v201
    v_add_f32 v42, v42, v202
    v_add_f32 v43, v43, v203
    v_mfma_f32_16x16x32_bf16 v[148:151], v[208:211], a[68:71], v[148:151]
    v_exp_f32 v240, v40
    v_cvt_pk_bf16_f32 v166, v244, v245
    v_mfma_f32_16x16x32_bf16 v[152:155], v[208:211], a[72:75], v[152:155]
    v_add_f32 v244, v244, v245
    v_exp_f32 v241, v41
    v_cvt_pk_bf16_f32 v167, v246, v247
    v_mfma_f32_16x16x32_bf16 v[156:159], v[208:211], a[76:79], v[156:159]
    ds_read_b64_tr_b16 v[208:209], v249 offset:32
    v_add_f32 v246, v246, v247
    v_exp_f32 v242, v42
    v_add_f32 v244, v244, v246
    v_add_f32 v233, v233, v244
    v_mfma_f32_16x16x32_bf16 v[144:147], v[212:215], a[80:83], v[144:147]
    ds_read_b64_tr_b16 v[210:211], v249 offset:2080
    v_exp_f32 v243, v43
    v_add_f32 v56, v56, v200
    v_add_f32 v57, v57, v201
    v_add_f32 v58, v58, v202
    v_mfma_f32_16x16x32_bf16 v[148:151], v[212:215], a[84:87], v[148:151]
    v_add_f32 v59, v59, v203
    v_exp_f32 v244, v56
    v_cvt_pk_bf16_f32 v168, v240, v241
    v_mfma_f32_16x16x32_bf16 v[152:155], v[212:215], a[88:91], v[152:155]
    v_add_f32 v240, v240, v241
    v_exp_f32 v245, v57
    v_cvt_pk_bf16_f32 v169, v242, v243
    v_mfma_f32_16x16x32_bf16 v[156:159], v[212:215], a[92:95], v[156:159]
    s_waitcnt lgkmcnt(4)
    ds_read_b64_tr_b16 v[212:213], v249 offset:128
    v_add_f32 v242, v242, v243
    v_exp_f32 v246, v58
    v_add_f32 v234, v240, v242
    v_mfma_f32_16x16x32_bf16 v[144:147], v[216:219], a[96:99], v[144:147]
    ds_read_b64_tr_b16 v[214:215], v249 offset:2176
    v_exp_f32 v247, v59
    v_add_f32 v44, v44, v204
    v_add_f32 v45, v45, v205
    v_add_f32 v46, v46, v206
    v_mfma_f32_16x16x32_bf16 v[148:151], v[216:219], a[100:103], v[148:151]
    v_add_f32 v47, v47, v207
    v_exp_f32 v240, v44
    v_mfma_f32_16x16x32_bf16 v[152:155], v[216:219], a[104:107], v[152:155]
    v_cvt_pk_bf16_f32 v170, v244, v245
    v_add_f32 v244, v244, v245
    v_exp_f32 v241, v45
    v_mfma_f32_16x16x32_bf16 v[156:159], v[216:219], a[108:111], v[156:159]
    ds_read_b64_tr_b16 v[216:217], v249 offset:160
    v_cvt_pk_bf16_f32 v171, v246, v247
    v_add_f32 v246, v246, v247
    v_exp_f32 v242, v46
    v_add_f32 v244, v244, v246
    v_mfma_f32_16x16x32_bf16 v[144:147], v[220:223], a[112:115], v[144:147]
    ds_read_b64_tr_b16 v[218:219], v249 offset:2208
    v_add_f32 v234, v234, v244
    v_exp_f32 v243, v47
    v_add_f32 v60, v60, v204
    v_add_f32 v61, v61, v205
    v_mfma_f32_16x16x32_bf16 v[148:151], v[220:223], a[116:119], v[148:151]
    v_add_f32 v62, v62, v206
    v_add_f32 v63, v63, v207
    v_exp_f32 v244, v60
    v_mfma_f32_16x16x32_bf16 v[152:155], v[220:223], a[120:123], v[152:155]
    v_cvt_pk_bf16_f32 v172, v240, v241
    v_add_f32 v240, v240, v241
    v_exp_f32 v245, v61
    v_mfma_f32_16x16x32_bf16 v[156:159], v[220:223], a[124:127], v[156:159]
    s_waitcnt lgkmcnt(4)
    ds_read_b64_tr_b16 v[220:221], v249 offset:256
    v_cvt_pk_bf16_f32 v173, v242, v243
    v_add_f32 v242, v242, v243
    v_exp_f32 v246, v62
    v_add_f32 v235, v240, v242
    v_mfma_f32_16x16x32_bf16 v[0:3], v[224:227], v[160:163], 0
    ds_read_b64_tr_b16 v[222:223], v249 offset:2304
    v_exp_f32 v247, v63
    v_cvt_pk_bf16_f32 v174, v244, v245
    v_add_f32 v244, v244, v245
    v_cvt_pk_bf16_f32 v175, v246, v247
    v_add_f32 v246, v246, v247
    v_add_f32 v244, v244, v246
    v_add_f32 v235, v235, v244
    v_mfma_f32_16x16x32_bf16 v[64:67], v[224:227], v[164:167], 0
    v_add_f32 v128, v128, v192
    v_add_f32 v129, v129, v193
    v_mfma_f32_16x16x32_bf16 a[128:131], v[224:227], v[168:171], 0
    v_add_f32 v130, v130, v194
    v_add_f32 v131, v131, v195
    v_mfma_f32_16x16x32_bf16 a[192:195], v[224:227], v[172:175], 0
    s_barrier
    ds_read_b64_tr_b16 v[224:225], v249 offset:288
    v_exp_f32 v240, v128
    v_mfma_f32_16x16x32_bf16 v[4:7], v[208:211], v[160:163], 0
    s_add_u32 m0, s35, 97664
    ds_read_b64_tr_b16 v[226:227], v249 offset:2336
    v_exp_f32 v241, v129
    v_mfma_f32_16x16x32_bf16 v[68:71], v[208:211], v[164:167], 0
    s_add_u32 s32, s30, s31
    buffer_load_dwordx4 v250, s[12:15], s32 offen offset:0 lds
    v_mfma_f32_16x16x32_bf16 a[132:135], v[208:211], v[168:171], 0
    v_exp_f32 v242, v130
    v_mfma_f32_16x16x32_bf16 a[196:199], v[208:211], v[172:175], 0
    s_waitcnt lgkmcnt(4)
    ds_read_b64_tr_b16 v[208:209], v249 offset:384
    v_mfma_f32_16x16x32_bf16 v[8:11], v[212:215], v[160:163], 0
    s_add_u32 s30, s30, 16384
    buffer_load_dwordx4 v250, s[12:15], s32 offen offset:1024 lds
    v_exp_f32 v243, v131
    v_add_f32 v132, v132, v196
    v_mfma_f32_16x16x32_bf16 v[72:75], v[212:215], v[164:167], 0
    ds_read_b64_tr_b16 v[210:211], v249 offset:2432
    v_add_f32 v133, v133, v197
    v_mfma_f32_16x16x32_bf16 a[136:139], v[212:215], v[168:171], 0
    v_add_f32 v134, v134, v198
    v_add_f32 v135, v135, v199
    v_mfma_f32_16x16x32_bf16 a[200:203], v[212:215], v[172:175], 0
    ds_read_b64_tr_b16 v[212:213], v249 offset:416
    v_mfma_f32_16x16x32_bf16 v[12:15], v[216:219], v[160:163], 0
    s_and_b32 s30, s30, 0x7ffff
    buffer_load_dwordx4 v250, s[12:15], s32 offen offset:2048 lds
    v_exp_f32 v244, v132
    v_cvt_pk_bf16_f32 v176, v240, v241
    v_mfma_f32_16x16x32_bf16 v[76:79], v[216:219], v[164:167], 0
    ds_read_b64_tr_b16 v[214:215], v249 offset:2464
    v_add_f32 v240, v240, v241
    v_mfma_f32_16x16x32_bf16 a[140:143], v[216:219], v[168:171], 0
    v_exp_f32 v245, v133
    v_mfma_f32_16x16x32_bf16 a[204:207], v[216:219], v[172:175], 0
    s_waitcnt lgkmcnt(4)
    ds_read_b64_tr_b16 v[216:217], v249 offset:512
    v_cvt_pk_bf16_f32 v177, v242, v243
    v_mfma_f32_16x16x32_bf16 v[16:19], v[220:223], v[160:163], 0
    buffer_load_dwordx4 v250, s[12:15], s32 offen offset:3072 lds
    v_add_f32 v242, v242, v243
    v_exp_f32 v246, v134
    v_mfma_f32_16x16x32_bf16 v[80:83], v[220:223], v[164:167], 0
    ds_read_b64_tr_b16 v[218:219], v249 offset:2560
    v_add_f32 v236, v240, v242
    v_mfma_f32_16x16x32_bf16 a[144:147], v[220:223], v[168:171], 0
    v_exp_f32 v247, v135
    v_mfma_f32_16x16x32_bf16 a[208:211], v[220:223], v[172:175], 0
    ds_read_b64_tr_b16 v[220:221], v249 offset:544
    v_add_f32 v136, v136, v200
    v_mfma_f32_16x16x32_bf16 v[20:23], v[224:227], v[160:163], 0
    s_add_u32 m0, s35, 101792
    ds_read_b64_tr_b16 v[222:223], v249 offset:2592
    v_add_f32 v137, v137, v201
    v_add_f32 v138, v138, v202
    v_add_f32 v139, v139, v203
    v_mfma_f32_16x16x32_bf16 v[84:87], v[224:227], v[164:167], 0
    s_add_u32 s32, s32, 4096
    buffer_load_dwordx4 v250, s[12:15], s32 offen offset:0 lds
    v_exp_f32 v240, v136
    v_mfma_f32_16x16x32_bf16 a[148:151], v[224:227], v[168:171], 0
    v_cvt_pk_bf16_f32 v180, v244, v245
    v_add_f32 v244, v244, v245
    v_mfma_f32_16x16x32_bf16 a[212:215], v[224:227], v[172:175], 0
    s_waitcnt lgkmcnt(4)
    ds_read_b64_tr_b16 v[224:225], v249 offset:640
    v_mfma_f32_16x16x32_bf16 v[24:27], v[208:211], v[160:163], 0
    buffer_load_dwordx4 v250, s[12:15], s32 offen offset:1024 lds
    v_exp_f32 v241, v137
    v_cvt_pk_bf16_f32 v181, v246, v247
    v_mfma_f32_16x16x32_bf16 v[88:91], v[208:211], v[164:167], 0
    ds_read_b64_tr_b16 v[226:227], v249 offset:2688
    v_add_f32 v246, v246, v247
    v_mfma_f32_16x16x32_bf16 a[152:155], v[208:211], v[168:171], 0
    v_exp_f32 v242, v138
    v_mfma_f32_16x16x32_bf16 a[216:219], v[208:211], v[172:175], 0
    ds_read_b64_tr_b16 v[208:209], v249 offset:672
    v_add_f32 v237, v244, v246
    v_mfma_f32_16x16x32_bf16 v[28:31], v[212:215], v[160:163], 0
    buffer_load_dwordx4 v250, s[12:15], s32 offen offset:2048 lds
    v_exp_f32 v243, v139
    v_add_f32 v140, v140, v204
    v_mfma_f32_16x16x32_bf16 v[92:95], v[212:215], v[164:167], 0
    ds_read_b64_tr_b16 v[210:211], v249 offset:2720
    v_add_f32 v141, v141, v205
    v_add_f32 v142, v142, v206
    v_mfma_f32_16x16x32_bf16 a[156:159], v[212:215], v[168:171], 0
    v_add_f32 v143, v143, v207
    v_mfma_f32_16x16x32_bf16 a[220:223], v[212:215], v[172:175], 0
    s_waitcnt lgkmcnt(4)
    ds_read_b64_tr_b16 v[212:213], v249 offset:768
    v_exp_f32 v244, v140
    v_cvt_pk_bf16_f32 v184, v240, v241
    v_mfma_f32_16x16x32_bf16 v[32:35], v[216:219], v[160:163], 0
    buffer_load_dwordx4 v250, s[12:15], s32 offen offset:3072 lds
    v_add_f32 v240, v240, v241
    v_exp_f32 v245, v141
    v_mfma_f32_16x16x32_bf16 v[96:99], v[216:219], v[164:167], 0
    ds_read_b64_tr_b16 v[214:215], v249 offset:2816
    v_cvt_pk_bf16_f32 v185, v242, v243
    v_mfma_f32_16x16x32_bf16 a[160:163], v[216:219], v[168:171], 0
    v_add_f32 v242, v242, v243
    v_mfma_f32_16x16x32_bf16 a[224:227], v[216:219], v[172:175], 0
    ds_read_b64_tr_b16 v[216:217], v249 offset:800
    v_exp_f32 v246, v142
    v_add_f32 v238, v240, v242
    v_mfma_f32_16x16x32_bf16 v[36:39], v[220:223], v[160:163], 0
    ds_read_b64_tr_b16 v[218:219], v249 offset:2848
    v_exp_f32 v247, v143
    v_mfma_f32_16x16x32_bf16 v[100:103], v[220:223], v[164:167], 0
    v_exp_f32 v240, v144
    v_mfma_f32_16x16x32_bf16 a[164:167], v[220:223], v[168:171], 0
    v_cvt_pk_bf16_f32 v188, v244, v245
    v_add_f32 v244, v244, v245
    v_mfma_f32_16x16x32_bf16 a[228:231], v[220:223], v[172:175], 0
    s_waitcnt lgkmcnt(4)
    ds_read_b64_tr_b16 v[220:221], v249 offset:896
    v_exp_f32 v241, v145
    v_cvt_pk_bf16_f32 v189, v246, v247
    v_mfma_f32_16x16x32_bf16 v[40:43], v[224:227], v[160:163], 0
    s_mov_b32 m0, 97408
    ds_read_b64_tr_b16 v[222:223], v249 offset:2944
    v_add_f32 v246, v246, v247
    v_exp_f32 v242, v146
    v_mfma_f32_16x16x32_bf16 v[104:107], v[224:227], v[164:167], 0
    s_add_u32 s92, s92, 32768
    buffer_load_dword v250, s[96:99], s92 offen lds
    v_add_f32 v239, v244, v246
    v_mfma_f32_16x16x32_bf16 a[168:171], v[224:227], v[168:171], 0
    v_exp_f32 v243, v147
    v_mfma_f32_16x16x32_bf16 a[232:235], v[224:227], v[172:175], 0
    s_waitcnt vmcnt(18)
    v_exp_f32 v244, v148
    v_mfma_f32_16x16x32_bf16 v[44:47], v[208:211], v[160:163], 0
    s_barrier
    ds_read_b64_tr_b16 v[224:225], v249 offset:928
    v_cvt_pk_bf16_f32 v178, v240, v241
    v_mfma_f32_16x16x32_bf16 v[108:111], v[208:211], v[164:167], 0
    ds_read_b64_tr_b16 v[226:227], v249 offset:2976
    v_add_f32 v240, v240, v241
    v_mfma_f32_16x16x32_bf16 a[172:175], v[208:211], v[168:171], 0
    v_exp_f32 v245, v149
    v_mfma_f32_16x16x32_bf16 a[236:239], v[208:211], v[172:175], 0
    s_waitcnt lgkmcnt(4)
    ds_read_b128 v[208:211], v248 offset:33088
    v_cvt_pk_bf16_f32 v179, v242, v243
    v_mfma_f32_16x16x32_bf16 v[48:51], v[212:215], v[160:163], 0
    v_add_f32 v242, v242, v243
    v_exp_f32 v246, v150
    v_mfma_f32_16x16x32_bf16 v[112:115], v[212:215], v[164:167], 0
    v_add_f32 v240, v240, v242
    v_add_f32 v236, v236, v240
    v_mfma_f32_16x16x32_bf16 a[176:179], v[212:215], v[168:171], 0
    v_exp_f32 v247, v151
    v_mfma_f32_16x16x32_bf16 a[240:243], v[212:215], v[172:175], 0
    ds_read_b128 v[212:215], v248 offset:33216
    v_exp_f32 v240, v152
    v_cvt_pk_bf16_f32 v182, v244, v245
    v_mfma_f32_16x16x32_bf16 v[52:55], v[216:219], v[160:163], 0
    v_add_f32 v244, v244, v245
    v_exp_f32 v241, v153
    v_mfma_f32_16x16x32_bf16 v[116:119], v[216:219], v[164:167], 0
    v_cvt_pk_bf16_f32 v183, v246, v247
    v_add_f32 v246, v246, v247
    v_mfma_f32_16x16x32_bf16 a[180:183], v[216:219], v[168:171], 0
    v_exp_f32 v242, v154
    v_add_f32 v244, v244, v246
    v_mfma_f32_16x16x32_bf16 a[244:247], v[216:219], v[172:175], 0
    s_waitcnt lgkmcnt(2)
    ds_read_b128 v[216:219], v248 offset:33344
    v_add_f32 v237, v237, v244
    v_exp_f32 v243, v155
    v_mfma_f32_16x16x32_bf16 v[56:59], v[220:223], v[160:163], 0
    v_exp_f32 v244, v156
    v_cvt_pk_bf16_f32 v186, v240, v241
    v_mfma_f32_16x16x32_bf16 v[120:123], v[220:223], v[164:167], 0
    v_add_f32 v240, v240, v241
    v_mfma_f32_16x16x32_bf16 a[184:187], v[220:223], v[168:171], 0
    v_exp_f32 v245, v157
    v_cvt_pk_bf16_f32 v187, v242, v243
    v_mfma_f32_16x16x32_bf16 a[248:251], v[220:223], v[172:175], 0
    ds_read_b128 v[220:223], v248 offset:33472
    v_add_f32 v242, v242, v243
    v_exp_f32 v246, v158
    v_mfma_f32_16x16x32_bf16 v[60:63], v[224:227], v[160:163], 0
    v_add_f32 v240, v240, v242
    v_add_f32 v238, v238, v240
    v_mfma_f32_16x16x32_bf16 v[124:127], v[224:227], v[164:167], 0
    v_exp_f32 v247, v159
    v_mfma_f32_16x16x32_bf16 a[188:191], v[224:227], v[168:171], 0
    v_cvt_pk_bf16_f32 v190, v244, v245
    v_add_f32 v244, v244, v245
    v_cvt_pk_bf16_f32 v191, v246, v247
    v_mfma_f32_16x16x32_bf16 a[252:255], v[224:227], v[172:175], 0
    s_waitcnt lgkmcnt(2)
    v_add_f32 v246, v246, v247
    v_add_f32 v244, v244, v246
    v_add_f32 v239, v239, v244
    v_max3_f32 v240, v236, v237, v238
    v_max_f32 v240, v240, v239
    v_cmp_lt_f32 vcc, s38, v240
    s_mov_b32 s37, 0
    s_cbranch_vccnz ka_kernel_slow
ka_kernel_ret0:
.p2align 5
    s_nop 0
    s_nop 0
    s_nop 0
    s_nop 0
ka_kernel_loop:
    v_mfma_f32_16x16x32_bf16 v[128:131], v[208:211], a[0:3], v[192:195]
    ds_read_b128 v[224:227], v248 offset:33600
    v_add_f32 v232, v232, v236
    v_mfma_f32_16x16x32_bf16 v[132:135], v[208:211], a[4:7], v[196:199]
    v_add_f32 v233, v233, v237
    v_add_f32 v234, v234, v238
    v_mfma_f32_16x16x32_bf16 v[136:139], v[208:211], a[8:11], v[200:203]
    v_add_f32 v235, v235, v239
    v_mfma_f32_16x16x32_bf16 v[140:143], v[208:211], a[12:15], v[204:207]
    s_waitcnt vmcnt(10)
    s_barrier
    ds_read_b128 v[228:231], v248 offset:33728
    v_mfma_f32_16x16x32_bf16 v[128:131], v[212:215], a[16:19], v[128:131]
    s_add_u32 m0, s35, 0
    s_add_u32 s33, s39, s31
    buffer_load_dwordx4 v250, s[16:19], s33 offen offset:0 lds
    v_mfma_f32_16x16x32_bf16 v[132:135], v[212:215], a[20:23], v[132:135]
    v_mfma_f32_16x16x32_bf16 v[136:139], v[212:215], a[24:27], v[136:139]
    v_mfma_f32_16x16x32_bf16 v[140:143], v[212:215], a[28:31], v[140:143]
    s_waitcnt lgkmcnt(2)
    ds_read_b128 v[208:211], v248 offset:33856
    v_mfma_f32_16x16x32_bf16 v[128:131], v[216:219], a[32:35], v[128:131]
    s_add_u32 s39, s39, 16384
    buffer_load_dwordx4 v250, s[16:19], s33 offen offset:1024 lds
    v_mfma_f32_16x16x32_bf16 v[132:135], v[216:219], a[36:39], v[132:135]
    v_mfma_f32_16x16x32_bf16 v[136:139], v[216:219], a[40:43], v[136:139]
    v_mfma_f32_16x16x32_bf16 v[140:143], v[216:219], a[44:47], v[140:143]
    ds_read_b128 v[212:215], v248 offset:33984
    v_mfma_f32_16x16x32_bf16 v[128:131], v[220:223], a[48:51], v[128:131]
    s_and_b32 s39, s39, 0x7ffff
    buffer_load_dwordx4 v250, s[16:19], s33 offen offset:2048 lds
    v_mfma_f32_16x16x32_bf16 v[132:135], v[220:223], a[52:55], v[132:135]
    v_mfma_f32_16x16x32_bf16 v[136:139], v[220:223], a[56:59], v[136:139]
    v_mfma_f32_16x16x32_bf16 v[140:143], v[220:223], a[60:63], v[140:143]
    s_waitcnt lgkmcnt(2)
    ds_read_b128 v[216:219], v248 offset:35136
    v_mfma_f32_16x16x32_bf16 v[128:131], v[224:227], a[64:67], v[128:131]
    buffer_load_dwordx4 v250, s[16:19], s33 offen offset:3072 lds
    v_mfma_f32_16x16x32_bf16 v[132:135], v[224:227], a[68:71], v[132:135]
    v_mfma_f32_16x16x32_bf16 v[136:139], v[224:227], a[72:75], v[136:139]
    v_mfma_f32_16x16x32_bf16 v[140:143], v[224:227], a[76:79], v[140:143]
    ds_read_b128 v[220:223], v248 offset:35264
    v_mfma_f32_16x16x32_bf16 v[128:131], v[228:231], a[80:83], v[128:131]
    s_add_u32 m0, s35, 4128
    s_add_u32 s33, s33, 4096
    buffer_load_dwordx4 v250, s[16:19], s33 offen offset:0 lds
    v_mfma_f32_16x16x32_bf16 v[132:135], v[228:231], a[84:87], v[132:135]
    v_mfma_f32_16x16x32_bf16 v[136:139], v[228:231], a[88:91], v[136:139]
    v_mfma_f32_16x16x32_bf16 v[140:143], v[228:231], a[92:95], v[140:143]
    s_waitcnt lgkmcnt(2)
    ds_read_b128 v[224:227], v248 offset:35392
    v_mfma_f32_16x16x32_bf16 v[128:131], v[208:211], a[96:99], v[128:131]
    buffer_load_dwordx4 v250, s[16:19], s33 offen offset:1024 lds
    v_mfma_f32_16x16x32_bf16 v[132:135], v[208:211], a[100:103], v[132:135]
    v_mfma_f32_16x16x32_bf16 v[136:139], v[208:211], a[104:107], v[136:139]
    v_mfma_f32_16x16x32_bf16 v[140:143], v[208:211], a[108:111], v[140:143]
    ds_read_b128 v[228:231], v248 offset:35520
    v_mfma_f32_16x16x32_bf16 v[128:131], v[212:215], a[112:115], v[128:131]
    buffer_load_dwordx4 v250, s[16:19], s33 offen offset:2048 lds
    v_mfma_f32_16x16x32_bf16 v[132:135], v[212:215], a[116:119], v[132:135]
    v_mfma_f32_16x16x32_bf16 v[136:139], v[212:215], a[120:123], v[136:139]
    v_mfma_f32_16x16x32_bf16 v[140:143], v[212:215], a[124:127], v[140:143]
    s_waitcnt lgkmcnt(2)
    ds_read_b128 v[208:211], v248 offset:35648
    v_mfma_f32_16x16x32_bf16 v[144:147], v[216:219], a[0:3], v[192:195]
    buffer_load_dwordx4 v250, s[16:19], s33 offen offset:3072 lds
    v_mfma_f32_16x16x32_bf16 v[148:151], v[216:219], a[4:7], v[196:199]
    v_exp_f32 v240, v128
    v_mfma_f32_16x16x32_bf16 v[152:155], v[216:219], a[8:11], v[200:203]
    v_exp_f32 v241, v129
    v_mfma_f32_16x16x32_bf16 v[156:159], v[216:219], a[12:15], v[204:207]
    ds_read_b128 v[212:215], v248 offset:35776
    v_mfma_f32_16x16x32_bf16 v[144:147], v[220:223], a[16:19], v[144:147]
    v_exp_f32 v242, v130
    v_mfma_f32_16x16x32_bf16 v[148:151], v[220:223], a[20:23], v[148:151]
    v_exp_f32 v243, v131
    v_mfma_f32_16x16x32_bf16 v[152:155], v[220:223], a[24:27], v[152:155]
    v_exp_f32 v244, v132
    v_mfma_f32_16x16x32_bf16 v[156:159], v[220:223], a[28:31], v[156:159]
    s_waitcnt lgkmcnt(2)
    ds_read_b128 v[216:219], v248 offset:35904
    v_mfma_f32_16x16x32_bf16 v[144:147], v[224:227], a[32:35], v[144:147]
    v_cvt_pk_bf16_f32 v160, v240, v241
    v_add_f32 v240, v240, v241
    v_mfma_f32_16x16x32_bf16 v[148:151], v[224:227], a[36:39], v[148:151]
    v_exp_f32 v245, v133
    v_mfma_f32_16x16x32_bf16 v[152:155], v[224:227], a[40:43], v[152:155]
    v_cvt_pk_bf16_f32 v161, v242, v243
    v_add_f32 v242, v242, v243
    v_mfma_f32_16x16x32_bf16 v[156:159], v[224:227], a[44:47], v[156:159]
    ds_read_b128 v[220:223], v248 offset:36032
    v_mfma_f32_16x16x32_bf16 v[144:147], v[228:231], a[48:51], v[144:147]
    v_exp_f32 v246, v134
    v_mfma_f32_16x16x32_bf16 v[148:151], v[228:231], a[52:55], v[148:151]
    v_add_f32 v236, v240, v242
    v_mfma_f32_16x16x32_bf16 v[152:155], v[228:231], a[56:59], v[152:155]
    v_exp_f32 v247, v135
    v_mfma_f32_16x16x32_bf16 v[156:159], v[228:231], a[60:63], v[156:159]
    s_waitcnt lgkmcnt(2)
    ds_read_b64_tr_b16 v[224:225], v249 offset:33088
    v_mfma_f32_16x16x32_bf16 v[144:147], v[208:211], a[64:67], v[144:147]
    ds_read_b64_tr_b16 v[226:227], v249 offset:35136
    v_mfma_f32_16x16x32_bf16 v[148:151], v[208:211], a[68:71], v[148:151]
    v_exp_f32 v240, v136
    v_mfma_f32_16x16x32_bf16 v[152:155], v[208:211], a[72:75], v[152:155]
    v_cvt_pk_bf16_f32 v164, v244, v245
    v_add_f32 v244, v244, v245
    v_mfma_f32_16x16x32_bf16 v[156:159], v[208:211], a[76:79], v[156:159]
    ds_read_b64_tr_b16 v[208:209], v249 offset:33120
    v_mfma_f32_16x16x32_bf16 v[144:147], v[212:215], a[80:83], v[144:147]
    ds_read_b64_tr_b16 v[210:211], v249 offset:35168
    v_mfma_f32_16x16x32_bf16 v[148:151], v[212:215], a[84:87], v[148:151]
    v_exp_f32 v241, v137
    v_mfma_f32_16x16x32_bf16 v[152:155], v[212:215], a[88:91], v[152:155]
    v_cvt_pk_bf16_f32 v165, v246, v247
    v_add_f32 v246, v246, v247
    v_mfma_f32_16x16x32_bf16 v[156:159], v[212:215], a[92:95], v[156:159]
    s_waitcnt lgkmcnt(4)
    ds_read_b64_tr_b16 v[212:213], v249 offset:33216
    v_mfma_f32_16x16x32_bf16 v[144:147], v[216:219], a[96:99], v[144:147]
    ds_read_b64_tr_b16 v[214:215], v249 offset:35264
    v_mfma_f32_16x16x32_bf16 v[148:151], v[216:219], a[100:103], v[148:151]
    v_exp_f32 v242, v138
    v_mfma_f32_16x16x32_bf16 v[152:155], v[216:219], a[104:107], v[152:155]
    v_add_f32 v237, v244, v246
    v_mfma_f32_16x16x32_bf16 v[156:159], v[216:219], a[108:111], v[156:159]
    ds_read_b64_tr_b16 v[216:217], v249 offset:33248
    v_mfma_f32_16x16x32_bf16 v[144:147], v[220:223], a[112:115], v[144:147]
    ds_read_b64_tr_b16 v[218:219], v249 offset:35296
    v_mfma_f32_16x16x32_bf16 v[148:151], v[220:223], a[116:119], v[148:151]
    v_exp_f32 v243, v139
    v_mfma_f32_16x16x32_bf16 v[152:155], v[220:223], a[120:123], v[152:155]
    v_exp_f32 v244, v140
    v_mfma_f32_16x16x32_bf16 v[156:159], v[220:223], a[124:127], v[156:159]
    s_waitcnt lgkmcnt(4)
    ds_read_b64_tr_b16 v[220:221], v249 offset:33344
    v_mfma_f32_16x16x32_bf16 v[0:3], v[224:227], v[176:179], v[0:3]
    ds_read_b64_tr_b16 v[222:223], v249 offset:35392
    v_cvt_pk_bf16_f32 v168, v240, v241
    v_mfma_f32_16x16x32_bf16 v[64:67], v[224:227], v[180:183], v[64:67]
    v_add_f32 v240, v240, v241
    v_mfma_f32_16x16x32_bf16 a[128:131], v[224:227], v[184:187], a[128:131]
    v_exp_f32 v245, v141
    v_mfma_f32_16x16x32_bf16 a[192:195], v[224:227], v[188:191], a[192:195]
    s_waitcnt vmcnt(9)
    s_barrier
    ds_read_b64_tr_b16 v[224:225], v249 offset:33376
    v_mfma_f32_16x16x32_bf16 v[4:7], v[208:211], v[176:179], v[4:7]
    s_add_u32 m0, s35, 130752
    ds_read_b64_tr_b16 v[226:227], v249 offset:35424
    s_add_u32 s32, s30, s31
    v_mfma_f32_16x16x32_bf16 v[68:71], v[208:211], v[180:183], v[68:71]
    buffer_load_dwordx4 v250, s[12:15], s32 offen offset:0 lds
    v_cvt_pk_bf16_f32 v169, v242, v243
    v_mfma_f32_16x16x32_bf16 a[132:135], v[208:211], v[184:187], a[132:135]
    v_add_f32 v242, v242, v243
    v_mfma_f32_16x16x32_bf16 a[196:199], v[208:211], v[188:191], a[196:199]
    s_waitcnt lgkmcnt(4)
    ds_read_b64_tr_b16 v[208:209], v249 offset:33472
    v_mfma_f32_16x16x32_bf16 v[8:11], v[212:215], v[176:179], v[8:11]
    s_add_u32 s30, s30, 16384
    buffer_load_dwordx4 v250, s[12:15], s32 offen offset:1024 lds
    v_exp_f32 v246, v142
    v_mfma_f32_16x16x32_bf16 v[72:75], v[212:215], v[180:183], v[72:75]
    ds_read_b64_tr_b16 v[210:211], v249 offset:35520
    v_add_f32 v238, v240, v242
    v_mfma_f32_16x16x32_bf16 a[136:139], v[212:215], v[184:187], a[136:139]
    v_exp_f32 v247, v143
    v_mfma_f32_16x16x32_bf16 a[200:203], v[212:215], v[188:191], a[200:203]
    ds_read_b64_tr_b16 v[212:213], v249 offset:33504
    v_mfma_f32_16x16x32_bf16 v[12:15], v[216:219], v[176:179], v[12:15]
    s_and_b32 s30, s30, 0x7ffff
    buffer_load_dwordx4 v250, s[12:15], s32 offen offset:2048 lds
    ds_read_b64_tr_b16 v[214:215], v249 offset:35552
    v_mfma_f32_16x16x32_bf16 v[76:79], v[216:219], v[180:183], v[76:79]
    v_exp_f32 v240, v144
    v_mfma_f32_16x16x32_bf16 a[140:143], v[216:219], v[184:187], a[140:143]
    v_cvt_pk_bf16_f32 v172, v244, v245
    v_add_f32 v244, v244, v245
    v_mfma_f32_16x16x32_bf16 a[204:207], v[216:219], v[188:191], a[204:207]
    s_waitcnt lgkmcnt(4)
    ds_read_b64_tr_b16 v[216:217], v249 offset:33600
    v_mfma_f32_16x16x32_bf16 v[16:19], v[220:223], v[176:179], v[16:19]
    buffer_load_dwordx4 v250, s[12:15], s32 offen offset:3072 lds
    ds_read_b64_tr_b16 v[218:219], v249 offset:35648
    v_mfma_f32_16x16x32_bf16 v[80:83], v[220:223], v[180:183], v[80:83]
    v_exp_f32 v241, v145
    v_mfma_f32_16x16x32_bf16 a[144:147], v[220:223], v[184:187], a[144:147]
    v_cvt_pk_bf16_f32 v173, v246, v247
    v_add_f32 v246, v246, v247
    v_mfma_f32_16x16x32_bf16 a[208:211], v[220:223], v[188:191], a[208:211]
    ds_read_b64_tr_b16 v[220:221], v249 offset:33632
    v_mfma_f32_16x16x32_bf16 v[20:23], v[224:227], v[176:179], v[20:23]
    s_add_u32 m0, s35, 134880
    ds_read_b64_tr_b16 v[222:223], v249 offset:35680
    s_add_u32 s32, s32, 4096
    v_mfma_f32_16x16x32_bf16 v[84:87], v[224:227], v[180:183], v[84:87]
    buffer_load_dwordx4 v250, s[12:15], s32 offen offset:0 lds
    v_mfma_f32_16x16x32_bf16 a[148:151], v[224:227], v[184:187], a[148:151]
    v_exp_f32 v242, v146
    v_mfma_f32_16x16x32_bf16 a[212:215], v[224:227], v[188:191], a[212:215]
    s_waitcnt lgkmcnt(4)
    ds_read_b64_tr_b16 v[224:225], v249 offset:33728
    v_add_f32 v239, v244, v246
    v_mfma_f32_16x16x32_bf16 v[24:27], v[208:211], v[176:179], v[24:27]
    buffer_load_dwordx4 v250, s[12:15], s32 offen offset:1024 lds
    ds_read_b64_tr_b16 v[226:227], v249 offset:35776
    v_mfma_f32_16x16x32_bf16 v[88:91], v[208:211], v[180:183], v[88:91]
    v_exp_f32 v243, v147
    v_mfma_f32_16x16x32_bf16 a[152:155], v[208:211], v[184:187], a[152:155]
    v_exp_f32 v244, v148
    v_mfma_f32_16x16x32_bf16 a[216:219], v[208:211], v[188:191], a[216:219]
    ds_read_b64_tr_b16 v[208:209], v249 offset:33760
    v_cvt_pk_bf16_f32 v162, v240, v241
    v_mfma_f32_16x16x32_bf16 v[28:31], v[212:215], v[176:179], v[28:31]
    buffer_load_dwordx4 v250, s[12:15], s32 offen offset:2048 lds
    ds_read_b64_tr_b16 v[210:211], v249 offset:35808
    v_mfma_f32_16x16x32_bf16 v[92:95], v[212:215], v[180:183], v[92:95]
    v_add_f32 v240, v240, v241
    v_mfma_f32_16x16x32_bf16 a[156:159], v[212:215], v[184:187], a[156:159]
    v_exp_f32 v245, v149
    v_mfma_f32_16x16x32_bf16 a[220:223], v[212:215], v[188:191], a[220:223]
    s_waitcnt lgkmcnt(4)
    ds_read_b64_tr_b16 v[212:213], v249 offset:33856
    v_mfma_f32_16x16x32_bf16 v[32:35], v[216:219], v[176:179], v[32:35]
    buffer_load_dwordx4 v250, s[12:15], s32 offen offset:3072 lds
    ds_read_b64_tr_b16 v[214:215], v249 offset:35904
    v_mfma_f32_16x16x32_bf16 v[96:99], v[216:219], v[180:183], v[96:99]
    v_cvt_pk_bf16_f32 v163, v242, v243
    v_add_f32 v242, v242, v243
    v_mfma_f32_16x16x32_bf16 a[160:163], v[216:219], v[184:187], a[160:163]
    v_exp_f32 v246, v150
    v_mfma_f32_16x16x32_bf16 a[224:227], v[216:219], v[188:191], a[224:227]
    ds_read_b64_tr_b16 v[216:217], v249 offset:33888
    v_add_f32 v240, v240, v242
    v_mfma_f32_16x16x32_bf16 v[36:39], v[220:223], v[176:179], v[36:39]
    ds_read_b64_tr_b16 v[218:219], v249 offset:35936
    v_add_f32 v236, v236, v240
    v_mfma_f32_16x16x32_bf16 v[100:103], v[220:223], v[180:183], v[100:103]
    v_exp_f32 v247, v151
    v_mfma_f32_16x16x32_bf16 a[164:167], v[220:223], v[184:187], a[164:167]
    v_exp_f32 v240, v152
    v_mfma_f32_16x16x32_bf16 a[228:231], v[220:223], v[188:191], a[228:231]
    s_waitcnt lgkmcnt(4)
    ds_read_b64_tr_b16 v[220:221], v249 offset:33984
    s_mov_b32 m0, 97408
    v_mfma_f32_16x16x32_bf16 v[40:43], v[224:227], v[176:179], v[40:43]
    s_add_u32 s92, s92, 32768
    buffer_load_dword v250, s[96:99], s92 offen lds
    v_cvt_pk_bf16_f32 v166, v244, v245
    v_mfma_f32_16x16x32_bf16 v[104:107], v[224:227], v[180:183], v[104:107]
    ds_read_b64_tr_b16 v[222:223], v249 offset:36032
    v_add_f32 v244, v244, v245
    v_mfma_f32_16x16x32_bf16 a[168:171], v[224:227], v[184:187], a[168:171]
    v_exp_f32 v241, v153
    v_mfma_f32_16x16x32_bf16 a[232:235], v[224:227], v[188:191], a[232:235]
    ds_read_b64_tr_b16 v[224:225], v249 offset:34016
    v_cvt_pk_bf16_f32 v167, v246, v247
    v_mfma_f32_16x16x32_bf16 v[44:47], v[208:211], v[176:179], v[44:47]
    ds_read_b64_tr_b16 v[226:227], v249 offset:36064
    v_add_f32 v246, v246, v247
    v_mfma_f32_16x16x32_bf16 v[108:111], v[208:211], v[180:183], v[108:111]
    v_exp_f32 v242, v154
    v_mfma_f32_16x16x32_bf16 a[172:175], v[208:211], v[184:187], a[172:175]
    v_add_f32 v244, v244, v246
    v_add_f32 v237, v237, v244
    v_mfma_f32_16x16x32_bf16 a[236:239], v[208:211], v[188:191], a[236:239]
    s_waitcnt lgkmcnt(4)
    ds_read_b128 v[208:211], v248 offset:0
    v_mfma_f32_16x16x32_bf16 v[48:51], v[212:215], v[176:179], v[48:51]
    v_exp_f32 v243, v155
    v_mfma_f32_16x16x32_bf16 v[112:115], v[212:215], v[180:183], v[112:115]
    v_exp_f32 v244, v156
    v_mfma_f32_16x16x32_bf16 a[176:179], v[212:215], v[184:187], a[176:179]
    v_cvt_pk_bf16_f32 v170, v240, v241
    v_add_f32 v240, v240, v241
    v_mfma_f32_16x16x32_bf16 a[240:243], v[212:215], v[188:191], a[240:243]
    ds_read_b128 v[212:215], v248 offset:128
    v_mfma_f32_16x16x32_bf16 v[52:55], v[216:219], v[176:179], v[52:55]
    v_exp_f32 v245, v157
    v_mfma_f32_16x16x32_bf16 v[116:119], v[216:219], v[180:183], v[116:119]
    v_cvt_pk_bf16_f32 v171, v242, v243
    v_add_f32 v242, v242, v243
    v_mfma_f32_16x16x32_bf16 a[180:183], v[216:219], v[184:187], a[180:183]
    v_exp_f32 v246, v158
    v_mfma_f32_16x16x32_bf16 a[244:247], v[216:219], v[188:191], a[244:247]
    s_waitcnt lgkmcnt(2)
    ds_read_b128 v[216:219], v248 offset:256
    v_mfma_f32_16x16x32_bf16 v[56:59], v[220:223], v[176:179], v[56:59]
    v_add_f32 v240, v240, v242
    v_add_f32 v238, v238, v240
    v_mfma_f32_16x16x32_bf16 v[120:123], v[220:223], v[180:183], v[120:123]
    v_exp_f32 v247, v159
    v_mfma_f32_16x16x32_bf16 a[184:187], v[220:223], v[184:187], a[184:187]
    v_cvt_pk_bf16_f32 v174, v244, v245
    v_add_f32 v244, v244, v245
    v_mfma_f32_16x16x32_bf16 a[248:251], v[220:223], v[188:191], a[248:251]
    ds_read_b128 v[220:223], v248 offset:384
    v_cvt_pk_bf16_f32 v175, v246, v247
    v_mfma_f32_16x16x32_bf16 v[60:63], v[224:227], v[176:179], v[60:63]
    v_add_f32 v246, v246, v247
    v_add_f32 v244, v244, v246
    v_mfma_f32_16x16x32_bf16 v[124:127], v[224:227], v[180:183], v[124:127]
    v_add_f32 v239, v239, v244
    v_max3_f32 v240, v236, v237, v238
    v_mfma_f32_16x16x32_bf16 a[188:191], v[224:227], v[184:187], a[188:191]
    v_max_f32 v240, v240, v239
    v_cmp_lt_f32 vcc, s38, v240
    v_mfma_f32_16x16x32_bf16 a[252:255], v[224:227], v[188:191], a[252:255]
    s_waitcnt lgkmcnt(2)
    s_mov_b32 s37, 1
    s_cbranch_vccnz ka_kernel_slow
ka_kernel_ret1:
    v_mfma_f32_16x16x32_bf16 v[128:131], v[208:211], a[0:3], v[192:195]
    ds_read_b128 v[224:227], v248 offset:512
    v_add_f32 v232, v232, v236
    v_mfma_f32_16x16x32_bf16 v[132:135], v[208:211], a[4:7], v[196:199]
    v_add_f32 v233, v233, v237
    v_add_f32 v234, v234, v238
    v_mfma_f32_16x16x32_bf16 v[136:139], v[208:211], a[8:11], v[200:203]
    v_add_f32 v235, v235, v239
    v_mfma_f32_16x16x32_bf16 v[140:143], v[208:211], a[12:15], v[204:207]
    s_waitcnt vmcnt(9)
    s_barrier
    ds_read_b128 v[228:231], v248 offset:640
    v_mfma_f32_16x16x32_bf16 v[128:131], v[212:215], a[16:19], v[128:131]
    s_add_u32 m0, s35, 33088
    s_add_u32 s33, s39, s31
    buffer_load_dwordx4 v250, s[16:19], s33 offen offset:0 lds
    v_mfma_f32_16x16x32_bf16 v[132:135], v[212:215], a[20:23], v[132:135]
    v_mfma_f32_16x16x32_bf16 v[136:139], v[212:215], a[24:27], v[136:139]
    v_mfma_f32_16x16x32_bf16 v[140:143], v[212:215], a[28:31], v[140:143]
    s_waitcnt lgkmcnt(2)
    ds_read_b128 v[208:211], v248 offset:768
    v_mfma_f32_16x16x32_bf16 v[128:131], v[216:219], a[32:35], v[128:131]
    s_add_u32 s39, s39, 16384
    buffer_load_dwordx4 v250, s[16:19], s33 offen offset:1024 lds
    v_mfma_f32_16x16x32_bf16 v[132:135], v[216:219], a[36:39], v[132:135]
    v_mfma_f32_16x16x32_bf16 v[136:139], v[216:219], a[40:43], v[136:139]
    v_mfma_f32_16x16x32_bf16 v[140:143], v[216:219], a[44:47], v[140:143]
    ds_read_b128 v[212:215], v248 offset:896
    v_mfma_f32_16x16x32_bf16 v[128:131], v[220:223], a[48:51], v[128:131]
    s_and_b32 s39, s39, 0x7ffff
    buffer_load_dwordx4 v250, s[16:19], s33 offen offset:2048 lds
    v_mfma_f32_16x16x32_bf16 v[132:135], v[220:223], a[52:55], v[132:135]
    v_mfma_f32_16x16x32_bf16 v[136:139], v[220:223], a[56:59], v[136:139]
    v_mfma_f32_16x16x32_bf16 v[140:143], v[220:223], a[60:63], v[140:143]
    s_waitcnt lgkmcnt(2)
    ds_read_b128 v[216:219], v248 offset:2048
    v_mfma_f32_16x16x32_bf16 v[128:131], v[224:227], a[64:67], v[128:131]
    buffer_load_dwordx4 v250, s[16:19], s33 offen offset:3072 lds
    v_mfma_f32_16x16x32_bf16 v[132:135], v[224:227], a[68:71], v[132:135]
    v_mfma_f32_16x16x32_bf16 v[136:139], v[224:227], a[72:75], v[136:139]
    v_mfma_f32_16x16x32_bf16 v[140:143], v[224:227], a[76:79], v[140:143]
    ds_read_b128 v[220:223], v248 offset:2176
    v_mfma_f32_16x16x32_bf16 v[128:131], v[228:231], a[80:83], v[128:131]
    s_add_u32 m0, s35, 37216
    s_add_u32 s33, s33, 4096
    buffer_load_dwordx4 v250, s[16:19], s33 offen offset:0 lds
    v_mfma_f32_16x16x32_bf16 v[132:135], v[228:231], a[84:87], v[132:135]
    v_mfma_f32_16x16x32_bf16 v[136:139], v[228:231], a[88:91], v[136:139]
    v_mfma_f32_16x16x32_bf16 v[140:143], v[228:231], a[92:95], v[140:143]
    s_waitcnt lgkmcnt(2)
    ds_read_b128 v[224:227], v248 offset:2304
    v_mfma_f32_16x16x32_bf16 v[128:131], v[208:211], a[96:99], v[128:131]
    buffer_load_dwordx4 v250, s[16:19], s33 offen offset:1024 lds
    v_mfma_f32_16x16x32_bf16 v[132:135], v[208:211], a[100:103], v[132:135]
    v_mfma_f32_16x16x32_bf16 v[136:139], v[208:211], a[104:107], v[136:139]
    v_mfma_f32_16x16x32_bf16 v[140:143], v[208:211], a[108:111], v[140:143]
    ds_read_b128 v[228:231], v248 offset:2432
    v_mfma_f32_16x16x32_bf16 v[128:131], v[212:215], a[112:115], v[128:131]
    buffer_load_dwordx4 v250, s[16:19], s33 offen offset:2048 lds
    v_mfma_f32_16x16x32_bf16 v[132:135], v[212:215], a[116:119], v[132:135]
    v_mfma_f32_16x16x32_bf16 v[136:139], v[212:215], a[120:123], v[136:139]
    v_mfma_f32_16x16x32_bf16 v[140:143], v[212:215], a[124:127], v[140:143]
    s_waitcnt lgkmcnt(2)
    ds_read_b128 v[208:211], v248 offset:2560
    v_mfma_f32_16x16x32_bf16 v[144:147], v[216:219], a[0:3], v[192:195]
    buffer_load_dwordx4 v250, s[16:19], s33 offen offset:3072 lds
    v_mfma_f32_16x16x32_bf16 v[148:151], v[216:219], a[4:7], v[196:199]
    v_exp_f32 v240, v128
    v_mfma_f32_16x16x32_bf16 v[152:155], v[216:219], a[8:11], v[200:203]
    v_exp_f32 v241, v129
    v_mfma_f32_16x16x32_bf16 v[156:159], v[216:219], a[12:15], v[204:207]
    ds_read_b128 v[212:215], v248 offset:2688
    v_mfma_f32_16x16x32_bf16 v[144:147], v[220:223], a[16:19], v[144:147]
    v_exp_f32 v242, v130
    v_mfma_f32_16x16x32_bf16 v[148:151], v[220:223], a[20:23], v[148:151]
    v_exp_f32 v243, v131
    v_mfma_f32_16x16x32_bf16 v[152:155], v[220:223], a[24:27], v[152:155]
    v_exp_f32 v244, v132
    v_mfma_f32_16x16x32_bf16 v[156:159], v[220:223], a[28:31], v[156:159]
    s_waitcnt lgkmcnt(2)
    ds_read_b128 v[216:219], v248 offset:2816
    v_mfma_f32_16x16x32_bf16 v[144:147], v[224:227], a[32:35], v[144:147]
    v_cvt_pk_bf16_f32 v176, v240, v241
    v_add_f32 v240, v240, v241
    v_mfma_f32_16x16x32_bf16 v[148:151], v[224:227], a[36:39], v[148:151]
    v_exp_f32 v245, v133
    v_mfma_f32_16x16x32_bf16 v[152:155], v[224:227], a[40:43], v[152:155]
    v_cvt_pk_bf16_f32 v177, v242, v243
    v_add_f32 v242, v242, v243
    v_mfma_f32_16x16x32_bf16 v[156:159], v[224:227], a[44:47], v[156:159]
    ds_read_b128 v[220:223], v248 offset:2944
    v_mfma_f32_16x16x32_bf16 v[144:147], v[228:231], a[48:51], v[144:147]
    v_exp_f32 v246, v134
    v_mfma_f32_16x16x32_bf16 v[148:151], v[228:231], a[52:55], v[148:151]
    v_add_f32 v236, v240, v242
    v_mfma_f32_16x16x32_bf16 v[152:155], v[228:231], a[56:59], v[152:155]
    v_exp_f32 v247, v135
    v_mfma_f32_16x16x32_bf16 v[156:159], v[228:231], a[60:63], v[156:159]
    s_waitcnt lgkmcnt(2)
    ds_read_b64_tr_b16 v[224:225], v249 offset:0
    v_mfma_f32_16x16x32_bf16 v[144:147], v[208:211], a[64:67], v[144:147]
    ds_read_b64_tr_b16 v[226:227], v249 offset:2048
    v_mfma_f32_16x16x32_bf16 v[148:151], v[208:211], a[68:71], v[148:151]
    v_exp_f32 v240, v136
    v_mfma_f32_16x16x32_bf16 v[152:155], v[208:211], a[72:75], v[152:155]
    v_cvt_pk_bf16_f32 v180, v244, v245
    v_add_f32 v244, v244, v245
    v_mfma_f32_16x16x32_bf16 v[156:159], v[208:211], a[76:79], v[156:159]
    ds_read_b64_tr_b16 v[208:209], v249 offset:32
    v_mfma_f32_16x16x32_bf16 v[144:147], v[212:215], a[80:83], v[144:147]
    ds_read_b64_tr_b16 v[210:211], v249 offset:2080
    v_mfma_f32_16x16x32_bf16 v[148:151], v[212:215], a[84:87], v[148:151]
    v_exp_f32 v241, v137
    v_mfma_f32_16x16x32_bf16 v[152:155], v[212:215], a[88:91], v[152:155]
    v_cvt_pk_bf16_f32 v181, v246, v247
    v_add_f32 v246, v246, v247
    v_mfma_f32_16x16x32_bf16 v[156:159], v[212:215], a[92:95], v[156:159]
    s_waitcnt lgkmcnt(4)
    ds_read_b64_tr_b16 v[212:213], v249 offset:128
    v_mfma_f32_16x16x32_bf16 v[144:147], v[216:219], a[96:99], v[144:147]
    ds_read_b64_tr_b16 v[214:215], v249 offset:2176
    v_mfma_f32_16x16x32_bf16 v[148:151], v[216:219], a[100:103], v[148:151]
    v_exp_f32 v242, v138
    v_mfma_f32_16x16x32_bf16 v[152:155], v[216:219], a[104:107], v[152:155]
    v_add_f32 v237, v244, v246
    v_mfma_f32_16x16x32_bf16 v[156:159], v[216:219], a[108:111], v[156:159]
    ds_read_b64_tr_b16 v[216:217], v249 offset:160
    v_mfma_f32_16x16x32_bf16 v[144:147], v[220:223], a[112:115], v[144:147]
    ds_read_b64_tr_b16 v[218:219], v249 offset:2208
    v_mfma_f32_16x16x32_bf16 v[148:151], v[220:223], a[116:119], v[148:151]
    v_exp_f32 v243, v139
    v_mfma_f32_16x16x32_bf16 v[152:155], v[220:223], a[120:123], v[152:155]
    v_exp_f32 v244, v140
    v_mfma_f32_16x16x32_bf16 v[156:159], v[220:223], a[124:127], v[156:159]
    s_waitcnt lgkmcnt(4)
    ds_read_b64_tr_b16 v[220:221], v249 offset:256
    v_mfma_f32_16x16x32_bf16 v[0:3], v[224:227], v[160:163], v[0:3]
    ds_read_b64_tr_b16 v[222:223], v249 offset:2304
    v_cvt_pk_bf16_f32 v184, v240, v241
    v_mfma_f32_16x16x32_bf16 v[64:67], v[224:227], v[164:167], v[64:67]
    v_add_f32 v240, v240, v241
    v_mfma_f32_16x16x32_bf16 a[128:131], v[224:227], v[168:171], a[128:131]
    v_exp_f32 v245, v141
    v_mfma_f32_16x16x32_bf16 a[192:195], v[224:227], v[172:175], a[192:195]
    s_waitcnt vmcnt(9)
    s_barrier
    ds_read_b64_tr_b16 v[224:225], v249 offset:288
    v_mfma_f32_16x16x32_bf16 v[4:7], v[208:211], v[160:163], v[4:7]
    s_add_u32 m0, s35, 97664
    ds_read_b64_tr_b16 v[226:227], v249 offset:2336
    s_add_u32 s32, s30, s31
    v_mfma_f32_16x16x32_bf16 v[68:71], v[208:211], v[164:167], v[68:71]
    buffer_load_dwordx4 v250, s[12:15], s32 offen offset:0 lds
    v_cvt_pk_bf16_f32 v185, v242, v243
    v_mfma_f32_16x16x32_bf16 a[132:135], v[208:211], v[168:171], a[132:135]
    v_add_f32 v242, v242, v243
    v_mfma_f32_16x16x32_bf16 a[196:199], v[208:211], v[172:175], a[196:199]
    s_waitcnt lgkmcnt(4)
    ds_read_b64_tr_b16 v[208:209], v249 offset:384
    v_mfma_f32_16x16x32_bf16 v[8:11], v[212:215], v[160:163], v[8:11]
    s_add_u32 s30, s30, 16384
    buffer_load_dwordx4 v250, s[12:15], s32 offen offset:1024 lds
    v_exp_f32 v246, v142
    v_mfma_f32_16x16x32_bf16 v[72:75], v[212:215], v[164:167], v[72:75]
    ds_read_b64_tr_b16 v[210:211], v249 offset:2432
    v_add_f32 v238, v240, v242
    v_mfma_f32_16x16x32_bf16 a[136:139], v[212:215], v[168:171], a[136:139]
    v_exp_f32 v247, v143
    v_mfma_f32_16x16x32_bf16 a[200:203], v[212:215], v[172:175], a[200:203]
    ds_read_b64_tr_b16 v[212:213], v249 offset:416
    v_mfma_f32_16x16x32_bf16 v[12:15], v[216:219], v[160:163], v[12:15]
    s_and_b32 s30, s30, 0x7ffff
    buffer_load_dwordx4 v250, s[12:15], s32 offen offset:2048 lds
    ds_read_b64_tr_b16 v[214:215], v249 offset:2464
    v_mfma_f32_16x16x32_bf16 v[76:79], v[216:219], v[164:167], v[76:79]
    v_exp_f32 v240, v144
    v_mfma_f32_16x16x32_bf16 a[140:143], v[216:219], v[168:171], a[140:143]
    v_cvt_pk_bf16_f32 v188, v244, v245
    v_add_f32 v244, v244, v245
    v_mfma_f32_16x16x32_bf16 a[204:207], v[216:219], v[172:175], a[204:207]
    s_waitcnt lgkmcnt(4)
    ds_read_b64_tr_b16 v[216:217], v249 offset:512
    v_mfma_f32_16x16x32_bf16 v[16:19], v[220:223], v[160:163], v[16:19]
    buffer_load_dwordx4 v250, s[12:15], s32 offen offset:3072 lds
    ds_read_b64_tr_b16 v[218:219], v249 offset:2560
    v_mfma_f32_16x16x32_bf16 v[80:83], v[220:223], v[164:167], v[80:83]
    v_exp_f32 v241, v145
    v_mfma_f32_16x16x32_bf16 a[144:147], v[220:223], v[168:171], a[144:147]
    v_cvt_pk_bf16_f32 v189, v246, v247
    v_add_f32 v246, v246, v247
    v_mfma_f32_16x16x32_bf16 a[208:211], v[220:223], v[172:175], a[208:211]
    ds_read_b64_tr_b16 v[220:221], v249 offset:544
    v_mfma_f32_16x16x32_bf16 v[20:23], v[224:227], v[160:163], v[20:23]
    s_add_u32 m0, s35, 101792
    ds_read_b64_tr_b16 v[222:223], v249 offset:2592
    s_add_u32 s32, s32, 4096
    v_mfma_f32_16x16x32_bf16 v[84:87], v[224:227], v[164:167], v[84:87]
    buffer_load_dwordx4 v250, s[12:15], s32 offen offset:0 lds
    v_mfma_f32_16x16x32_bf16 a[148:151], v[224:227], v[168:171], a[148:151]
    v_exp_f32 v242, v146
    v_mfma_f32_16x16x32_bf16 a[212:215], v[224:227], v[172:175], a[212:215]
    s_waitcnt lgkmcnt(4)
    ds_read_b64_tr_b16 v[224:225], v249 offset:640
    v_add_f32 v239, v244, v246
    v_mfma_f32_16x16x32_bf16 v[24:27], v[208:211], v[160:163], v[24:27]
    buffer_load_dwordx4 v250, s[12:15], s32 offen offset:1024 lds
    ds_read_b64_tr_b16 v[226:227], v249 offset:2688
    v_mfma_f32_16x16x32_bf16 v[88:91], v[208:211], v[164:167], v[88:91]
    v_exp_f32 v243, v147
    v_mfma_f32_16x16x32_bf16 a[152:155], v[208:211], v[168:171], a[152:155]
    v_exp_f32 v244, v148
    v_mfma_f32_16x16x32_bf16 a[216:219], v[208:211], v[172:175], a[216:219]
    ds_read_b64_tr_b16 v[208:209], v249 offset:672
    v_cvt_pk_bf16_f32 v178, v240, v241
    v_mfma_f32_16x16x32_bf16 v[28:31], v[212:215], v[160:163], v[28:31]
    buffer_load_dwordx4 v250, s[12:15], s32 offen offset:2048 lds
    ds_read_b64_tr_b16 v[210:211], v249 offset:2720
    v_mfma_f32_16x16x32_bf16 v[92:95], v[212:215], v[164:167], v[92:95]
    v_add_f32 v240, v240, v241
    v_mfma_f32_16x16x32_bf16 a[156:159], v[212:215], v[168:171], a[156:159]
    v_exp_f32 v245, v149
    v_mfma_f32_16x16x32_bf16 a[220:223], v[212:215], v[172:175], a[220:223]
    s_waitcnt lgkmcnt(4)
    ds_read_b64_tr_b16 v[212:213], v249 offset:768
    v_mfma_f32_16x16x32_bf16 v[32:35], v[216:219], v[160:163], v[32:35]
    buffer_load_dwordx4 v250, s[12:15], s32 offen offset:3072 lds
    ds_read_b64_tr_b16 v[214:215], v249 offset:2816
    v_mfma_f32_16x16x32_bf16 v[96:99], v[216:219], v[164:167], v[96:99]
    v_cvt_pk_bf16_f32 v179, v242, v243
    v_add_f32 v242, v242, v243
    v_mfma_f32_16x16x32_bf16 a[160:163], v[216:219], v[168:171], a[160:163]
    v_exp_f32 v246, v150
    v_mfma_f32_16x16x32_bf16 a[224:227], v[216:219], v[172:175], a[224:227]
    ds_read_b64_tr_b16 v[216:217], v249 offset:800
    v_add_f32 v240, v240, v242
    v_mfma_f32_16x16x32_bf16 v[36:39], v[220:223], v[160:163], v[36:39]
    ds_read_b64_tr_b16 v[218:219], v249 offset:2848
    v_add_f32 v236, v236, v240
    v_mfma_f32_16x16x32_bf16 v[100:103], v[220:223], v[164:167], v[100:103]
    v_exp_f32 v247, v151
    v_mfma_f32_16x16x32_bf16 a[164:167], v[220:223], v[168:171], a[164:167]
    v_exp_f32 v240, v152
    v_mfma_f32_16x16x32_bf16 a[228:231], v[220:223], v[172:175], a[228:231]
    s_waitcnt lgkmcnt(4)
    ds_read_b64_tr_b16 v[220:221], v249 offset:896
    v_mfma_f32_16x16x32_bf16 v[40:43], v[224:227], v[160:163], v[40:43]
    ds_read_b64_tr_b16 v[222:223], v249 offset:2944
    v_cvt_pk_bf16_f32 v182, v244, v245
    v_mfma_f32_16x16x32_bf16 v[104:107], v[224:227], v[164:167], v[104:107]
    v_add_f32 v244, v244, v245
    v_mfma_f32_16x16x32_bf16 a[168:171], v[224:227], v[168:171], a[168:171]
    v_exp_f32 v241, v153
    v_mfma_f32_16x16x32_bf16 a[232:235], v[224:227], v[172:175], a[232:235]
    ds_read_b64_tr_b16 v[224:225], v249 offset:928
    v_cvt_pk_bf16_f32 v183, v246, v247
    v_mfma_f32_16x16x32_bf16 v[44:47], v[208:211], v[160:163], v[44:47]
    ds_read_b64_tr_b16 v[226:227], v249 offset:2976
    v_add_f32 v246, v246, v247
    v_mfma_f32_16x16x32_bf16 v[108:111], v[208:211], v[164:167], v[108:111]
    v_exp_f32 v242, v154
    v_mfma_f32_16x16x32_bf16 a[172:175], v[208:211], v[168:171], a[172:175]
    v_add_f32 v244, v244, v246
    v_add_f32 v237, v237, v244
    v_mfma_f32_16x16x32_bf16 a[236:239], v[208:211], v[172:175], a[236:239]
    s_waitcnt lgkmcnt(4)
    ds_read_b128 v[208:211], v248 offset:33088
    v_mfma_f32_16x16x32_bf16 v[48:51], v[212:215], v[160:163], v[48:51]
    v_exp_f32 v243, v155
    v_mfma_f32_16x16x32_bf16 v[112:115], v[212:215], v[164:167], v[112:115]
    v_exp_f32 v244, v156
    v_mfma_f32_16x16x32_bf16 a[176:179], v[212:215], v[168:171], a[176:179]
    v_cvt_pk_bf16_f32 v186, v240, v241
    v_add_f32 v240, v240, v241
    v_mfma_f32_16x16x32_bf16 a[240:243], v[212:215], v[172:175], a[240:243]
    ds_read_b128 v[212:215], v248 offset:33216
    v_mfma_f32_16x16x32_bf16 v[52:55], v[216:219], v[160:163], v[52:55]
    v_exp_f32 v245, v157
    v_mfma_f32_16x16x32_bf16 v[116:119], v[216:219], v[164:167], v[116:119]
    v_cvt_pk_bf16_f32 v187, v242, v243
    v_add_f32 v242, v242, v243
    v_mfma_f32_16x16x32_bf16 a[180:183], v[216:219], v[168:171], a[180:183]
    v_exp_f32 v246, v158
    v_mfma_f32_16x16x32_bf16 a[244:247], v[216:219], v[172:175], a[244:247]
    s_waitcnt lgkmcnt(2)
    ds_read_b128 v[216:219], v248 offset:33344
    v_mfma_f32_16x16x32_bf16 v[56:59], v[220:223], v[160:163], v[56:59]
    v_add_f32 v240, v240, v242
    v_add_f32 v238, v238, v240
    v_mfma_f32_16x16x32_bf16 v[120:123], v[220:223], v[164:167], v[120:123]
    v_exp_f32 v247, v159
    v_mfma_f32_16x16x32_bf16 a[184:187], v[220:223], v[168:171], a[184:187]
    v_cvt_pk_bf16_f32 v190, v244, v245
    v_add_f32 v244, v244, v245
    v_mfma_f32_16x16x32_bf16 a[248:251], v[220:223], v[172:175], a[248:251]
    ds_read_b128 v[220:223], v248 offset:33472
    v_cvt_pk_bf16_f32 v191, v246, v247
    v_mfma_f32_16x16x32_bf16 v[60:63], v[224:227], v[160:163], v[60:63]
    v_add_f32 v246, v246, v247
    v_add_f32 v244, v244, v246
    v_mfma_f32_16x16x32_bf16 v[124:127], v[224:227], v[164:167], v[124:127]
    v_add_f32 v239, v239, v244
    v_max3_f32 v240, v236, v237, v238
    v_mfma_f32_16x16x32_bf16 a[188:191], v[224:227], v[168:171], a[188:191]
    v_max_f32 v240, v240, v239
    v_cmp_lt_f32 vcc, s38, v240
    v_mfma_f32_16x16x32_bf16 a[252:255], v[224:227], v[172:175], a[252:255]
    s_waitcnt lgkmcnt(2)
    s_mov_b32 s37, 2
    s_cbranch_vccnz ka_kernel_slow
ka_kernel_ret2:
    s_sub_u32 s36, s36, 1
    s_cmp_lg_u32 s36, 0
    s_cbranch_scc1 ka_kernel_loop
    v_mfma_f32_16x16x32_bf16 v[128:131], v[208:211], a[0:3], v[192:195]
    ds_read_b128 v[224:227], v248 offset:33600
    v_add_f32 v232, v232, v236
    v_mfma_f32_16x16x32_bf16 v[132:135], v[208:211], a[4:7], v[196:199]
    v_add_f32 v233, v233, v237
    v_add_f32 v234, v234, v238
    v_mfma_f32_16x16x32_bf16 v[136:139], v[208:211], a[8:11], v[200:203]
    v_add_f32 v235, v235, v239
    v_mfma_f32_16x16x32_bf16 v[140:143], v[208:211], a[12:15], v[204:207]
    s_waitcnt vmcnt(8)
    s_barrier
    ds_read_b128 v[228:231], v248 offset:33728
    v_mfma_f32_16x16x32_bf16 v[128:131], v[212:215], a[16:19], v[128:131]
    s_add_u32 m0, s35, 0
    s_add_u32 s33, s39, s31
    buffer_load_dwordx4 v250, s[16:19], s33 offen offset:0 lds
    v_mfma_f32_16x16x32_bf16 v[132:135], v[212:215], a[20:23], v[132:135]
    v_mfma_f32_16x16x32_bf16 v[136:139], v[212:215], a[24:27], v[136:139]
    v_mfma_f32_16x16x32_bf16 v[140:143], v[212:215], a[28:31], v[140:143]
    s_waitcnt lgkmcnt(2)
    ds_read_b128 v[208:211], v248 offset:33856
    v_mfma_f32_16x16x32_bf16 v[128:131], v[216:219], a[32:35], v[128:131]
    s_add_u32 s39, s39, 16384
    buffer_load_dwordx4 v250, s[16:19], s33 offen offset:1024 lds
    v_mfma_f32_16x16x32_bf16 v[132:135], v[216:219], a[36:39], v[132:135]
    v_mfma_f32_16x16x32_bf16 v[136:139], v[216:219], a[40:43], v[136:139]
    v_mfma_f32_16x16x32_bf16 v[140:143], v[216:219], a[44:47], v[140:143]
    ds_read_b128 v[212:215], v248 offset:33984
    v_mfma_f32_16x16x32_bf16 v[128:131], v[220:223], a[48:51], v[128:131]
    s_and_b32 s39, s39, 0x7ffff
    buffer_load_dwordx4 v250, s[16:19], s33 offen offset:2048 lds
    v_mfma_f32_16x16x32_bf16 v[132:135], v[220:223], a[52:55], v[132:135]
    v_mfma_f32_16x16x32_bf16 v[136:139], v[220:223], a[56:59], v[136:139]
    v_mfma_f32_16x16x32_bf16 v[140:143], v[220:223], a[60:63], v[140:143]
    s_waitcnt lgkmcnt(2)
    ds_read_b128 v[216:219], v248 offset:35136
    v_mfma_f32_16x16x32_bf16 v[128:131], v[224:227], a[64:67], v[128:131]
    buffer_load_dwordx4 v250, s[16:19], s33 offen offset:3072 lds
    v_mfma_f32_16x16x32_bf16 v[132:135], v[224:227], a[68:71], v[132:135]
    v_mfma_f32_16x16x32_bf16 v[136:139], v[224:227], a[72:75], v[136:139]
    v_mfma_f32_16x16x32_bf16 v[140:143], v[224:227], a[76:79], v[140:143]
    ds_read_b128 v[220:223], v248 offset:35264
    v_mfma_f32_16x16x32_bf16 v[128:131], v[228:231], a[80:83], v[128:131]
    s_add_u32 m0, s35, 4128
    s_add_u32 s33, s33, 4096
    buffer_load_dwordx4 v250, s[16:19], s33 offen offset:0 lds
    v_mfma_f32_16x16x32_bf16 v[132:135], v[228:231], a[84:87], v[132:135]
    v_mfma_f32_16x16x32_bf16 v[136:139], v[228:231], a[88:91], v[136:139]
    v_mfma_f32_16x16x32_bf16 v[140:143], v[228:231], a[92:95], v[140:143]
    s_waitcnt lgkmcnt(2)
    ds_read_b128 v[224:227], v248 offset:35392
    v_mfma_f32_16x16x32_bf16 v[128:131], v[208:211], a[96:99], v[128:131]
    buffer_load_dwordx4 v250, s[16:19], s33 offen offset:1024 lds
    v_mfma_f32_16x16x32_bf16 v[132:135], v[208:211], a[100:103], v[132:135]
    v_mfma_f32_16x16x32_bf16 v[136:139], v[208:211], a[104:107], v[136:139]
    v_mfma_f32_16x16x32_bf16 v[140:143], v[208:211], a[108:111], v[140:143]
    ds_read_b128 v[228:231], v248 offset:35520
    v_mfma_f32_16x16x32_bf16 v[128:131], v[212:215], a[112:115], v[128:131]
    buffer_load_dwordx4 v250, s[16:19], s33 offen offset:2048 lds
    v_mfma_f32_16x16x32_bf16 v[132:135], v[212:215], a[116:119], v[132:135]
    v_mfma_f32_16x16x32_bf16 v[136:139], v[212:215], a[120:123], v[136:139]
    v_mfma_f32_16x16x32_bf16 v[140:143], v[212:215], a[124:127], v[140:143]
    s_waitcnt lgkmcnt(2)
    ds_read_b128 v[208:211], v248 offset:35648
    v_mfma_f32_16x16x32_bf16 v[144:147], v[216:219], a[0:3], v[192:195]
    buffer_load_dwordx4 v250, s[16:19], s33 offen offset:3072 lds
    v_mfma_f32_16x16x32_bf16 v[148:151], v[216:219], a[4:7], v[196:199]
    v_exp_f32 v240, v128
    v_mfma_f32_16x16x32_bf16 v[152:155], v[216:219], a[8:11], v[200:203]
    v_exp_f32 v241, v129
    v_mfma_f32_16x16x32_bf16 v[156:159], v[216:219], a[12:15], v[204:207]
    ds_read_b128 v[212:215], v248 offset:35776
    v_mfma_f32_16x16x32_bf16 v[144:147], v[220:223], a[16:19], v[144:147]
    v_exp_f32 v242, v130
    v_mfma_f32_16x16x32_bf16 v[148:151], v[220:223], a[20:23], v[148:151]
    v_exp_f32 v243, v131
    v_mfma_f32_16x16x32_bf16 v[152:155], v[220:223], a[24:27], v[152:155]
    v_exp_f32 v244, v132
    v_mfma_f32_16x16x32_bf16 v[156:159], v[220:223], a[28:31], v[156:159]
    s_waitcnt lgkmcnt(2)
    ds_read_b128 v[216:219], v248 offset:35904
    v_mfma_f32_16x16x32_bf16 v[144:147], v[224:227], a[32:35], v[144:147]
    s_getpc_b64 s[96:97]
ka_kernel_pc2:
    s_lshr_b32 s3, s2, 3
    s_lshl_b32 s3, s3, 2
    v_mfma_f32_16x16x32_bf16 v[148:151], v[224:227], a[36:39], v[148:151]
    s_add_u32 s3, s3, s24
    s_and_b32 s3, s3, 31
    s_lshl_b32 s3, s3, 10
    v_mfma_f32_16x16x32_bf16 v[152:155], v[224:227], a[40:43], v[152:155]
    v_add_u32 v174, s3, v250
    s_mov_b32 s3, ((kb_kernel_end-ka_kernel_pc2-16)/16)*16
    s_and_b32 s96, s96, 0xffffff80
    s_mov_b32 m0, 95872
    v_min_u32 v174, s3, v174
    v_mov_b32 v175, s97
    v_add_co_u32 v174, s[98:99], s96, v174
    s_nop 1
    v_addc_co_u32 v175, s[98:99], 0, v175, s[98:99]
    global_load_lds_dword v[174:175], off
    v_mfma_f32_16x16x32_bf16 v[156:159], v[224:227], a[44:47], v[156:159]
    ds_read_b128 v[220:223], v248 offset:36032
    v_cvt_pk_bf16_f32 v160, v240, v241
    v_add_f32 v240, v240, v241
    v_mfma_f32_16x16x32_bf16 v[144:147], v[228:231], a[48:51], v[144:147]
    v_exp_f32 v245, v133
    v_mfma_f32_16x16x32_bf16 v[148:151], v[228:231], a[52:55], v[148:151]
    v_cvt_pk_bf16_f32 v161, v242, v243
    v_add_f32 v242, v242, v243
    v_mfma_f32_16x16x32_bf16 v[152:155], v[228:231], a[56:59], v[152:155]
    v_exp_f32 v246, v134
    v_mfma_f32_16x16x32_bf16 v[156:159], v[228:231], a[60:63], v[156:159]
    s_waitcnt lgkmcnt(2)
    ds_read_b64_tr_b16 v[224:225], v249 offset:33088
    v_add_f32 v236, v240, v242
    v_mfma_f32_16x16x32_bf16 v[144:147], v[208:211], a[64:67], v[144:147]
    ds_read_b64_tr_b16 v[226:227], v249 offset:35136
    v_mfma_f32_16x16x32_bf16 v[148:151], v[208:211], a[68:71], v[148:151]
    v_exp_f32 v247, v135
    v_mfma_f32_16x16x32_bf16 v[152:155], v[208:211], a[72:75], v[152:155]
    v_exp_f32 v240, v136
    v_mfma_f32_16x16x32_bf16 v[156:159], v[208:211], a[76:79], v[156:159]
    ds_read_b64_tr_b16 v[208:209], v249 offset:33120
    v_cvt_pk_bf16_f32 v164, v244, v245
    v_mfma_f32_16x16x32_bf16 v[144:147], v[212:215], a[80:83], v[144:147]
    ds_read_b64_tr_b16 v[210:211], v249 offset:35168
    v_add_f32 v244, v244, v245
    v_mfma_f32_16x16x32_bf16 v[148:151], v[212:215], a[84:87], v[148:151]
    v_exp_f32 v241, v137
    v_mfma_f32_16x16x32_bf16 v[152:155], v[212:215], a[88:91], v[152:155]
    v_cvt_pk_bf16_f32 v165, v246, v247
    v_add_f32 v246, v246, v247
    v_mfma_f32_16x16x32_bf16 v[156:159], v[212:215], a[92:95], v[156:159]
    s_waitcnt lgkmcnt(4)
    ds_read_b64_tr_b16 v[212:213], v249 offset:33216
    v_mfma_f32_16x16x32_bf16 v[144:147], v[216:219], a[96:99], v[144:147]
    ds_read_b64_tr_b16 v[214:215], v249 offset:35264
    v_mfma_f32_16x16x32_bf16 v[148:151], v[216:219], a[100:103], v[148:151]
    v_exp_f32 v242, v138
    v_mfma_f32_16x16x32_bf16 v[152:155], v[216:219], a[104:107], v[152:155]
    v_add_f32 v237, v244, v246
    v_mfma_f32_16x16x32_bf16 v[156:159], v[216:219], a[108:111], v[156:159]
    ds_read_b64_tr_b16 v[216:217], v249 offset:33248
    v_mfma_f32_16x16x32_bf16 v[144:147], v[220:223], a[112:115], v[144:147]
    ds_read_b64_tr_b16 v[218:219], v249 offset:35296
    v_mfma_f32_16x16x32_bf16 v[148:151], v[220:223], a[116:119], v[148:151]
    v_exp_f32 v243, v139
    v_mfma_f32_16x16x32_bf16 v[152:155], v[220:223], a[120:123], v[152:155]
    v_exp_f32 v244, v140
    v_mfma_f32_16x16x32_bf16 v[156:159], v[220:223], a[124:127], v[156:159]
    s_waitcnt lgkmcnt(4)
    ds_read_b64_tr_b16 v[220:221], v249 offset:33344
    v_mfma_f32_16x16x32_bf16 v[0:3], v[224:227], v[176:179], v[0:3]
    ds_read_b64_tr_b16 v[222:223], v249 offset:35392
    v_cvt_pk_bf16_f32 v168, v240, v241
    v_mfma_f32_16x16x32_bf16 v[64:67], v[224:227], v[180:183], v[64:67]
    v_add_f32 v240, v240, v241
    v_mfma_f32_16x16x32_bf16 a[128:131], v[224:227], v[184:187], a[128:131]
    v_exp_f32 v245, v141
    v_mfma_f32_16x16x32_bf16 a[192:195], v[224:227], v[188:191], a[192:195]
    s_waitcnt vmcnt(9)
    s_barrier
    ds_read_b64_tr_b16 v[224:225], v249 offset:33376
    v_mfma_f32_16x16x32_bf16 v[4:7], v[208:211], v[176:179], v[4:7]
    s_add_u32 m0, s50, 0
    s_nop 0
    buffer_load_dwordx4 v251, s[44:47], s48 offen offset:0 lds
    ds_read_b64_tr_b16 v[226:227], v249 offset:35424
    v_mfma_f32_16x16x32_bf16 v[68:71], v[208:211], v[180:183], v[68:71]
    v_cvt_pk_bf16_f32 v169, v242, v243
    v_add_f32 v242, v242, v243
    v_mfma_f32_16x16x32_bf16 a[132:135], v[208:211], v[184:187], a[132:135]
    v_exp_f32 v246, v142
    v_mfma_f32_16x16x32_bf16 a[196:199], v[208:211], v[188:191], a[196:199]
    s_waitcnt lgkmcnt(4)
    ds_read_b64_tr_b16 v[208:209], v249 offset:33472
    v_mfma_f32_16x16x32_bf16 v[8:11], v[212:215], v[176:179], v[8:11]
    buffer_load_dwordx4 v252, s[44:47], s48 offen offset:1024 lds
    ds_read_b64_tr_b16 v[210:211], v249 offset:35520
    v_mfma_f32_16x16x32_bf16 v[72:75], v[212:215], v[180:183], v[72:75]
    v_add_f32 v238, v240, v242
    v_mfma_f32_16x16x32_bf16 a[136:139], v[212:215], v[184:187], a[136:139]
    v_exp_f32 v247, v143
    v_mfma_f32_16x16x32_bf16 a[200:203], v[212:215], v[188:191], a[200:203]
    ds_read_b64_tr_b16 v[212:213], v249 offset:33504
    v_mfma_f32_16x16x32_bf16 v[12:15], v[216:219], v[176:179], v[12:15]
    ds_read_b64_tr_b16 v[214:215], v249 offset:35552
    v_mfma_f32_16x16x32_bf16 v[76:79], v[216:219], v[180:183], v[76:79]
    buffer_load_dwordx4 v253, s[44:47], s48 offen offset:2048 lds
    s_add_u32 s48, s48, 28672
    v_mfma_f32_16x16x32_bf16 a[140:143], v[216:219], v[184:187], a[140:143]
    v_exp_f32 v240, v144
    v_mfma_f32_16x16x32_bf16 a[204:207], v[216:219], v[188:191], a[204:207]
    s_waitcnt lgkmcnt(4)
    ds_read_b64_tr_b16 v[216:217], v249 offset:33600
    v_mfma_f32_16x16x32_bf16 v[16:19], v[220:223], v[176:179], v[16:19]
    ds_read_b64_tr_b16 v[218:219], v249 offset:35648
    v_cvt_pk_bf16_f32 v172, v244, v245
    v_mfma_f32_16x16x32_bf16 v[80:83], v[220:223], v[180:183], v[80:83]
    s_add_u32 m0, s50, 3072
    s_nop 0
    buffer_load_dwordx4 v251, s[44:47], s48 offen offset:0 lds
    v_mfma_f32_16x16x32_bf16 a[144:147], v[220:223], v[184:187], a[144:147]
    v_add_f32 v244, v244, v245
    v_mfma_f32_16x16x32_bf16 a[208:211], v[220:223], v[188:191], a[208:211]
    ds_read_b64_tr_b16 v[220:221], v249 offset:33632
    v_mfma_f32_16x16x32_bf16 v[20:23], v[224:227], v[176:179], v[20:23]
    ds_read_b64_tr_b16 v[222:223], v249 offset:35680
    v_mfma_f32_16x16x32_bf16 v[84:87], v[224:227], v[180:183], v[84:87]
    v_exp_f32 v241, v145
    v_mfma_f32_16x16x32_bf16 a[148:151], v[224:227], v[184:187], a[148:151]
    buffer_load_dwordx4 v252, s[44:47], s48 offen offset:1024 lds
    v_cvt_pk_bf16_f32 v173, v246, v247
    v_mfma_f32_16x16x32_bf16 a[212:215], v[224:227], v[188:191], a[212:215]
    s_waitcnt lgkmcnt(4)
    ds_read_b64_tr_b16 v[224:225], v249 offset:33728
    v_mfma_f32_16x16x32_bf16 v[24:27], v[208:211], v[176:179], v[24:27]
    ds_read_b64_tr_b16 v[226:227], v249 offset:35776
    v_add_f32 v246, v246, v247
    v_mfma_f32_16x16x32_bf16 v[88:91], v[208:211], v[180:183], v[88:91]
    v_exp_f32 v242, v146
    v_mfma_f32_16x16x32_bf16 a[152:155], v[208:211], v[184:187], a[152:155]
    buffer_load_dwordx4 v253, s[44:47], s48 offen offset:2048 lds
    s_add_u32 s48, s48, 28672
    v_mfma_f32_16x16x32_bf16 a[216:219], v[208:211], v[188:191], a[216:219]
    ds_read_b64_tr_b16 v[208:209], v249 offset:33760
    v_add_f32 v239, v244, v246
    v_mfma_f32_16x16x32_bf16 v[28:31], v[212:215], v[176:179], v[28:31]
    ds_read_b64_tr_b16 v[210:211], v249 offset:35808
    v_mfma_f32_16x16x32_bf16 v[92:95], v[212:215], v[180:183], v[92:95]
    v_exp_f32 v243, v147
    v_mfma_f32_16x16x32_bf16 a[156:159], v[212:215], v[184:187], a[156:159]
    v_exp_f32 v244, v148
    v_mfma_f32_16x16x32_bf16 a[220:223], v[212:215], v[188:191], a[220:223]
    s_waitcnt lgkmcnt(4)
    ds_read_b64_tr_b16 v[212:213], v249 offset:33856
    s_add_u32 m0, s50, 64576
    v_mfma_f32_16x16x32_bf16 v[32:35], v[216:219], v[176:179], v[32:35]
    buffer_load_dwordx4 v251, s[44:47], s48 offen offset:0 lds
    v_cvt_pk_bf16_f32 v162, v240, v241
    v_mfma_f32_16x16x32_bf16 v[96:99], v[216:219], v[180:183], v[96:99]
    ds_read_b64_tr_b16 v[214:215], v249 offset:35904
    v_add_f32 v240, v240, v241
    v_mfma_f32_16x16x32_bf16 a[160:163], v[216:219], v[184:187], a[160:163]
    v_exp_f32 v245, v149
    v_mfma_f32_16x16x32_bf16 a[224:227], v[216:219], v[188:191], a[224:227]
    ds_read_b64_tr_b16 v[216:217], v249 offset:33888
    v_cvt_pk_bf16_f32 v163, v242, v243
    v_mfma_f32_16x16x32_bf16 v[36:39], v[220:223], v[176:179], v[36:39]
    buffer_load_dwordx4 v252, s[44:47], s48 offen offset:1024 lds
    ds_read_b64_tr_b16 v[218:219], v249 offset:35936
    v_mfma_f32_16x16x32_bf16 v[100:103], v[220:223], v[180:183], v[100:103]
    v_add_f32 v242, v242, v243
    v_mfma_f32_16x16x32_bf16 a[164:167], v[220:223], v[184:187], a[164:167]
    v_exp_f32 v246, v150
    v_mfma_f32_16x16x32_bf16 a[228:231], v[220:223], v[188:191], a[228:231]
    s_waitcnt lgkmcnt(4)
    ds_read_b64_tr_b16 v[220:221], v249 offset:33984
    v_mfma_f32_16x16x32_bf16 v[40:43], v[224:227], v[176:179], v[40:43]
    buffer_load_dwordx4 v253, s[44:47], s48 offen offset:2048 lds
    s_add_u32 s48, s48, 28672
    v_mfma_f32_16x16x32_bf16 v[104:107], v[224:227], v[180:183], v[104:107]
    ds_read_b64_tr_b16 v[222:223], v249 offset:36032
    v_add_f32 v240, v240, v242
    v_mfma_f32_16x16x32_bf16 a[168:171], v[224:227], v[184:187], a[168:171]
    v_add_f32 v236, v236, v240
    v_mfma_f32_16x16x32_bf16 a[232:235], v[224:227], v[188:191], a[232:235]
    ds_read_b64_tr_b16 v[224:225], v249 offset:34016
    v_mfma_f32_16x16x32_bf16 v[44:47], v[208:211], v[176:179], v[44:47]
    ds_read_b64_tr_b16 v[226:227], v249 offset:36064
    v_exp_f32 v247, v151
    v_mfma_f32_16x16x32_bf16 v[108:111], v[208:211], v[180:183], v[108:111]
    s_add_u32 m0, s50, 67648
    s_nop 0
    buffer_load_dwordx4 v251, s[44:47], s48 offen offset:0 lds
    v_mfma_f32_16x16x32_bf16 a[172:175], v[208:211], v[184:187], a[172:175]
    v_exp_f32 v240, v152
    v_mfma_f32_16x16x32_bf16 a[236:239], v[208:211], v[188:191], a[236:239]
    s_waitcnt lgkmcnt(4)
    ds_read_b128 v[208:211], v248 offset:0
    v_mfma_f32_16x16x32_bf16 v[48:51], v[212:215], v[176:179], v[48:51]
    v_cvt_pk_bf16_f32 v166, v244, v245
    v_add_f32 v244, v244, v245
    v_mfma_f32_16x16x32_bf16 v[112:115], v[212:215], v[180:183], v[112:115]
    buffer_load_dwordx4 v252, s[44:47], s48 offen offset:1024 lds
    v_mfma_f32_16x16x32_bf16 a[176:179], v[212:215], v[184:187], a[176:179]
    v_exp_f32 v241, v153
    v_mfma_f32_16x16x32_bf16 a[240:243], v[212:215], v[188:191], a[240:243]
    ds_read_b128 v[212:215], v248 offset:128
    v_cvt_pk_bf16_f32 v167, v246, v247
    v_mfma_f32_16x16x32_bf16 v[52:55], v[216:219], v[176:179], v[52:55]
    v_add_f32 v246, v246, v247
    v_mfma_f32_16x16x32_bf16 v[116:119], v[216:219], v[180:183], v[116:119]
    v_exp_f32 v242, v154
    v_mfma_f32_16x16x32_bf16 a[180:183], v[216:219], v[184:187], a[180:183]
    buffer_load_dwordx4 v253, s[44:47], s48 offen offset:2048 lds
    s_add_u32 s48, s48, 28672
    v_mfma_f32_16x16x32_bf16 a[244:247], v[216:219], v[188:191], a[244:247]
    s_waitcnt lgkmcnt(2)
    ds_read_b128 v[216:219], v248 offset:256
    v_mfma_f32_16x16x32_bf16 v[56:59], v[220:223], v[176:179], v[56:59]
    v_add_f32 v244, v244, v246
    v_add_f32 v237, v237, v244
    v_mfma_f32_16x16x32_bf16 v[120:123], v[220:223], v[180:183], v[120:123]
    v_exp_f32 v243, v155
    v_mfma_f32_16x16x32_bf16 a[184:187], v[220:223], v[184:187], a[184:187]
    v_exp_f32 v244, v156
    v_mfma_f32_16x16x32_bf16 a[248:251], v[220:223], v[188:191], a[248:251]
    ds_read_b128 v[220:223], v248 offset:384
    v_cvt_pk_bf16_f32 v170, v240, v241
    v_mfma_f32_16x16x32_bf16 v[60:63], v[224:227], v[176:179], v[60:63]
    v_add_f32 v240, v240, v241
    v_mfma_f32_16x16x32_bf16 v[124:127], v[224:227], v[180:183], v[124:127]
    v_exp_f32 v245, v157
    v_mfma_f32_16x16x32_bf16 a[188:191], v[224:227], v[184:187], a[188:191]
    v_cvt_pk_bf16_f32 v171, v242, v243
    v_add_f32 v242, v242, v243
    v_mfma_f32_16x16x32_bf16 a[252:255], v[224:227], v[188:191], a[252:255]
    s_waitcnt lgkmcnt(2)
    v_exp_f32 v246, v158
    v_add_f32 v240, v240, v242
    v_add_f32 v238, v238, v240
    v_exp_f32 v247, v159
    v_cvt_pk_bf16_f32 v174, v244, v245
    v_add_f32 v244, v244, v245
    v_cvt_pk_bf16_f32 v175, v246, v247
    v_add_f32 v246, v246, v247
    v_add_f32 v244, v244, v246
    v_add_f32 v239, v239, v244
    v_max3_f32 v240, v236, v237, v238
    v_max_f32 v240, v240, v239
    v_cmp_lt_f32 vcc, s38, v240
    s_mov_b32 s37, 3
    s_cbranch_vccnz ka_kernel_slow
ka_kernel_ret3:
    v_mfma_f32_16x16x32_bf16 v[128:131], v[208:211], a[0:3], v[192:195]
    ds_read_b128 v[224:227], v248 offset:512
    v_add_f32 v232, v232, v236
    v_mfma_f32_16x16x32_bf16 v[132:135], v[208:211], a[4:7], v[196:199]
    v_add_f32 v233, v233, v237
    v_add_f32 v234, v234, v238
    v_mfma_f32_16x16x32_bf16 v[136:139], v[208:211], a[8:11], v[200:203]
    v_add_f32 v235, v235, v239
    v_mfma_f32_16x16x32_bf16 v[140:143], v[208:211], a[12:15], v[204:207]
    s_waitcnt vmcnt(13)
    s_barrier
    ds_read_b128 v[228:231], v248 offset:640
    v_mfma_f32_16x16x32_bf16 v[128:131], v[212:215], a[16:19], v[128:131]
    s_add_u32 m0, s35, 33088
    s_add_u32 s33, s39, s31
    buffer_load_dwordx4 v250, s[16:19], s33 offen offset:0 lds
    v_mfma_f32_16x16x32_bf16 v[132:135], v[212:215], a[20:23], v[132:135]
    v_mfma_f32_16x16x32_bf16 v[136:139], v[212:215], a[24:27], v[136:139]
    v_mfma_f32_16x16x32_bf16 v[140:143], v[212:215], a[28:31], v[140:143]
    s_waitcnt lgkmcnt(2)
    ds_read_b128 v[208:211], v248 offset:768
    v_mfma_f32_16x16x32_bf16 v[128:131], v[216:219], a[32:35], v[128:131]
    s_add_u32 s39, s39, 16384
    buffer_load_dwordx4 v250, s[16:19], s33 offen offset:1024 lds
    v_mfma_f32_16x16x32_bf16 v[132:135], v[216:219], a[36:39], v[132:135]
    v_mfma_f32_16x16x32_bf16 v[136:139], v[216:219], a[40:43], v[136:139]
    v_mfma_f32_16x16x32_bf16 v[140:143], v[216:219], a[44:47], v[140:143]
    ds_read_b128 v[212:215], v248 offset:896
    v_mfma_f32_16x16x32_bf16 v[128:131], v[220:223], a[48:51], v[128:131]
    s_and_b32 s39, s39, 0x7ffff
    buffer_load_dwordx4 v250, s[16:19], s33 offen offset:2048 lds
    v_mfma_f32_16x16x32_bf16 v[132:135], v[220:223], a[52:55], v[132:135]
    v_mfma_f32_16x16x32_bf16 v[136:139], v[220:223], a[56:59], v[136:139]
    v_mfma_f32_16x16x32_bf16 v[140:143], v[220:223], a[60:63], v[140:143]
    s_waitcnt lgkmcnt(2)
    ds_read_b128 v[216:219], v248 offset:2048
    v_mfma_f32_16x16x32_bf16 v[128:131], v[224:227], a[64:67], v[128:131]
    buffer_load_dwordx4 v250, s[16:19], s33 offen offset:3072 lds
    v_mfma_f32_16x16x32_bf16 v[132:135], v[224:227], a[68:71], v[132:135]
    v_mfma_f32_16x16x32_bf16 v[136:139], v[224:227], a[72:75], v[136:139]
    v_mfma_f32_16x16x32_bf16 v[140:143], v[224:227], a[76:79], v[140:143]
    ds_read_b128 v[220:223], v248 offset:2176
    v_mfma_f32_16x16x32_bf16 v[128:131], v[228:231], a[80:83], v[128:131]
    s_add_u32 m0, s35, 37216
    s_add_u32 s33, s33, 4096
    buffer_load_dwordx4 v250, s[16:19], s33 offen offset:0 lds
    v_mfma_f32_16x16x32_bf16 v[132:135], v[228:231], a[84:87], v[132:135]
    v_mfma_f32_16x16x32_bf16 v[136:139], v[228:231], a[88:91], v[136:139]
    v_mfma_f32_16x16x32_bf16 v[140:143], v[228:231], a[92:95], v[140:143]
    s_waitcnt lgkmcnt(2)
    ds_read_b128 v[224:227], v248 offset:2304
    v_mfma_f32_16x16x32_bf16 v[128:131], v[208:211], a[96:99], v[128:131]
    buffer_load_dwordx4 v250, s[16:19], s33 offen offset:1024 lds
    v_mfma_f32_16x16x32_bf16 v[132:135], v[208:211], a[100:103], v[132:135]
    v_mfma_f32_16x16x32_bf16 v[136:139], v[208:211], a[104:107], v[136:139]
    v_mfma_f32_16x16x32_bf16 v[140:143], v[208:211], a[108:111], v[140:143]
    ds_read_b128 v[228:231], v248 offset:2432
    v_mfma_f32_16x16x32_bf16 v[128:131], v[212:215], a[112:115], v[128:131]
    buffer_load_dwordx4 v250, s[16:19], s33 offen offset:2048 lds
    v_mfma_f32_16x16x32_bf16 v[132:135], v[212:215], a[116:119], v[132:135]
    v_mfma_f32_16x16x32_bf16 v[136:139], v[212:215], a[120:123], v[136:139]
    v_mfma_f32_16x16x32_bf16 v[140:143], v[212:215], a[124:127], v[140:143]
    s_waitcnt lgkmcnt(2)
    ds_read_b128 v[208:211], v248 offset:2560
    v_mfma_f32_16x16x32_bf16 v[144:147], v[216:219], a[0:3], v[192:195]
    buffer_load_dwordx4 v250, s[16:19], s33 offen offset:3072 lds
    v_mfma_f32_16x16x32_bf16 v[148:151], v[216:219], a[4:7], v[196:199]
    v_exp_f32 v240, v128
    v_mfma_f32_16x16x32_bf16 v[152:155], v[216:219], a[8:11], v[200:203]
    v_exp_f32 v241, v129
    v_mfma_f32_16x16x32_bf16 v[156:159], v[216:219], a[12:15], v[204:207]
    ds_read_b128 v[212:215], v248 offset:2688
    v_mfma_f32_16x16x32_bf16 v[144:147], v[220:223], a[16:19], v[144:147]
    v_exp_f32 v242, v130
    v_mfma_f32_16x16x32_bf16 v[148:151], v[220:223], a[20:23], v[148:151]
    v_exp_f32 v243, v131
    v_mfma_f32_16x16x32_bf16 v[152:155], v[220:223], a[24:27], v[152:155]
    v_exp_f32 v244, v132
    v_mfma_f32_16x16x32_bf16 v[156:159], v[220:223], a[28:31], v[156:159]
    s_waitcnt lgkmcnt(2)
    ds_read_b128 v[216:219], v248 offset:2816
    v_mfma_f32_16x16x32_bf16 v[144:147], v[224:227], a[32:35], v[144:147]
    v_cvt_pk_bf16_f32 v176, v240, v241
    v_add_f32 v240, v240, v241
    v_mfma_f32_16x16x32_bf16 v[148:151], v[224:227], a[36:39], v[148:151]
    v_exp_f32 v245, v133
    v_mfma_f32_16x16x32_bf16 v[152:155], v[224:227], a[40:43], v[152:155]
    v_cvt_pk_bf16_f32 v177, v242, v243
    v_add_f32 v242, v242, v243
    v_mfma_f32_16x16x32_bf16 v[156:159], v[224:227], a[44:47], v[156:159]
    ds_read_b128 v[220:223], v248 offset:2944
    v_mfma_f32_16x16x32_bf16 v[144:147], v[228:231], a[48:51], v[144:147]
    v_exp_f32 v246, v134
    v_mfma_f32_16x16x32_bf16 v[148:151], v[228:231], a[52:55], v[148:151]
    v_add_f32 v236, v240, v242
    v_mfma_f32_16x16x32_bf16 v[152:155], v[228:231], a[56:59], v[152:155]
    v_exp_f32 v247, v135
    v_mfma_f32_16x16x32_bf16 v[156:159], v[228:231], a[60:63], v[156:159]
    s_waitcnt lgkmcnt(2)
    ds_read_b64_tr_b16 v[224:225], v249 offset:0
    v_mfma_f32_16x16x32_bf16 v[144:147], v[208:211], a[64:67], v[144:147]
    ds_read_b64_tr_b16 v[226:227], v249 offset:2048
    v_mfma_f32_16x16x32_bf16 v[148:151], v[208:211], a[68:71], v[148:151]
    v_exp_f32 v240, v136
    v_mfma_f32_16x16x32_bf16 v[152:155], v[208:211], a[72:75], v[152:155]
    v_cvt_pk_bf16_f32 v180, v244, v245
    v_add_f32 v244, v244, v245
    v_mfma_f32_16x16x32_bf16 v[156:159], v[208:211], a[76:79], v[156:159]
    ds_read_b64_tr_b16 v[208:209], v249 offset:32
    v_mfma_f32_16x16x32_bf16 v[144:147], v[212:215], a[80:83], v[144:147]
    ds_read_b64_tr_b16 v[210:211], v249 offset:2080
    v_mfma_f32_16x16x32_bf16 v[148:151], v[212:215], a[84:87], v[148:151]
    v_exp_f32 v241, v137
    v_mfma_f32_16x16x32_bf16 v[152:155], v[212:215], a[88:91], v[152:155]
    v_cvt_pk_bf16_f32 v181, v246, v247
    v_add_f32 v246, v246, v247
    v_mfma_f32_16x16x32_bf16 v[156:159], v[212:215], a[92:95], v[156:159]
    s_waitcnt lgkmcnt(4)
    ds_read_b64_tr_b16 v[212:213], v249 offset:128
    v_mfma_f32_16x16x32_bf16 v[144:147], v[216:219], a[96:99], v[144:147]
    ds_read_b64_tr_b16 v[214:215], v249 offset:2176
    v_mfma_f32_16x16x32_bf16 v[148:151], v[216:219], a[100:103], v[148:151]
    v_exp_f32 v242, v138
    v_mfma_f32_16x16x32_bf16 v[152:155], v[216:219], a[104:107], v[152:155]
    v_add_f32 v237, v244, v246
    v_mfma_f32_16x16x32_bf16 v[156:159], v[216:219], a[108:111], v[156:159]
    ds_read_b64_tr_b16 v[216:217], v249 offset:160
    v_mfma_f32_16x16x32_bf16 v[144:147], v[220:223], a[112:115], v[144:147]
    ds_read_b64_tr_b16 v[218:219], v249 offset:2208
    v_mfma_f32_16x16x32_bf16 v[148:151], v[220:223], a[116:119], v[148:151]
    v_exp_f32 v243, v139
    v_mfma_f32_16x16x32_bf16 v[152:155], v[220:223], a[120:123], v[152:155]
    v_exp_f32 v244, v140
    v_mfma_f32_16x16x32_bf16 v[156:159], v[220:223], a[124:127], v[156:159]
    s_waitcnt lgkmcnt(4)
    ds_read_b64_tr_b16 v[220:221], v249 offset:256
    v_mfma_f32_16x16x32_bf16 v[0:3], v[224:227], v[160:163], v[0:3]
    ds_read_b64_tr_b16 v[222:223], v249 offset:2304
    v_add_u32 v248, 64576, v254
    v_mfma_f32_16x16x32_bf16 v[64:67], v[224:227], v[164:167], v[64:67]
    v_cvt_pk_bf16_f32 v184, v240, v241
    v_add_f32 v240, v240, v241
    v_mfma_f32_16x16x32_bf16 a[128:131], v[224:227], v[168:171], a[128:131]
    v_exp_f32 v245, v141
    v_mfma_f32_16x16x32_bf16 a[192:195], v[224:227], v[172:175], a[192:195]
    s_waitcnt vmcnt(8)
    s_barrier
    ds_read_b64_tr_b16 v[224:225], v249 offset:288
    v_mfma_f32_16x16x32_bf16 v[4:7], v[208:211], v[160:163], v[4:7]
    s_add_u32 m0, s50, 31488
    s_nop 0
    buffer_load_dwordx4 v251, s[44:47], s48 offen offset:0 lds
    ds_read_b64_tr_b16 v[226:227], v249 offset:2336
    v_mfma_f32_16x16x32_bf16 v[68:71], v[208:211], v[164:167], v[68:71]
    ds_read_b64_tr_b16 a[0:1], v254 offset:0
    ds_read_b64_tr_b16 a[2:3], v254 offset:1536
    v_mfma_f32_16x16x32_bf16 a[132:135], v[208:211], v[168:171], a[132:135]
    ds_read_b64_tr_b16 a[4:5], v254 offset:32
    ds_read_b64_tr_b16 a[6:7], v254 offset:1568
    v_mfma_f32_16x16x32_bf16 a[196:199], v[208:211], v[172:175], a[196:199]
    s_waitcnt lgkmcnt(8)
    buffer_load_dwordx4 v252, s[44:47], s48 offen offset:1024 lds
    ds_read_b64_tr_b16 v[208:209], v249 offset:384
    v_mfma_f32_16x16x32_bf16 v[8:11], v[212:215], v[160:163], v[8:11]
    ds_read_b64_tr_b16 a[8:9], v254 offset:64
    ds_read_b64_tr_b16 v[210:211], v249 offset:2432
    v_mfma_f32_16x16x32_bf16 v[72:75], v[212:215], v[164:167], v[72:75]
    ds_read_b64_tr_b16 a[10:11], v254 offset:1600
    ds_read_b64_tr_b16 a[12:13], v254 offset:3072
    v_mfma_f32_16x16x32_bf16 a[136:139], v[212:215], v[168:171], a[136:139]
    buffer_load_dwordx4 v253, s[44:47], s48 offen offset:2048 lds
    s_add_u32 s48, s48, 28672
    v_mfma_f32_16x16x32_bf16 a[200:203], v[212:215], v[172:175], a[200:203]
    ds_read_b64_tr_b16 a[14:15], v254 offset:4608
    ds_read_b64_tr_b16 v[212:213], v249 offset:416
    v_mfma_f32_16x16x32_bf16 v[12:15], v[216:219], v[160:163], v[12:15]
    s_waitcnt lgkmcnt(9)
    ds_read_b64_tr_b16 a[16:17], v254 offset:3104
    ds_read_b64_tr_b16 v[214:215], v249 offset:2464
    v_mfma_f32_16x16x32_bf16 v[76:79], v[216:219], v[164:167], v[76:79]
    s_add_u32 m0, s50, 34560
    s_nop 0
    buffer_load_dwordx4 v251, s[44:47], s48 offen offset:0 lds
    v_mfma_f32_16x16x32_bf16 a[140:143], v[216:219], v[168:171], a[140:143]
    ds_read_b64_tr_b16 a[18:19], v254 offset:4640
    ds_read_b64_tr_b16 a[20:21], v254 offset:3136
    v_mfma_f32_16x16x32_bf16 a[204:207], v[216:219], v[172:175], a[204:207]
    ds_read_b64_tr_b16 v[216:217], v249 offset:512
    v_mfma_f32_16x16x32_bf16 v[16:19], v[220:223], v[160:163], v[16:19]
    buffer_load_dwordx4 v252, s[44:47], s48 offen offset:1024 lds
    ds_read_b64_tr_b16 v[218:219], v249 offset:2560
    v_mfma_f32_16x16x32_bf16 v[80:83], v[220:223], v[164:167], v[80:83]
    s_waitcnt lgkmcnt(9)
    ds_read_b64_tr_b16 a[22:23], v254 offset:4672
    ds_read_b64_tr_b16 a[24:25], v248 offset:0
    v_mfma_f32_16x16x32_bf16 a[144:147], v[220:223], v[168:171], a[144:147]
    ds_read_b64_tr_b16 a[26:27], v248 offset:1536
    ds_read_b64_tr_b16 a[28:29], v248 offset:32
    v_mfma_f32_16x16x32_bf16 a[208:211], v[220:223], v[172:175], a[208:211]
    buffer_load_dwordx4 v253, s[44:47], s48 offen offset:2048 lds
    s_add_u32 s48, s48, 28672
    v_mfma_f32_16x16x32_bf16 v[20:23], v[224:227], v[160:163], v[20:23]
    ds_read_b64_tr_b16 v[220:221], v249 offset:544
    ds_read_b64_tr_b16 a[30:31], v248 offset:1568
    v_mfma_f32_16x16x32_bf16 v[84:87], v[224:227], v[164:167], v[84:87]
    s_waitcnt lgkmcnt(9)
    ds_read_b64_tr_b16 v[222:223], v249 offset:2592
    ds_read_b64_tr_b16 a[32:33], v248 offset:64
    v_mfma_f32_16x16x32_bf16 a[148:151], v[224:227], v[168:171], a[148:151]
    ds_read_b64_tr_b16 a[34:35], v248 offset:1600
    ds_read_b64_tr_b16 a[36:37], v248 offset:3072
    v_mfma_f32_16x16x32_bf16 a[212:215], v[224:227], v[172:175], a[212:215]
    ds_read_b64_tr_b16 a[38:39], v248 offset:4608
    ds_read_b64_tr_b16 v[224:225], v249 offset:640
    v_mfma_f32_16x16x32_bf16 v[24:27], v[208:211], v[160:163], v[24:27]
    s_waitcnt lgkmcnt(9)
    ds_read_b64_tr_b16 a[40:41], v248 offset:3104
    ds_read_b64_tr_b16 v[226:227], v249 offset:2688
    v_mfma_f32_16x16x32_bf16 v[88:91], v[208:211], v[164:167], v[88:91]
    s_nop 0
    ds_read_b64_tr_b16 a[42:43], v248 offset:4640
    s_add_u32 m0, s50, 0
    v_mfma_f32_16x16x32_bf16 a[152:155], v[208:211], v[168:171], a[152:155]
    ds_read_b64_tr_b16 a[44:45], v248 offset:3136
    v_cvt_pk_bf16_f32 v185, v242, v243
    v_mfma_f32_16x16x32_bf16 a[216:219], v[208:211], v[172:175], a[216:219]
    buffer_load_dwordx4 v251, s[44:47], s48 offen offset:0 lds
    ds_read_b64_tr_b16 a[46:47], v248 offset:4672
    v_mfma_f32_16x16x32_bf16 v[28:31], v[212:215], v[160:163], v[28:31]
    ds_read_b64_tr_b16 v[208:209], v249 offset:672
    v_add_f32 v242, v242, v243
    v_mfma_f32_16x16x32_bf16 v[92:95], v[212:215], v[164:167], v[92:95]
    buffer_load_dwordx4 v252, s[44:47], s48 offen offset:1024 lds
    s_waitcnt lgkmcnt(9)
    ds_read_b64_tr_b16 v[210:211], v249 offset:2720
    v_mfma_f32_16x16x32_bf16 a[156:159], v[212:215], v[168:171], a[156:159]
    v_exp_f32 v246, v142
    v_mfma_f32_16x16x32_bf16 a[220:223], v[212:215], v[172:175], a[220:223]
    buffer_load_dwordx4 v253, s[44:47], s48 offen offset:2048 lds
    v_add_f32 v238, v240, v242
    v_mfma_f32_16x16x32_bf16 v[32:35], v[216:219], v[160:163], v[32:35]
    s_add_u32 s48, s48, 28672
    ds_read_b64_tr_b16 v[212:213], v249 offset:768
    ds_read_b64_tr_b16 v[214:215], v249 offset:2816
    v_mfma_f32_16x16x32_bf16 v[96:99], v[216:219], v[164:167], v[96:99]
    v_exp_f32 v247, v143
    v_mfma_f32_16x16x32_bf16 a[160:163], v[216:219], v[168:171], a[160:163]
    s_add_u32 m0, s50, 3072
    s_nop 0
    buffer_load_dwordx4 v251, s[44:47], s48 offen offset:0 lds
    v_mfma_f32_16x16x32_bf16 a[224:227], v[216:219], v[172:175], a[224:227]
    ds_read_b64_tr_b16 v[216:217], v249 offset:800
    v_mfma_f32_16x16x32_bf16 v[36:39], v[220:223], v[160:163], v[36:39]
    ds_read_b64_tr_b16 v[218:219], v249 offset:2848
    v_mfma_f32_16x16x32_bf16 v[100:103], v[220:223], v[164:167], v[100:103]
    buffer_load_dwordx4 v252, s[44:47], s48 offen offset:1024 lds
    v_mfma_f32_16x16x32_bf16 a[164:167], v[220:223], v[168:171], a[164:167]
    v_exp_f32 v240, v144
    v_mfma_f32_16x16x32_bf16 a[228:231], v[220:223], v[172:175], a[228:231]
    s_waitcnt lgkmcnt(4)
    ds_read_b64_tr_b16 v[220:221], v249 offset:896
    v_mfma_f32_16x16x32_bf16 v[40:43], v[224:227], v[160:163], v[40:43]
    buffer_load_dwordx4 v253, s[44:47], s48 offen offset:2048 lds
    s_add_u32 s48, s48, 28672
    v_mfma_f32_16x16x32_bf16 v[104:107], v[224:227], v[164:167], v[104:107]
    ds_read_b64_tr_b16 v[222:223], v249 offset:2944
    v_cvt_pk_bf16_f32 v188, v244, v245
    v_mfma_f32_16x16x32_bf16 a[168:171], v[224:227], v[168:171], a[168:171]
    v_add_f32 v244, v244, v245
    v_mfma_f32_16x16x32_bf16 a[232:235], v[224:227], v[172:175], a[232:235]
    ds_read_b64_tr_b16 v[224:225], v249 offset:928
    v_mfma_f32_16x16x32_bf16 v[44:47], v[208:211], v[160:163], v[44:47]
    ds_read_b64_tr_b16 v[226:227], v249 offset:2976
    v_exp_f32 v241, v145
    v_mfma_f32_16x16x32_bf16 v[108:111], v[208:211], v[164:167], v[108:111]
    s_waitcnt vmcnt(12)
    v_cvt_pk_bf16_f32 v189, v246, v247
    v_add_f32 v246, v246, v247
    v_mfma_f32_16x16x32_bf16 a[172:175], v[208:211], v[168:171], a[172:175]
    s_barrier
    v_exp_f32 v242, v146
    v_mfma_f32_16x16x32_bf16 a[236:239], v[208:211], v[172:175], a[236:239]
    s_waitcnt lgkmcnt(4)
    ds_read_b64_tr_b16 v[208:209], v249 offset:33088
    v_mfma_f32_16x16x32_bf16 v[48:51], v[212:215], v[160:163], v[48:51]
    ds_read_b64_tr_b16 v[210:211], v249 offset:35136
    v_add_f32 v239, v244, v246
    v_mfma_f32_16x16x32_bf16 v[112:115], v[212:215], v[164:167], v[112:115]
    v_exp_f32 v243, v147
    v_mfma_f32_16x16x32_bf16 a[176:179], v[212:215], v[168:171], a[176:179]
    v_exp_f32 v244, v148
    v_mfma_f32_16x16x32_bf16 a[240:243], v[212:215], v[172:175], a[240:243]
    ds_read_b64_tr_b16 v[212:213], v249 offset:33120
    v_cvt_pk_bf16_f32 v178, v240, v241
    v_mfma_f32_16x16x32_bf16 v[52:55], v[216:219], v[160:163], v[52:55]
    ds_read_b64_tr_b16 v[214:215], v249 offset:35168
    v_add_f32 v240, v240, v241
    v_mfma_f32_16x16x32_bf16 v[116:119], v[216:219], v[164:167], v[116:119]
    v_exp_f32 v245, v149
    v_mfma_f32_16x16x32_bf16 a[180:183], v[216:219], v[168:171], a[180:183]
    v_cvt_pk_bf16_f32 v179, v242, v243
    v_add_f32 v242, v242, v243
    v_mfma_f32_16x16x32_bf16 a[244:247], v[216:219], v[172:175], a[244:247]
    s_waitcnt lgkmcnt(4)
    ds_read_b64_tr_b16 v[216:217], v249 offset:33216
    v_mfma_f32_16x16x32_bf16 v[56:59], v[220:223], v[160:163], v[56:59]
    ds_read_b64_tr_b16 v[218:219], v249 offset:35264
    v_mfma_f32_16x16x32_bf16 v[120:123], v[220:223], v[164:167], v[120:123]
    v_exp_f32 v246, v150
    v_mfma_f32_16x16x32_bf16 a[184:187], v[220:223], v[168:171], a[184:187]
    v_add_f32 v240, v240, v242
    v_add_f32 v236, v236, v240
    v_mfma_f32_16x16x32_bf16 a[248:251], v[220:223], v[172:175], a[248:251]
    ds_read_b64_tr_b16 v[220:221], v249 offset:33248
    v_mfma_f32_16x16x32_bf16 v[60:63], v[224:227], v[160:163], v[60:63]
    ds_read_b64_tr_b16 v[222:223], v249 offset:35296
    v_mfma_f32_16x16x32_bf16 v[124:127], v[224:227], v[164:167], v[124:127]
    v_exp_f32 v247, v151
    v_mfma_f32_16x16x32_bf16 a[188:191], v[224:227], v[168:171], a[188:191]
    v_exp_f32 v240, v152
    v_mfma_f32_16x16x32_bf16 a[252:255], v[224:227], v[172:175], a[252:255]
    s_waitcnt lgkmcnt(4)
    v_cvt_pk_bf16_f32 v182, v244, v245
    v_add_f32 v244, v244, v245
    v_exp_f32 v241, v153
    v_cvt_pk_bf16_f32 v183, v246, v247
    v_add_f32 v246, v246, v247
    v_exp_f32 v242, v154
    v_add_f32 v244, v244, v246
    v_add_f32 v237, v237, v244
    v_exp_f32 v243, v155
    v_exp_f32 v244, v156
    v_cvt_pk_bf16_f32 v186, v240, v241
    v_add_f32 v240, v240, v241
    v_exp_f32 v245, v157
    v_cvt_pk_bf16_f32 v187, v242, v243
    v_add_f32 v242, v242, v243
    v_exp_f32 v246, v158
    v_add_f32 v240, v240, v242
    v_add_f32 v238, v238, v240
    v_exp_f32 v247, v159
    v_cvt_pk_bf16_f32 v190, v244, v245
    v_add_f32 v244, v244, v245
    v_cvt_pk_bf16_f32 v191, v246, v247
    v_add_f32 v246, v246, v247
    v_add_f32 v244, v244, v246
    v_add_f32 v239, v239, v244
    v_max3_f32 v240, v236, v237, v238
    v_max_f32 v240, v240, v239
    v_cmp_lt_f32 vcc, s38, v240
    s_mov_b32 s37, 4
    s_cbranch_vccnz ka_kernel_slow
ka_kernel_ret4:
    v_mfma_f32_16x16x32_bf16 v[0:3], v[208:211], v[176:179], v[0:3]
    ds_read_b64_tr_b16 v[224:225], v249 offset:33344
    s_waitcnt vmcnt(6)
    v_mfma_f32_16x16x32_bf16 v[64:67], v[208:211], v[180:183], v[64:67]
    s_lshr_b32 s3, s2, 3
    ds_read_b64_tr_b16 v[226:227], v249 offset:35392
    v_add_f32 v232, v232, v236
    v_mfma_f32_16x16x32_bf16 a[128:131], v[208:211], v[184:187], a[128:131]
    s_lshl_b32 s3, s3, 2
    ds_read_b64_tr_b16 a[48:49], v254 offset:31488
    s_add_u32 s3, s3, s24
    v_mfma_f32_16x16x32_bf16 a[192:195], v[208:211], v[188:191], a[192:195]
    s_mov_b32 m0, 95872
    ds_read_b64_tr_b16 a[50:51], v254 offset:33024
    s_mul_i32 s3, s3, 12544
    s_add_u32 s3, s3, 0
    v_lshlrev_b32 v148, 7, v255
    buffer_load_dword v148, s[40:43], s3 offen lds
    s_lshr_b32 s3, s2, 3
    s_lshl_b32 s3, s3, 2
    s_add_u32 s3, s3, s24
    s_mov_b32 m0, 95872
    s_mul_i32 s3, s3, 12544
    s_add_u32 s3, s3, 4352
    v_lshlrev_b32 v148, 7, v255
    buffer_load_dword v148, s[40:43], s3 offen lds
    s_lshr_b32 s3, s2, 3
    s_lshl_b32 s3, s3, 2
    s_add_u32 s3, s3, s24
    s_mov_b32 m0, 95872
    s_mul_i32 s3, s3, 7168
    s_and_b32 s34, s2, 7
    s_mul_i32 s34, s34, 917504
    s_add_u32 s3, s3, s34
    v_lshlrev_b32 v148, 7, v255
    buffer_load_dword v148, s[20:23], s3 offen lds
    v_mfma_f32_16x16x32_bf16 v[4:7], v[212:215], v[176:179], v[4:7]
    ds_read_b64_tr_b16 a[52:53], v254 offset:31520
    ds_read_b64_tr_b16 v[228:229], v249 offset:33376
    v_add_f32 v233, v233, v237
    v_mfma_f32_16x16x32_bf16 v[68:71], v[212:215], v[180:183], v[68:71]
    ds_read_b64_tr_b16 a[54:55], v254 offset:33056
    ds_read_b64_tr_b16 v[230:231], v249 offset:35424
    v_add_f32 v234, v234, v238
    v_mfma_f32_16x16x32_bf16 a[132:135], v[212:215], v[184:187], a[132:135]
    ds_read_b64_tr_b16 a[56:57], v254 offset:31552
    ds_read_b64_tr_b16 a[58:59], v254 offset:33088
    v_add_f32 v235, v235, v239
    v_mfma_f32_16x16x32_bf16 a[196:199], v[212:215], v[188:191], a[196:199]
    s_waitcnt lgkmcnt(10)
    ds_read_b64_tr_b16 a[60:61], v254 offset:34560
    ds_read_b64_tr_b16 a[62:63], v254 offset:36096
    v_mov_b32 v128, v232
    v_mfma_f32_16x16x32_bf16 v[8:11], v[216:219], v[176:179], v[8:11]
    ds_read_b64_tr_b16 v[208:209], v249 offset:33472
    v_mov_b32 v129, v233
    v_mfma_f32_16x16x32_bf16 v[72:75], v[216:219], v[180:183], v[72:75]
    ds_read_b64_tr_b16 a[64:65], v254 offset:34592
    ds_read_b64_tr_b16 v[210:211], v249 offset:35520
    v_mov_b32 v130, v234
    v_mfma_f32_16x16x32_bf16 a[136:139], v[216:219], v[184:187], a[136:139]
    s_waitcnt lgkmcnt(9)
    ds_read_b64_tr_b16 a[66:67], v254 offset:36128
    ds_read_b64_tr_b16 a[68:69], v254 offset:34624
    v_mov_b32 v131, v235
    v_mfma_f32_16x16x32_bf16 a[200:203], v[216:219], v[188:191], a[200:203]
    ds_read_b64_tr_b16 a[70:71], v254 offset:36160
    v_permlane32_swap_b32 v232, v128
    v_mfma_f32_16x16x32_bf16 v[12:15], v[220:223], v[176:179], v[12:15]
    ds_read_b64_tr_b16 v[212:213], v249 offset:33504
    v_permlane32_swap_b32 v233, v129
    v_permlane32_swap_b32 v234, v130
    v_mfma_f32_16x16x32_bf16 v[76:79], v[220:223], v[180:183], v[76:79]
    ds_read_b64_tr_b16 v[214:215], v249 offset:35552
    v_permlane32_swap_b32 v235, v131
    v_add_f32 v232, v232, v128
    v_mfma_f32_16x16x32_bf16 a[140:143], v[220:223], v[184:187], a[140:143]
    v_add_f32 v233, v233, v129
    v_add_f32 v234, v234, v130
    v_mfma_f32_16x16x32_bf16 a[204:207], v[220:223], v[188:191], a[204:207]
    s_waitcnt lgkmcnt(12)
    ds_read_b64_tr_b16 v[216:217], v249 offset:33600
    v_add_f32 v235, v235, v131
    v_mov_b32 v128, v232
    v_mov_b32 v129, v233
    v_mfma_f32_16x16x32_bf16 v[16:19], v[224:227], v[176:179], v[16:19]
    ds_read_b64_tr_b16 v[218:219], v249 offset:35648
    v_mov_b32 v130, v234
    v_mov_b32 v131, v235
    v_permlane16_swap_b32 v232, v128
    v_mfma_f32_16x16x32_bf16 v[80:83], v[224:227], v[180:183], v[80:83]
    v_permlane16_swap_b32 v233, v129
    v_permlane16_swap_b32 v234, v130
    v_mfma_f32_16x16x32_bf16 a[144:147], v[224:227], v[184:187], a[144:147]
    v_permlane16_swap_b32 v235, v131
    v_add_f32 v232, v232, v128
    v_mfma_f32_16x16x32_bf16 a[208:211], v[224:227], v[188:191], a[208:211]
    s_lshl_b32 s3, s24, 8
    ds_read_b64_tr_b16 v[220:221], v249 offset:33632
    v_add_f32 v233, v233, v129
    v_add_f32 v133, v234, v130
    v_mfma_f32_16x16x32_bf16 v[20:23], v[228:231], v[176:179], v[20:23]
    s_add_u32 s3, s3, 0x9000
    v_add_f32 v135, v235, v131
    v_mov_b32 v132, v200
    v_mov_b32 v134, v204
    v_mfma_f32_16x16x32_bf16 v[84:87], v[228:231], v[180:183], v[84:87]
    v_and_b32 v136, 15, v255
    v_lshl_add_u32 v136, v136, 4, s3
    s_waitcnt lgkmcnt(9)
    ds_write_b128 v136, v[132:135] offset:57984
    ds_read_b64_tr_b16 v[222:223], v249 offset:35680
    v_mfma_f32_16x16x32_bf16 a[148:151], v[228:231], v[184:187], a[148:151]
    s_waitcnt lgkmcnt(1)
    v_xor_b32 v136, 0x100, v136
    v_lshlrev_b32 v246, 4, v255
    v_add_u32 v241, s51, v246
    v_xor_b32 v240, 0x2000, v241
    v_lshlrev_b32 v137, 1, v241
    v_sub_u32 v137, v137, v246
    v_add_u32 v236, 97664, v137
    v_xor_b32 v138, 16384, v137
    v_add_u32 v237, 97664, v138
    v_xor_b32 v138, 32768, v137
    v_add_u32 v238, 97664, v138
    v_xor_b32 v138, 49152, v137
    v_add_u32 v239, 97664, v138
    v_mfma_f32_16x16x32_bf16 a[212:215], v[228:231], v[188:191], a[212:215]
    s_barrier
    ds_read_b128 v[132:135], v136 offset:57984
    ds_write_b128 v237, a[128:131] offset:0
    v_mfma_f32_16x16x32_bf16 v[24:27], v[208:211], v[176:179], v[24:27]
    ds_write_b128 v237, a[192:195] offset:1024
    ds_read_b64_tr_b16 v[224:225], v249 offset:33728
    v_mfma_f32_16x16x32_bf16 v[88:91], v[208:211], v[180:183], v[88:91]
    ds_read_b64_tr_b16 v[226:227], v249 offset:35776
    ds_write_b128 v237, a[132:135] offset:2048
    v_mfma_f32_16x16x32_bf16 a[152:155], v[208:211], v[184:187], a[152:155]
    v_mfma_f32_16x16x32_bf16 a[216:219], v[208:211], v[188:191], a[216:219]
    ds_write_b128 v237, a[196:199] offset:3072
    s_waitcnt vmcnt(3)
    v_mfma_f32_16x16x32_bf16 v[28:31], v[212:215], v[176:179], v[28:31]
    ds_read_b64_tr_b16 v[228:229], v249 offset:33760
    ds_write_b128 v237, a[136:139] offset:4096
    v_mfma_f32_16x16x32_bf16 v[92:95], v[212:215], v[180:183], v[92:95]
    s_waitcnt lgkmcnt(8)
    ds_read_b64_tr_b16 v[230:231], v249 offset:35808
    v_min_f32 v138, v192, v132
    v_mfma_f32_16x16x32_bf16 a[156:159], v[212:215], v[184:187], a[156:159]
    ds_read_b64_tr_b16 a[72:73], v254 offset:0
    ds_read_b64_tr_b16 a[74:75], v254 offset:1536
    v_mfma_f32_16x16x32_bf16 a[220:223], v[212:215], v[188:191], a[220:223]
    ds_read_b64_tr_b16 a[76:77], v254 offset:32
    ds_write_b128 v237, a[200:203] offset:5120
    v_mfma_f32_16x16x32_bf16 v[32:35], v[216:219], v[176:179], v[32:35]
    ds_read_b64_tr_b16 v[208:209], v249 offset:33856
    v_min_f32 v140, v196, v134
    v_mfma_f32_16x16x32_bf16 v[96:99], v[216:219], v[180:183], v[96:99]
    ds_write_b128 v237, a[140:143] offset:6144
    s_waitcnt lgkmcnt(9)
    ds_read_b64_tr_b16 v[210:211], v249 offset:35904
    v_sub_f32 v242, v138, v192
    v_mfma_f32_16x16x32_bf16 a[160:163], v[216:219], v[184:187], a[160:163]
    ds_read_b64_tr_b16 a[78:79], v254 offset:1568
    ds_write_b128 v237, a[204:207] offset:7168
    v_sub_f32 v243, v140, v196
    v_mfma_f32_16x16x32_bf16 a[224:227], v[216:219], v[188:191], a[224:227]
    ds_read_b64_tr_b16 a[80:81], v254 offset:64
    ds_read_b64_tr_b16 a[82:83], v254 offset:1600
    v_sub_f32 v244, v138, v132
    v_mfma_f32_16x16x32_bf16 v[36:39], v[220:223], v[176:179], v[36:39]
    ds_write_b128 v237, a[144:147] offset:8192
    s_waitcnt lgkmcnt(9)
    ds_read_b64_tr_b16 v[212:213], v249 offset:33888
    v_sub_f32 v245, v140, v134
    v_mfma_f32_16x16x32_bf16 v[100:103], v[220:223], v[180:183], v[100:103]
    ds_read_b64_tr_b16 a[84:85], v254 offset:3072
    ds_read_b64_tr_b16 v[214:215], v249 offset:35936
    v_exp_f32 v242, v242
    v_mfma_f32_16x16x32_bf16 a[164:167], v[220:223], v[184:187], a[164:167]
    ds_read_b64_tr_b16 a[86:87], v254 offset:4608
    ds_write_b128 v237, a[208:211] offset:9216
    v_exp_f32 v243, v243
    v_mfma_f32_16x16x32_bf16 a[228:231], v[220:223], v[188:191], a[228:231]
    ds_read_b64_tr_b16 a[88:89], v254 offset:3104
    s_waitcnt lgkmcnt(9)
    ds_write_b128 v237, a[148:151] offset:10240
    v_exp_f32 v244, v244
    v_mfma_f32_16x16x32_bf16 v[40:43], v[224:227], v[176:179], v[40:43]
    ds_read_b64_tr_b16 v[216:217], v249 offset:33984
    v_exp_f32 v245, v245
    v_mfma_f32_16x16x32_bf16 v[104:107], v[224:227], v[180:183], v[104:107]
    ds_write_b128 v237, a[212:215] offset:11264
    ds_read_b64_tr_b16 v[218:219], v249 offset:36032
    v_mul_f32 v139, v242, v232
    v_mfma_f32_16x16x32_bf16 a[168:171], v[224:227], v[184:187], a[168:171]
    ds_read_b64_tr_b16 a[90:91], v254 offset:4640
    ds_read_b64_tr_b16 a[92:93], v254 offset:3136
    v_mul_f32 v141, v243, v233
    v_mfma_f32_16x16x32_bf16 a[232:235], v[224:227], v[188:191], a[232:235]
    s_waitcnt lgkmcnt(9)
    ds_read_b64_tr_b16 a[94:95], v254 offset:4672
    ds_write_b128 v237, a[152:155] offset:12288
    v_fma_f32 v139, v244, v133, v139
    v_mfma_f32_16x16x32_bf16 v[44:47], v[228:231], v[176:179], v[44:47]
    ds_write_b128 v237, a[216:219] offset:13312
    ds_read_b64_tr_b16 v[220:221], v249 offset:34016
    v_fma_f32 v141, v245, v135, v141
    v_mfma_f32_16x16x32_bf16 v[108:111], v[228:231], v[180:183], v[108:111]
    ds_read_b64_tr_b16 v[222:223], v249 offset:36064
    v_rcp_f32 v139, v139
    v_mfma_f32_16x16x32_bf16 a[172:175], v[228:231], v[184:187], a[172:175]
    ds_write_b128 v237, a[156:159] offset:14336
    v_rcp_f32 v141, v141
    v_mul_f32 v242, v242, v139
    v_mfma_f32_16x16x32_bf16 a[236:239], v[228:231], v[188:191], a[236:239]
    s_waitcnt lgkmcnt(9)
    ds_write_b128 v237, a[220:223] offset:15360
    v_mul_f32 v243, v243, v141
    v_mul_f32 v244, v244, v139
    v_mfma_f32_16x16x32_bf16 v[48:51], v[208:211], v[176:179], v[48:51]
    ds_write_b128 v240, a[160:163] offset:0
    v_mul_f32 v245, v245, v141
    v_mfma_f32_16x16x32_bf16 v[112:115], v[208:211], v[180:183], v[112:115]
    v_mfma_f32_16x16x32_bf16 a[176:179], v[208:211], v[184:187], a[176:179]
    ds_write_b128 v240, a[224:227] offset:1024
    v_mfma_f32_16x16x32_bf16 a[240:243], v[208:211], v[188:191], a[240:243]
    v_mfma_f32_16x16x32_bf16 v[52:55], v[212:215], v[176:179], v[52:55]
    ds_write_b128 v240, a[164:167] offset:2048
    v_mfma_f32_16x16x32_bf16 v[116:119], v[212:215], v[180:183], v[116:119]
    ds_write_b128 v240, a[228:231] offset:3072
    v_mfma_f32_16x16x32_bf16 a[180:183], v[212:215], v[184:187], a[180:183]
    v_mfma_f32_16x16x32_bf16 a[244:247], v[212:215], v[188:191], a[244:247]
    s_waitcnt lgkmcnt(6)
    ds_write_b128 v240, a[168:171] offset:4096
    v_mfma_f32_16x16x32_bf16 v[56:59], v[216:219], v[176:179], v[56:59]
    v_mfma_f32_16x16x32_bf16 v[120:123], v[216:219], v[180:183], v[120:123]
    ds_write_b128 v240, a[232:235] offset:5120
    v_mfma_f32_16x16x32_bf16 a[184:187], v[216:219], v[184:187], a[184:187]
    ds_write_b128 v240, a[172:175] offset:6144
    v_mfma_f32_16x16x32_bf16 a[248:251], v[216:219], v[188:191], a[248:251]
    v_mfma_f32_16x16x32_bf16 v[60:63], v[220:223], v[176:179], v[60:63]
    ds_write_b128 v240, a[236:239] offset:7168
    v_mfma_f32_16x16x32_bf16 v[124:127], v[220:223], v[180:183], v[124:127]
    v_mfma_f32_16x16x32_bf16 a[188:191], v[220:223], v[184:187], a[188:191]
    v_mfma_f32_16x16x32_bf16 a[252:255], v[220:223], v[188:191], a[252:255]
    s_waitcnt lgkmcnt(0)
    s_barrier
    s_movk_i32 s3, 896
    ds_read_b128 v[128:131], v241 offset:0
    ds_read_b128 v[132:135], v241 offset:2048
    v_lshrrev_b32 v252, 3, v255
    v_mul_u32_u24 v248, s3, v252
    v_lshrrev_b32 v252, 1, v252
    v_bfe_u32 v253, v255, 1, 2
    v_xor_b32 v252, v252, v253
    v_lshl_add_u32 v248, v252, 5, v248
    v_and_b32 v253, 1, v255
    v_lshl_add_u32 v248, v253, 4, v248
    v_add_u32 v249, 6144, v248
    v_add_u32 v250, 12288, v248
    v_add_u32 v251, 18432, v248
    v_bfe_u32 v252, v255, 2, 3
    v_lshlrev_b32 v252, 7, v252
    v_bfe_u32 v253, v255, 5, 1
    v_lshl_add_u32 v252, v253, 10, v252
    v_bfe_u32 v253, v255, 0, 2
    v_lshl_add_u32 v252, v253, 3, v252
    v_bfe_u32 v253, v255, 3, 2
    v_lshl_add_u32 v252, v253, 5, v252
    v_add_u32 v253, s52, v252
    v_add_u32 v252, s51, v252
    v_mul_f32 v32, v242, v32
    v_mul_f32 v33, v242, v33
    v_mul_f32 v34, v242, v34
    v_mul_f32 v35, v242, v35
    v_mul_f32 v36, v242, v36
    v_mul_f32 v37, v242, v37
    v_mul_f32 v38, v242, v38
    v_mul_f32 v39, v242, v39
    s_waitcnt lgkmcnt(0)
    v_fma_f32 v32, v244, v128, v32
    v_fma_f32 v33, v244, v129, v33
    v_fma_f32 v34, v244, v130, v34
    v_fma_f32 v35, v244, v131, v35
    v_fma_f32 v36, v244, v132, v36
    v_fma_f32 v37, v244, v133, v37
    v_fma_f32 v38, v244, v134, v38
    v_fma_f32 v39, v244, v135, v39
    v_cvt_pk_bf16_f32 v32, v32, v33
    v_cvt_pk_bf16_f32 v33, v34, v35
    v_cvt_pk_bf16_f32 v34, v36, v37
    v_cvt_pk_bf16_f32 v35, v38, v39
    s_nop 1
    v_mfma_f32_16x16x32_bf16 v[192:195], a[48:51], v[32:35], 0
    ds_read_b128 v[136:139], v241 offset:1024
    ds_read_b128 v[140:143], v241 offset:3072
    ds_read_b128 v[144:147], v241 offset:4096
    ds_read_b128 v[148:151], v241 offset:6144
    ds_read_b128 v[152:155], v241 offset:5120
    ds_read_b128 v[156:159], v241 offset:7168
    ds_read_b128 v[160:163], v236 offset:0
    ds_read_b128 v[164:167], v236 offset:2048
    ds_write_b128 v240, a[176:179] offset:33088
    ds_write_b128 v240, a[240:243] offset:34112
    ds_read_b128 v[168:171], v236 offset:1024
    ds_read_b128 v[172:175], v236 offset:3072
    ds_write_b128 v240, a[180:183] offset:35136
    ds_write_b128 v240, a[244:247] offset:36160
    ds_read_b128 v[128:131], v236 offset:4096
    s_waitcnt lgkmcnt(9)
    ds_read_b128 v[132:135], v236 offset:6144
    ds_write_b128 v240, a[184:187] offset:37184
    ds_write_b128 v240, a[248:251] offset:38208
    v_mul_f32 v96, v243, v96
    v_mul_f32 v97, v243, v97
    v_mul_f32 v98, v243, v98
    v_mul_f32 v99, v243, v99
    v_mul_f32 v100, v243, v100
    v_mul_f32 v101, v243, v101
    v_mul_f32 v102, v243, v102
    v_mul_f32 v103, v243, v103
    v_fma_f32 v96, v245, v136, v96
    v_fma_f32 v97, v245, v137, v97
    v_fma_f32 v98, v245, v138, v98
    v_fma_f32 v99, v245, v139, v99
    v_fma_f32 v100, v245, v140, v100
    v_fma_f32 v101, v245, v141, v101
    v_fma_f32 v102, v245, v142, v102
    v_fma_f32 v103, v245, v143, v103
    v_cvt_pk_bf16_f32 v96, v96, v97
    v_cvt_pk_bf16_f32 v97, v98, v99
    v_cvt_pk_bf16_f32 v98, v100, v101
    v_cvt_pk_bf16_f32 v99, v102, v103
    v_mul_f32 v40, v242, v40
    v_mul_f32 v41, v242, v41
    v_mul_f32 v42, v242, v42
    v_mul_f32 v43, v242, v43
    v_mul_f32 v44, v242, v44
    v_mul_f32 v45, v242, v45
    v_mul_f32 v46, v242, v46
    v_mul_f32 v47, v242, v47
    v_fma_f32 v40, v244, v144, v40
    v_fma_f32 v41, v244, v145, v41
    v_fma_f32 v42, v244, v146, v42
    v_fma_f32 v43, v244, v147, v43
    v_fma_f32 v44, v244, v148, v44
    v_fma_f32 v45, v244, v149, v45
    v_fma_f32 v46, v244, v150, v46
    v_fma_f32 v47, v244, v151, v47
    ds_read_b128 v[136:139], v236 offset:5120
    ds_read_b128 v[140:143], v236 offset:7168
    ds_write_b128 v240, a[188:191] offset:39232
    s_waitcnt lgkmcnt(9)
    ds_write_b128 v240, a[252:255] offset:40256
    ds_read_b128 v[144:147], v236 offset:8192
    ds_read_b128 v[148:151], v236 offset:10240
    v_mfma_f32_16x16x32_bf16 v[200:203], a[52:55], v[32:35], 0
    v_cvt_pk_bf16_f32 v40, v40, v41
    v_cvt_pk_bf16_f32 v41, v42, v43
    v_cvt_pk_bf16_f32 v42, v44, v45
    v_cvt_pk_bf16_f32 v43, v46, v47
    v_mul_f32 v104, v243, v104
    v_mul_f32 v105, v243, v105
    v_mul_f32 v106, v243, v106
    v_mul_f32 v107, v243, v107
    v_mul_f32 v108, v243, v108
    v_mul_f32 v109, v243, v109
    v_mul_f32 v110, v243, v110
    v_mul_f32 v111, v243, v111
    v_fma_f32 v104, v245, v152, v104
    v_fma_f32 v105, v245, v153, v105
    v_fma_f32 v106, v245, v154, v106
    v_fma_f32 v107, v245, v155, v107
    v_fma_f32 v108, v245, v156, v108
    v_fma_f32 v109, v245, v157, v109
    v_fma_f32 v110, v245, v158, v110
    v_fma_f32 v111, v245, v159, v111
    v_cvt_pk_bf16_f32 v104, v104, v105
    v_cvt_pk_bf16_f32 v105, v106, v107
    v_cvt_pk_bf16_f32 v106, v108, v109
    v_cvt_pk_bf16_f32 v107, v110, v111
    ds_read_b128 v[152:155], v236 offset:9216
    ds_read_b128 v[156:159], v236 offset:11264
    v_mfma_f32_16x16x32_bf16 v[208:211], a[56:59], v[32:35], 0
    s_add_u32 m0, s51, 0
    s_nop 0
    buffer_load_dwordx4 v248, s[44:47], s49 offen offset:0 lds
    v_mul_f32 v0, v242, v0
    v_mul_f32 v1, v242, v1
    v_mul_f32 v2, v242, v2
    v_mul_f32 v3, v242, v3
    v_mul_f32 v4, v242, v4
    v_mul_f32 v5, v242, v5
    v_mul_f32 v6, v242, v6
    v_mul_f32 v7, v242, v7
    v_fma_f32 v0, v244, v160, v0
    v_fma_f32 v1, v244, v161, v1
    v_fma_f32 v2, v244, v162, v2
    v_fma_f32 v3, v244, v163, v3
    v_fma_f32 v4, v244, v164, v4
    v_fma_f32 v5, v244, v165, v5
    v_fma_f32 v6, v244, v166, v6
    v_fma_f32 v7, v244, v167, v7
    v_cvt_pk_bf16_f32 v0, v0, v1
    v_cvt_pk_bf16_f32 v1, v2, v3
    v_cvt_pk_bf16_f32 v2, v4, v5
    v_cvt_pk_bf16_f32 v3, v6, v7
    ds_write_b128 v236, v[0:3] offset:0
    v_mfma_f32_16x16x32_bf16 v[196:199], a[48:51], v[96:99], 0
    s_waitcnt lgkmcnt(9)
    ds_read_b128 v[160:163], v236 offset:12288
    v_mul_f32 v64, v243, v64
    v_mfma_f32_16x16x32_bf16 v[204:207], a[52:55], v[96:99], 0
    ds_read_b128 v[164:167], v236 offset:14336
    v_mul_f32 v65, v243, v65
    v_mfma_f32_16x16x32_bf16 v[212:215], a[56:59], v[96:99], 0
    buffer_load_dwordx4 v249, s[44:47], s49 offen offset:1024 lds
    v_mul_f32 v66, v243, v66
    v_mul_f32 v67, v243, v67
    v_mul_f32 v68, v243, v68
    v_mul_f32 v69, v243, v69
    v_mul_f32 v70, v243, v70
    v_mul_f32 v71, v243, v71
    v_fma_f32 v64, v245, v168, v64
    v_fma_f32 v65, v245, v169, v65
    v_fma_f32 v66, v245, v170, v66
    v_fma_f32 v67, v245, v171, v67
    v_fma_f32 v68, v245, v172, v68
    v_fma_f32 v69, v245, v173, v69
    v_fma_f32 v70, v245, v174, v70
    v_fma_f32 v71, v245, v175, v71
    v_cvt_pk_bf16_f32 v64, v64, v65
    v_cvt_pk_bf16_f32 v65, v66, v67
    v_cvt_pk_bf16_f32 v66, v68, v69
    v_cvt_pk_bf16_f32 v67, v70, v71
    ds_write_b128 v236, v[64:67] offset:1024
    v_mfma_f32_16x16x32_bf16 v[192:195], a[60:63], v[40:43], v[192:195]
    ds_read_b128 v[168:171], v236 offset:13312
    v_mul_f32 v8, v242, v8
    v_mfma_f32_16x16x32_bf16 v[200:203], a[64:67], v[40:43], v[200:203]
    ds_read_b128 v[172:175], v236 offset:15360
    v_mul_f32 v9, v242, v9
    v_mfma_f32_16x16x32_bf16 v[208:211], a[68:71], v[40:43], v[208:211]
    buffer_load_dwordx4 v250, s[44:47], s49 offen offset:2048 lds
    v_mul_f32 v10, v242, v10
    v_mul_f32 v11, v242, v11
    v_mul_f32 v12, v242, v12
    v_mul_f32 v13, v242, v13
    v_mul_f32 v14, v242, v14
    v_mul_f32 v15, v242, v15
    v_fma_f32 v8, v244, v128, v8
    v_fma_f32 v9, v244, v129, v9
    v_fma_f32 v10, v244, v130, v10
    v_fma_f32 v11, v244, v131, v11
    v_fma_f32 v12, v244, v132, v12
    v_fma_f32 v13, v244, v133, v13
    v_fma_f32 v14, v244, v134, v14
    v_fma_f32 v15, v244, v135, v15
    v_cvt_pk_bf16_f32 v8, v8, v9
    v_cvt_pk_bf16_f32 v9, v10, v11
    v_cvt_pk_bf16_f32 v10, v12, v13
    v_cvt_pk_bf16_f32 v11, v14, v15
    ds_write_b128 v236, v[8:11] offset:2048
    v_mfma_f32_16x16x32_bf16 v[196:199], a[60:63], v[104:107], v[196:199]
    s_waitcnt lgkmcnt(11)
    s_barrier
    v_mul_f32 v72, v243, v72
    v_mfma_f32_16x16x32_bf16 v[204:207], a[64:67], v[104:107], v[204:207]
    ds_read_b128 v[128:131], v241 offset:33088
    ds_read_b128 v[132:135], v241 offset:35136
    v_mfma_f32_16x16x32_bf16 v[212:215], a[68:71], v[104:107], v[212:215]
    buffer_load_dwordx4 v251, s[44:47], s49 offen offset:3072 lds
    s_add_u32 s49, s49, 28672
    v_mul_f32 v73, v243, v73
    v_mul_f32 v74, v243, v74
    v_mul_f32 v75, v243, v75
    v_mul_f32 v76, v243, v76
    v_mul_f32 v77, v243, v77
    v_mul_f32 v78, v243, v78
    v_mul_f32 v79, v243, v79
    v_fma_f32 v72, v245, v136, v72
    v_fma_f32 v73, v245, v137, v73
    v_fma_f32 v74, v245, v138, v74
    v_fma_f32 v75, v245, v139, v75
    v_fma_f32 v76, v245, v140, v76
    v_fma_f32 v77, v245, v141, v77
    v_fma_f32 v78, v245, v142, v78
    v_fma_f32 v79, v245, v143, v79
    v_cvt_pk_bf16_f32 v72, v72, v73
    v_cvt_pk_bf16_f32 v73, v74, v75
    v_cvt_pk_bf16_f32 v74, v76, v77
    v_cvt_pk_bf16_f32 v75, v78, v79
    ds_write_b128 v236, v[72:75] offset:3072
    v_mfma_f32_16x16x32_bf16 v[192:195], a[0:3], v[0:3], v[192:195]
    s_waitcnt lgkmcnt(12)
    ds_read_b128 v[136:139], v241 offset:34112
    v_mul_f32 v16, v242, v16
    v_mfma_f32_16x16x32_bf16 v[200:203], a[4:7], v[0:3], v[200:203]
    ds_read_b128 v[140:143], v241 offset:36160
    v_mul_f32 v17, v242, v17
    v_mfma_f32_16x16x32_bf16 v[208:211], a[8:11], v[0:3], v[208:211]
    s_add_u32 m0, s51, 4096
    s_nop 0
    buffer_load_dwordx4 v248, s[44:47], s49 offen offset:0 lds
    v_mul_f32 v18, v242, v18
    v_mul_f32 v19, v242, v19
    v_mul_f32 v20, v242, v20
    v_mul_f32 v21, v242, v21
    v_mul_f32 v22, v242, v22
    v_mul_f32 v23, v242, v23
    v_fma_f32 v16, v244, v144, v16
    v_fma_f32 v17, v244, v145, v17
    v_fma_f32 v18, v244, v146, v18
    v_fma_f32 v19, v244, v147, v19
    v_fma_f32 v20, v244, v148, v20
    v_fma_f32 v21, v244, v149, v21
    v_fma_f32 v22, v244, v150, v22
    v_fma_f32 v23, v244, v151, v23
    v_cvt_pk_bf16_f32 v16, v16, v17
    v_cvt_pk_bf16_f32 v17, v18, v19
    v_cvt_pk_bf16_f32 v18, v20, v21
    v_cvt_pk_bf16_f32 v19, v22, v23
    ds_write_b128 v236, v[16:19] offset:4096
    s_waitcnt lgkmcnt(9)
    ds_write_b128 v236, v[32:35] offset:8192
    ds_write_b128 v236, v[40:43] offset:10240
    v_mfma_f32_16x16x32_bf16 v[196:199], a[0:3], v[64:67], v[196:199]
    ds_read_b128 v[144:147], v241 offset:37184
    v_mul_f32 v80, v243, v80
    v_mfma_f32_16x16x32_bf16 v[204:207], a[4:7], v[64:67], v[204:207]
    ds_read_b128 v[148:151], v241 offset:39232
    v_mul_f32 v81, v243, v81
    v_mfma_f32_16x16x32_bf16 v[212:215], a[8:11], v[64:67], v[212:215]
    buffer_load_dwordx4 v249, s[44:47], s49 offen offset:1024 lds
    v_mul_f32 v82, v243, v82
    v_mul_f32 v83, v243, v83
    v_mul_f32 v84, v243, v84
    v_mul_f32 v85, v243, v85
    v_mul_f32 v86, v243, v86
    v_mul_f32 v87, v243, v87
    v_fma_f32 v80, v245, v152, v80
    v_fma_f32 v81, v245, v153, v81
    v_fma_f32 v82, v245, v154, v82
    v_fma_f32 v83, v245, v155, v83
    v_fma_f32 v84, v245, v156, v84
    v_fma_f32 v85, v245, v157, v85
    v_fma_f32 v86, v245, v158, v86
    v_fma_f32 v87, v245, v159, v87
    v_cvt_pk_bf16_f32 v80, v80, v81
    v_cvt_pk_bf16_f32 v81, v82, v83
    v_cvt_pk_bf16_f32 v82, v84, v85
    v_cvt_pk_bf16_f32 v83, v86, v87
    ds_write_b128 v236, v[80:83] offset:5120
    ds_write_b128 v236, v[96:99] offset:9216
    s_waitcnt lgkmcnt(9)
    ds_write_b128 v236, v[104:107] offset:11264
    v_mfma_f32_16x16x32_bf16 v[192:195], a[12:15], v[8:11], v[192:195]
    ds_read_b128 v[152:155], v241 offset:38208
    v_mul_f32 v24, v242, v24
    v_mfma_f32_16x16x32_bf16 v[200:203], a[16:19], v[8:11], v[200:203]
    ds_read_b128 v[156:159], v241 offset:40256
    v_mul_f32 v25, v242, v25
    v_mfma_f32_16x16x32_bf16 v[208:211], a[20:23], v[8:11], v[208:211]
    buffer_load_dwordx4 v250, s[44:47], s49 offen offset:2048 lds
    v_mul_f32 v26, v242, v26
    v_mul_f32 v27, v242, v27
    v_mul_f32 v28, v242, v28
    v_mul_f32 v29, v242, v29
    v_mul_f32 v30, v242, v30
    v_mul_f32 v31, v242, v31
    v_fma_f32 v24, v244, v160, v24
    v_fma_f32 v25, v244, v161, v25
    v_fma_f32 v26, v244, v162, v26
    v_fma_f32 v27, v244, v163, v27
    v_fma_f32 v28, v244, v164, v28
    v_fma_f32 v29, v244, v165, v29
    v_fma_f32 v30, v244, v166, v30
    v_fma_f32 v31, v244, v167, v31
    v_cvt_pk_bf16_f32 v24, v24, v25
    v_cvt_pk_bf16_f32 v25, v26, v27
    v_cvt_pk_bf16_f32 v26, v28, v29
    v_cvt_pk_bf16_f32 v27, v30, v31
    ds_write_b128 v236, v[24:27] offset:6144
    v_mfma_f32_16x16x32_bf16 v[196:199], a[12:15], v[72:75], v[196:199]
    v_mul_f32 v88, v243, v88
    v_mul_f32 v89, v243, v89
    v_mfma_f32_16x16x32_bf16 v[204:207], a[16:19], v[72:75], v[204:207]
    v_mul_f32 v90, v243, v90
    v_mul_f32 v91, v243, v91
    v_mfma_f32_16x16x32_bf16 v[212:215], a[20:23], v[72:75], v[212:215]
    buffer_load_dwordx4 v251, s[44:47], s49 offen offset:3072 lds
    s_add_u32 s49, s49, 28672
    v_mul_f32 v92, v243, v92
    v_mul_f32 v93, v243, v93
    v_mul_f32 v94, v243, v94
    v_mul_f32 v95, v243, v95
    v_fma_f32 v88, v245, v168, v88
    v_fma_f32 v89, v245, v169, v89
    v_fma_f32 v90, v245, v170, v90
    v_fma_f32 v91, v245, v171, v91
    v_fma_f32 v92, v245, v172, v92
    v_fma_f32 v93, v245, v173, v93
    v_fma_f32 v94, v245, v174, v94
    v_fma_f32 v95, v245, v175, v95
    v_cvt_pk_bf16_f32 v88, v88, v89
    v_cvt_pk_bf16_f32 v89, v90, v91
    v_cvt_pk_bf16_f32 v90, v92, v93
    v_cvt_pk_bf16_f32 v91, v94, v95
    ds_write_b128 v236, v[88:91] offset:7168
    v_mfma_f32_16x16x32_bf16 v[192:195], a[24:27], v[16:19], v[192:195]
    v_mul_f32 v48, v242, v48
    v_mul_f32 v49, v242, v49
    v_mfma_f32_16x16x32_bf16 v[200:203], a[28:31], v[16:19], v[200:203]
    v_mul_f32 v50, v242, v50
    v_mul_f32 v51, v242, v51
    v_mfma_f32_16x16x32_bf16 v[208:211], a[32:35], v[16:19], v[208:211]
    v_mul_f32 v52, v242, v52
    v_mul_f32 v53, v242, v53
    v_mul_f32 v54, v242, v54
    v_mul_f32 v55, v242, v55
    v_fma_f32 v48, v244, v128, v48
    v_fma_f32 v49, v244, v129, v49
    v_fma_f32 v50, v244, v130, v50
    v_fma_f32 v51, v244, v131, v51
    v_fma_f32 v52, v244, v132, v52
    v_fma_f32 v53, v244, v133, v53
    v_fma_f32 v54, v244, v134, v54
    v_fma_f32 v55, v244, v135, v55
    v_cvt_pk_bf16_f32 v48, v48, v49
    v_cvt_pk_bf16_f32 v49, v50, v51
    v_cvt_pk_bf16_f32 v50, v52, v53
    v_cvt_pk_bf16_f32 v51, v54, v55
    ds_write_b128 v236, v[48:51] offset:12288
    v_mfma_f32_16x16x32_bf16 v[196:199], a[24:27], v[80:83], v[196:199]
    s_waitcnt lgkmcnt(13)
    v_mul_f32 v112, v243, v112
    v_mul_f32 v113, v243, v113
    v_mfma_f32_16x16x32_bf16 v[204:207], a[28:31], v[80:83], v[204:207]
    v_mul_f32 v114, v243, v114
    v_mul_f32 v115, v243, v115
    v_mfma_f32_16x16x32_bf16 v[212:215], a[32:35], v[80:83], v[212:215]
    v_mul_f32 v116, v243, v116
    v_mul_f32 v117, v243, v117
    v_mul_f32 v118, v243, v118
    v_mul_f32 v119, v243, v119
    v_fma_f32 v112, v245, v136, v112
    v_fma_f32 v113, v245, v137, v113
    v_fma_f32 v114, v245, v138, v114
    v_fma_f32 v115, v245, v139, v115
    v_fma_f32 v116, v245, v140, v116
    v_fma_f32 v117, v245, v141, v117
    v_fma_f32 v118, v245, v142, v118
    v_fma_f32 v119, v245, v143, v119
    v_cvt_pk_bf16_f32 v112, v112, v113
    v_cvt_pk_bf16_f32 v113, v114, v115
    v_cvt_pk_bf16_f32 v114, v116, v117
    v_cvt_pk_bf16_f32 v115, v118, v119
    ds_write_b128 v236, v[112:115] offset:13312
    v_mfma_f32_16x16x32_bf16 v[192:195], a[36:39], v[24:27], v[192:195]
    s_waitcnt lgkmcnt(9)
    v_mul_f32 v56, v242, v56
    v_mul_f32 v57, v242, v57
    v_mfma_f32_16x16x32_bf16 v[200:203], a[40:43], v[24:27], v[200:203]
    v_mul_f32 v58, v242, v58
    v_mul_f32 v59, v242, v59
    v_mfma_f32_16x16x32_bf16 v[208:211], a[44:47], v[24:27], v[208:211]
    v_mul_f32 v60, v242, v60
    v_mul_f32 v61, v242, v61
    v_mul_f32 v62, v242, v62
    v_mul_f32 v63, v242, v63
    v_fma_f32 v56, v244, v144, v56
    v_fma_f32 v57, v244, v145, v57
    v_fma_f32 v58, v244, v146, v58
    v_fma_f32 v59, v244, v147, v59
    v_fma_f32 v60, v244, v148, v60
    v_fma_f32 v61, v244, v149, v61
    v_fma_f32 v62, v244, v150, v62
    v_fma_f32 v63, v244, v151, v63
    v_cvt_pk_bf16_f32 v56, v56, v57
    v_cvt_pk_bf16_f32 v57, v58, v59
    v_cvt_pk_bf16_f32 v58, v60, v61
    v_cvt_pk_bf16_f32 v59, v62, v63
    ds_write_b128 v236, v[56:59] offset:14336
    v_mfma_f32_16x16x32_bf16 v[196:199], a[36:39], v[88:91], v[196:199]
    s_waitcnt lgkmcnt(5)
    v_mul_f32 v120, v243, v120
    v_mul_f32 v121, v243, v121
    v_mfma_f32_16x16x32_bf16 v[204:207], a[40:43], v[88:91], v[204:207]
    v_mul_f32 v122, v243, v122
    v_mul_f32 v123, v243, v123
    v_mfma_f32_16x16x32_bf16 v[212:215], a[44:47], v[88:91], v[212:215]
    s_add_u32 m0, s51, 33088
    s_nop 0
    buffer_load_dwordx4 v248, s[44:47], s49 offen offset:0 lds
    buffer_load_dwordx4 v249, s[44:47], s49 offen offset:1024 lds
    buffer_load_dwordx4 v250, s[44:47], s49 offen offset:2048 lds
    buffer_load_dwordx4 v251, s[44:47], s49 offen offset:3072 lds
    s_add_u32 s49, s49, 28672
    s_add_u32 m0, s51, 37184
    s_nop 0
    buffer_load_dwordx4 v248, s[44:47], s49 offen offset:0 lds
    buffer_load_dwordx4 v249, s[44:47], s49 offen offset:1024 lds
    buffer_load_dwordx4 v250, s[44:47], s49 offen offset:2048 lds
    buffer_load_dwordx4 v251, s[44:47], s49 offen offset:3072 lds
    s_add_u32 s49, s49, 28672
    v_mul_f32 v124, v243, v124
    v_mul_f32 v125, v243, v125
    v_mul_f32 v126, v243, v126
    v_mul_f32 v127, v243, v127
    v_fma_f32 v120, v245, v152, v120
    v_fma_f32 v121, v245, v153, v121
    v_fma_f32 v122, v245, v154, v122
    v_fma_f32 v123, v245, v155, v123
    v_fma_f32 v124, v245, v156, v124
    v_fma_f32 v125, v245, v157, v125
    v_fma_f32 v126, v245, v158, v126
    v_fma_f32 v127, v245, v159, v127
    v_cvt_pk_bf16_f32 v120, v120, v121
    v_cvt_pk_bf16_f32 v121, v122, v123
    v_cvt_pk_bf16_f32 v122, v124, v125
    v_cvt_pk_bf16_f32 v123, v126, v127
    ds_write_b128 v236, v[120:123] offset:15360
    s_waitcnt lgkmcnt(0)
    s_barrier
    v_mfma_f32_16x16x32_bf16 v[192:195], a[72:75], v[48:51], v[192:195]
    ds_read_b128 v[4:7], v237 offset:0
    ds_read_b128 v[68:71], v237 offset:1024
    ds_read_b128 v[12:15], v237 offset:2048
    ds_read_b128 v[76:79], v237 offset:3072
    ds_read_b128 v[20:23], v237 offset:4096
    ds_read_b128 v[84:87], v237 offset:5120
    ds_read_b128 v[28:31], v237 offset:6144
    ds_read_b128 v[92:95], v237 offset:7168
    v_mfma_f32_16x16x32_bf16 v[200:203], a[76:79], v[48:51], v[200:203]
    ds_read_b128 v[36:39], v237 offset:8192
    v_mfma_f32_16x16x32_bf16 v[208:211], a[80:83], v[48:51], v[208:211]
    ds_read_b128 v[100:103], v237 offset:9216
    v_mfma_f32_16x16x32_bf16 v[196:199], a[72:75], v[112:115], v[196:199]
    ds_read_b128 v[44:47], v237 offset:10240
    v_mfma_f32_16x16x32_bf16 v[204:207], a[76:79], v[112:115], v[204:207]
    ds_read_b128 v[108:111], v237 offset:11264
    v_mfma_f32_16x16x32_bf16 v[212:215], a[80:83], v[112:115], v[212:215]
    v_mfma_f32_16x16x32_bf16 v[192:195], a[84:87], v[56:59], v[192:195]
    ds_read_b128 v[52:55], v237 offset:12288
    v_mfma_f32_16x16x32_bf16 v[200:203], a[88:91], v[56:59], v[200:203]
    ds_read_b128 v[116:119], v237 offset:13312
    v_mfma_f32_16x16x32_bf16 v[208:211], a[92:95], v[56:59], v[208:211]
    ds_read_b128 v[60:63], v237 offset:14336
    v_mfma_f32_16x16x32_bf16 v[196:199], a[84:87], v[120:123], v[196:199]
    s_waitcnt lgkmcnt(9)
    ds_read_b128 v[124:127], v237 offset:15360
    v_mfma_f32_16x16x32_bf16 v[204:207], a[88:91], v[120:123], v[204:207]
    v_mfma_f32_16x16x32_bf16 v[212:215], a[92:95], v[120:123], v[212:215]
    ds_read_b128 a[128:131], v238 offset:0
    v_mfma_f32_16x16x32_bf16 v[128:131], a[0:3], v[4:7], 0
    ds_read_b128 a[160:163], v238 offset:1024
    v_mfma_f32_16x16x32_bf16 v[136:139], a[4:7], v[4:7], 0
    ds_read_b128 a[132:135], v238 offset:2048
    v_mfma_f32_16x16x32_bf16 v[144:147], a[8:11], v[4:7], 0
    ds_read_b128 a[164:167], v238 offset:3072
    v_mfma_f32_16x16x32_bf16 v[132:135], a[0:3], v[68:71], 0
    v_cvt_pk_bf16_f32 v216, v192, v193
    v_cvt_pk_bf16_f32 v217, v194, v195
    v_mfma_f32_16x16x32_bf16 v[140:143], a[4:7], v[68:71], 0
    ds_read_b128 a[136:139], v238 offset:4096
    v_cvt_pk_bf16_f32 v218, v196, v197
    v_mfma_f32_16x16x32_bf16 v[148:151], a[8:11], v[68:71], 0
    s_waitcnt lgkmcnt(9)
    ds_read_b128 a[168:171], v238 offset:5120
    v_cvt_pk_bf16_f32 v219, v198, v199
    v_mfma_f32_16x16x32_bf16 v[128:131], a[12:15], v[12:15], v[128:131]
    buffer_store_dwordx4 v[216:219], v246, s[20:23], s56 offen offset:0 sc1
    ds_read_b128 a[140:143], v238 offset:6144
    v_mfma_f32_16x16x32_bf16 v[136:139], a[16:19], v[12:15], v[136:139]
    ds_read_b128 a[172:175], v238 offset:7168
    v_cvt_pk_bf16_f32 v220, v200, v201
    v_mfma_f32_16x16x32_bf16 v[144:147], a[20:23], v[12:15], v[144:147]
    v_cvt_pk_bf16_f32 v221, v202, v203
    v_cvt_pk_bf16_f32 v222, v204, v205
    v_mfma_f32_16x16x32_bf16 v[132:135], a[12:15], v[76:79], v[132:135]
    ds_read_b128 a[144:147], v238 offset:8192
    v_cvt_pk_bf16_f32 v223, v206, v207
    v_mfma_f32_16x16x32_bf16 v[140:143], a[16:19], v[76:79], v[140:143]
    ds_read_b128 a[176:179], v238 offset:9216
    buffer_store_dwordx4 v[220:223], v246, s[20:23], s56 offen offset:1024 sc1
    v_mfma_f32_16x16x32_bf16 v[148:151], a[20:23], v[76:79], v[148:151]
    ds_read_b128 a[148:151], v238 offset:10240
    v_cvt_pk_bf16_f32 v224, v208, v209
    v_mfma_f32_16x16x32_bf16 v[128:131], a[24:27], v[20:23], v[128:131]
    s_waitcnt lgkmcnt(9)
    ds_read_b128 a[180:183], v238 offset:11264
    v_cvt_pk_bf16_f32 v225, v210, v211
    v_mfma_f32_16x16x32_bf16 v[136:139], a[28:31], v[20:23], v[136:139]
    v_cvt_pk_bf16_f32 v226, v212, v213
    v_cvt_pk_bf16_f32 v227, v214, v215
    v_mfma_f32_16x16x32_bf16 v[144:147], a[32:35], v[20:23], v[144:147]
    ds_read_b128 a[152:155], v238 offset:12288
    buffer_store_dwordx4 v[224:227], v246, s[20:23], s56 offen offset:2048 sc1
    v_mfma_f32_16x16x32_bf16 v[132:135], a[24:27], v[84:87], v[132:135]
    ds_read_b128 a[184:187], v238 offset:13312
    v_mfma_f32_16x16x32_bf16 v[140:143], a[28:31], v[84:87], v[140:143]
    ds_read_b128 a[156:159], v238 offset:14336
    v_mfma_f32_16x16x32_bf16 v[148:151], a[32:35], v[84:87], v[148:151]
    ds_read_b128 a[188:191], v238 offset:15360
    v_mfma_f32_16x16x32_bf16 v[128:131], a[36:39], v[28:31], v[128:131]
    v_mfma_f32_16x16x32_bf16 v[136:139], a[40:43], v[28:31], v[136:139]
    ds_read_b128 a[192:195], v239 offset:0
    v_mfma_f32_16x16x32_bf16 v[144:147], a[44:47], v[28:31], v[144:147]
    s_waitcnt lgkmcnt(9)
    ds_read_b128 a[224:227], v239 offset:1024
    v_mfma_f32_16x16x32_bf16 v[132:135], a[36:39], v[92:95], v[132:135]
    ds_read_b128 a[196:199], v239 offset:2048
    v_mfma_f32_16x16x32_bf16 v[140:143], a[40:43], v[92:95], v[140:143]
    ds_read_b128 a[228:231], v239 offset:3072
    v_mfma_f32_16x16x32_bf16 v[148:151], a[44:47], v[92:95], v[148:151]
    v_mfma_f32_16x16x32_bf16 v[128:131], a[48:51], v[36:39], v[128:131]
    ds_read_b128 a[200:203], v239 offset:4096
    v_mfma_f32_16x16x32_bf16 v[136:139], a[52:55], v[36:39], v[136:139]
    ds_read_b128 a[232:235], v239 offset:5120
    v_mfma_f32_16x16x32_bf16 v[144:147], a[56:59], v[36:39], v[144:147]
    ds_read_b128 a[204:207], v239 offset:6144
    v_mfma_f32_16x16x32_bf16 v[132:135], a[48:51], v[100:103], v[132:135]
    s_waitcnt lgkmcnt(9)
    ds_read_b128 a[236:239], v239 offset:7168
    v_mfma_f32_16x16x32_bf16 v[140:143], a[52:55], v[100:103], v[140:143]
    v_mfma_f32_16x16x32_bf16 v[148:151], a[56:59], v[100:103], v[148:151]
    ds_read_b128 a[208:211], v239 offset:8192
    v_mfma_f32_16x16x32_bf16 v[128:131], a[60:63], v[44:47], v[128:131]
    ds_read_b128 a[240:243], v239 offset:9216
    v_mfma_f32_16x16x32_bf16 v[136:139], a[64:67], v[44:47], v[136:139]
    ds_read_b128 a[212:215], v239 offset:10240
    v_mfma_f32_16x16x32_bf16 v[144:147], a[68:71], v[44:47], v[144:147]
    ds_read_b128 a[244:247], v239 offset:11264
    v_mfma_f32_16x16x32_bf16 v[132:135], a[60:63], v[108:111], v[132:135]
    v_mfma_f32_16x16x32_bf16 v[140:143], a[64:67], v[108:111], v[140:143]
    ds_read_b128 a[216:219], v239 offset:12288
    v_mfma_f32_16x16x32_bf16 v[148:151], a[68:71], v[108:111], v[148:151]
    s_waitcnt lgkmcnt(9)
    ds_read_b128 a[248:251], v239 offset:13312
    v_mfma_f32_16x16x32_bf16 v[128:131], a[72:75], v[52:55], v[128:131]
    ds_read_b128 a[220:223], v239 offset:14336
    v_mfma_f32_16x16x32_bf16 v[136:139], a[76:79], v[52:55], v[136:139]
    ds_read_b128 a[252:255], v239 offset:15360
    v_mfma_f32_16x16x32_bf16 v[144:147], a[80:83], v[52:55], v[144:147]
    v_mfma_f32_16x16x32_bf16 v[132:135], a[72:75], v[116:119], v[132:135]
    v_mfma_f32_16x16x32_bf16 v[140:143], a[76:79], v[116:119], v[140:143]
    v_mfma_f32_16x16x32_bf16 v[148:151], a[80:83], v[116:119], v[148:151]
    v_mfma_f32_16x16x32_bf16 v[128:131], a[84:87], v[60:63], v[128:131]
    v_mfma_f32_16x16x32_bf16 v[136:139], a[88:91], v[60:63], v[136:139]
    s_waitcnt lgkmcnt(0)
    s_barrier
    v_mfma_f32_16x16x32_bf16 v[144:147], a[92:95], v[60:63], v[144:147]
    s_add_u32 m0, s52, 0
    s_nop 0
    buffer_load_dwordx4 v248, s[44:47], s49 offen offset:0 lds
    v_mfma_f32_16x16x32_bf16 v[132:135], a[84:87], v[124:127], v[132:135]
    v_mfma_f32_16x16x32_bf16 v[140:143], a[88:91], v[124:127], v[140:143]
    buffer_load_dwordx4 v249, s[44:47], s49 offen offset:1024 lds
    v_mfma_f32_16x16x32_bf16 v[148:151], a[92:95], v[124:127], v[148:151]
    v_mfma_f32_16x16x32_bf16 v[152:155], a[0:3], a[128:131], 0
    buffer_load_dwordx4 v250, s[44:47], s49 offen offset:2048 lds
    v_mfma_f32_16x16x32_bf16 v[160:163], a[4:7], a[128:131], 0
    v_mfma_f32_16x16x32_bf16 v[168:171], a[8:11], a[128:131], 0
    buffer_load_dwordx4 v251, s[44:47], s49 offen offset:3072 lds
    s_add_u32 s49, s49, 28672
    v_mfma_f32_16x16x32_bf16 v[156:159], a[0:3], a[160:163], 0
    v_cvt_pk_bf16_f32 v228, v128, v129
    v_cvt_pk_bf16_f32 v229, v130, v131
    v_mfma_f32_16x16x32_bf16 v[164:167], a[4:7], a[160:163], 0
    s_add_u32 m0, s52, 4096
    s_nop 0
    buffer_load_dwordx4 v248, s[44:47], s49 offen offset:0 lds
    v_mfma_f32_16x16x32_bf16 v[172:175], a[8:11], a[160:163], 0
    v_cvt_pk_bf16_f32 v230, v132, v133
    v_cvt_pk_bf16_f32 v231, v134, v135
    v_mfma_f32_16x16x32_bf16 v[152:155], a[12:15], a[132:135], v[152:155]
    buffer_store_dwordx4 v[228:231], v246, s[20:23], s57 offen offset:0 sc1
    buffer_load_dwordx4 v249, s[44:47], s49 offen offset:1024 lds
    v_mfma_f32_16x16x32_bf16 v[160:163], a[16:19], a[132:135], v[160:163]
    v_cvt_pk_bf16_f32 v216, v136, v137
    v_cvt_pk_bf16_f32 v217, v138, v139
    v_mfma_f32_16x16x32_bf16 v[168:171], a[20:23], a[132:135], v[168:171]
    buffer_load_dwordx4 v250, s[44:47], s49 offen offset:2048 lds
    v_cvt_pk_bf16_f32 v218, v140, v141
    v_mfma_f32_16x16x32_bf16 v[156:159], a[12:15], a[164:167], v[156:159]
    v_cvt_pk_bf16_f32 v219, v142, v143
    v_mfma_f32_16x16x32_bf16 v[164:167], a[16:19], a[164:167], v[164:167]
    buffer_store_dwordx4 v[216:219], v246, s[20:23], s57 offen offset:1024 sc1
    buffer_load_dwordx4 v251, s[44:47], s49 offen offset:3072 lds
    v_mfma_f32_16x16x32_bf16 v[172:175], a[20:23], a[164:167], v[172:175]
    s_add_u32 s49, s49, 28672
    v_cvt_pk_bf16_f32 v220, v144, v145
    v_cvt_pk_bf16_f32 v221, v146, v147
    v_mfma_f32_16x16x32_bf16 v[152:155], a[24:27], a[136:139], v[152:155]
    s_add_u32 m0, s52, 8192
    s_nop 0
    buffer_load_dwordx4 v248, s[44:47], s49 offen offset:0 lds
    v_mfma_f32_16x16x32_bf16 v[160:163], a[28:31], a[136:139], v[160:163]
    v_cvt_pk_bf16_f32 v222, v148, v149
    v_cvt_pk_bf16_f32 v223, v150, v151
    v_mfma_f32_16x16x32_bf16 v[168:171], a[32:35], a[136:139], v[168:171]
    buffer_store_dwordx4 v[220:223], v246, s[20:23], s57 offen offset:2048 sc1
    buffer_load_dwordx4 v249, s[44:47], s49 offen offset:1024 lds
    v_mfma_f32_16x16x32_bf16 v[156:159], a[24:27], a[168:171], v[156:159]
    v_mfma_f32_16x16x32_bf16 v[164:167], a[28:31], a[168:171], v[164:167]
    buffer_load_dwordx4 v250, s[44:47], s49 offen offset:2048 lds
    v_mfma_f32_16x16x32_bf16 v[172:175], a[32:35], a[168:171], v[172:175]
    v_mfma_f32_16x16x32_bf16 v[152:155], a[36:39], a[140:143], v[152:155]
    buffer_load_dwordx4 v251, s[44:47], s49 offen offset:3072 lds
    s_add_u32 s49, s49, 28672
    v_mfma_f32_16x16x32_bf16 v[160:163], a[40:43], a[140:143], v[160:163]
    v_mfma_f32_16x16x32_bf16 v[168:171], a[44:47], a[140:143], v[168:171]
    s_add_u32 m0, s52, 12288
    s_nop 0
    buffer_load_dwordx4 v248, s[44:47], s49 offen offset:0 lds
    v_mfma_f32_16x16x32_bf16 v[156:159], a[36:39], a[172:175], v[156:159]
    v_mfma_f32_16x16x32_bf16 v[164:167], a[40:43], a[172:175], v[164:167]
    buffer_load_dwordx4 v249, s[44:47], s49 offen offset:1024 lds
    v_mfma_f32_16x16x32_bf16 v[172:175], a[44:47], a[172:175], v[172:175]
    v_mfma_f32_16x16x32_bf16 v[152:155], a[48:51], a[144:147], v[152:155]
    buffer_load_dwordx4 v250, s[44:47], s49 offen offset:2048 lds
    v_mfma_f32_16x16x32_bf16 v[160:163], a[52:55], a[144:147], v[160:163]
    v_mfma_f32_16x16x32_bf16 v[168:171], a[56:59], a[144:147], v[168:171]
    buffer_load_dwordx4 v251, s[44:47], s49 offen offset:3072 lds
    s_add_u32 s49, s49, 28672
    v_mfma_f32_16x16x32_bf16 v[156:159], a[48:51], a[176:179], v[156:159]
    v_mfma_f32_16x16x32_bf16 v[164:167], a[52:55], a[176:179], v[164:167]
    v_mfma_f32_16x16x32_bf16 v[172:175], a[56:59], a[176:179], v[172:175]
    v_mfma_f32_16x16x32_bf16 v[152:155], a[60:63], a[148:151], v[152:155]
    v_mfma_f32_16x16x32_bf16 v[160:163], a[64:67], a[148:151], v[160:163]
    v_mfma_f32_16x16x32_bf16 v[168:171], a[68:71], a[148:151], v[168:171]
    v_mfma_f32_16x16x32_bf16 v[156:159], a[60:63], a[180:183], v[156:159]
    v_mfma_f32_16x16x32_bf16 v[164:167], a[64:67], a[180:183], v[164:167]
    v_mfma_f32_16x16x32_bf16 v[172:175], a[68:71], a[180:183], v[172:175]
    v_mfma_f32_16x16x32_bf16 v[152:155], a[72:75], a[152:155], v[152:155]
    v_mfma_f32_16x16x32_bf16 v[160:163], a[76:79], a[152:155], v[160:163]
    v_mfma_f32_16x16x32_bf16 v[168:171], a[80:83], a[152:155], v[168:171]
    v_mfma_f32_16x16x32_bf16 v[156:159], a[72:75], a[184:187], v[156:159]
    v_mfma_f32_16x16x32_bf16 v[164:167], a[76:79], a[184:187], v[164:167]
    v_mfma_f32_16x16x32_bf16 v[172:175], a[80:83], a[184:187], v[172:175]
    v_mfma_f32_16x16x32_bf16 v[152:155], a[84:87], a[156:159], v[152:155]
    v_mfma_f32_16x16x32_bf16 v[160:163], a[88:91], a[156:159], v[160:163]
    v_mfma_f32_16x16x32_bf16 v[168:171], a[92:95], a[156:159], v[168:171]
    v_mfma_f32_16x16x32_bf16 v[156:159], a[84:87], a[188:191], v[156:159]
    v_mfma_f32_16x16x32_bf16 v[164:167], a[88:91], a[188:191], v[164:167]
    v_mfma_f32_16x16x32_bf16 v[172:175], a[92:95], a[188:191], v[172:175]
    v_mfma_f32_16x16x32_bf16 v[176:179], a[0:3], a[192:195], 0
    v_mfma_f32_16x16x32_bf16 v[184:187], a[4:7], a[192:195], 0
    v_mfma_f32_16x16x32_bf16 v[192:195], a[8:11], a[192:195], 0
    v_mfma_f32_16x16x32_bf16 v[180:183], a[0:3], a[224:227], 0
    v_cvt_pk_bf16_f32 v224, v152, v153
    v_cvt_pk_bf16_f32 v225, v154, v155
    v_mfma_f32_16x16x32_bf16 v[188:191], a[4:7], a[224:227], 0
    v_cvt_pk_bf16_f32 v226, v156, v157
    v_cvt_pk_bf16_f32 v227, v158, v159
    v_mfma_f32_16x16x32_bf16 v[196:199], a[8:11], a[224:227], 0
    buffer_store_dwordx4 v[224:227], v246, s[20:23], s58 offen offset:0 sc1
    v_cvt_pk_bf16_f32 v228, v160, v161
    v_mfma_f32_16x16x32_bf16 v[176:179], a[12:15], a[196:199], v[176:179]
    v_cvt_pk_bf16_f32 v229, v162, v163
    v_cvt_pk_bf16_f32 v230, v164, v165
    v_mfma_f32_16x16x32_bf16 v[184:187], a[16:19], a[196:199], v[184:187]
    v_cvt_pk_bf16_f32 v231, v166, v167
    v_mfma_f32_16x16x32_bf16 v[192:195], a[20:23], a[196:199], v[192:195]
    buffer_store_dwordx4 v[228:231], v246, s[20:23], s58 offen offset:1024 sc1
    v_cvt_pk_bf16_f32 v216, v168, v169
    v_mfma_f32_16x16x32_bf16 v[180:183], a[12:15], a[228:231], v[180:183]
    v_cvt_pk_bf16_f32 v217, v170, v171
    v_cvt_pk_bf16_f32 v218, v172, v173
    v_mfma_f32_16x16x32_bf16 v[188:191], a[16:19], a[228:231], v[188:191]
    v_cvt_pk_bf16_f32 v219, v174, v175
    v_mfma_f32_16x16x32_bf16 v[196:199], a[20:23], a[228:231], v[196:199]
    buffer_store_dwordx4 v[216:219], v246, s[20:23], s58 offen offset:2048 sc1
    v_mfma_f32_16x16x32_bf16 v[176:179], a[24:27], a[200:203], v[176:179]
    v_mfma_f32_16x16x32_bf16 v[184:187], a[28:31], a[200:203], v[184:187]
    v_mfma_f32_16x16x32_bf16 v[192:195], a[32:35], a[200:203], v[192:195]
    v_mfma_f32_16x16x32_bf16 v[180:183], a[24:27], a[232:235], v[180:183]
    v_mfma_f32_16x16x32_bf16 v[188:191], a[28:31], a[232:235], v[188:191]
    v_mfma_f32_16x16x32_bf16 v[196:199], a[32:35], a[232:235], v[196:199]
    v_mfma_f32_16x16x32_bf16 v[176:179], a[36:39], a[204:207], v[176:179]
    v_mfma_f32_16x16x32_bf16 v[184:187], a[40:43], a[204:207], v[184:187]
    v_mfma_f32_16x16x32_bf16 v[192:195], a[44:47], a[204:207], v[192:195]
    v_mfma_f32_16x16x32_bf16 v[180:183], a[36:39], a[236:239], v[180:183]
    v_mfma_f32_16x16x32_bf16 v[188:191], a[40:43], a[236:239], v[188:191]
    v_mfma_f32_16x16x32_bf16 v[196:199], a[44:47], a[236:239], v[196:199]
    s_waitcnt vmcnt(25)
    ds_read_b64_tr_b16 a[96:97], v252 offset:0
    v_mfma_f32_16x16x32_bf16 v[176:179], a[48:51], a[208:211], v[176:179]
    ds_read_b64_tr_b16 a[98:99], v252 offset:2048
    v_mfma_f32_16x16x32_bf16 v[184:187], a[52:55], a[208:211], v[184:187]
    v_mfma_f32_16x16x32_bf16 v[192:195], a[56:59], a[208:211], v[192:195]
    v_mfma_f32_16x16x32_bf16 v[180:183], a[48:51], a[240:243], v[180:183]
    v_mfma_f32_16x16x32_bf16 v[188:191], a[52:55], a[240:243], v[188:191]
    v_mfma_f32_16x16x32_bf16 v[196:199], a[56:59], a[240:243], v[196:199]
    v_mfma_f32_16x16x32_bf16 v[176:179], a[60:63], a[212:215], v[176:179]
    v_mfma_f32_16x16x32_bf16 v[184:187], a[64:67], a[212:215], v[184:187]
    ds_read_b64_tr_b16 a[100:101], v252 offset:4096
    v_mfma_f32_16x16x32_bf16 v[192:195], a[68:71], a[212:215], v[192:195]
    ds_read_b64_tr_b16 a[102:103], v252 offset:6144
    v_mfma_f32_16x16x32_bf16 v[180:183], a[60:63], a[244:247], v[180:183]
    v_mfma_f32_16x16x32_bf16 v[188:191], a[64:67], a[244:247], v[188:191]
    v_mfma_f32_16x16x32_bf16 v[196:199], a[68:71], a[244:247], v[196:199]
    v_mfma_f32_16x16x32_bf16 v[176:179], a[72:75], a[216:219], v[176:179]
    v_mfma_f32_16x16x32_bf16 v[184:187], a[76:79], a[216:219], v[184:187]
    v_mfma_f32_16x16x32_bf16 v[192:195], a[80:83], a[216:219], v[192:195]
    v_mfma_f32_16x16x32_bf16 v[180:183], a[72:75], a[248:251], v[180:183]
    ds_read_b64_tr_b16 a[104:105], v252 offset:33088
    v_mfma_f32_16x16x32_bf16 v[188:191], a[76:79], a[248:251], v[188:191]
    ds_read_b64_tr_b16 a[106:107], v252 offset:35136
    v_mfma_f32_16x16x32_bf16 v[196:199], a[80:83], a[248:251], v[196:199]
    v_mfma_f32_16x16x32_bf16 v[176:179], a[84:87], a[220:223], v[176:179]
    v_mfma_f32_16x16x32_bf16 v[184:187], a[88:91], a[220:223], v[184:187]
    v_mfma_f32_16x16x32_bf16 v[192:195], a[92:95], a[220:223], v[192:195]
    v_mfma_f32_16x16x32_bf16 v[180:183], a[84:87], a[252:255], v[180:183]
    v_mfma_f32_16x16x32_bf16 v[188:191], a[88:91], a[252:255], v[188:191]
    v_mfma_f32_16x16x32_bf16 v[196:199], a[92:95], a[252:255], v[196:199]
    s_waitcnt lgkmcnt(4)
    ds_read_b64_tr_b16 a[108:109], v252 offset:37184
    v_mfma_f32_16x16x32_bf16 v[128:131], a[96:99], v[0:3], 0
    ds_read_b64_tr_b16 a[110:111], v252 offset:39232
    v_mfma_f32_16x16x32_bf16 v[132:135], a[96:99], v[64:67], 0
    v_xor_b32 v252, 32, v252
    v_mfma_f32_16x16x32_bf16 v[136:139], a[96:99], v[4:7], 0
    v_mfma_f32_16x16x32_bf16 v[140:143], a[96:99], v[68:71], 0
    v_cvt_pk_bf16_f32 v220, v176, v177
    v_cvt_pk_bf16_f32 v221, v178, v179
    v_mfma_f32_16x16x32_bf16 v[144:147], a[96:99], a[128:131], 0
    v_cvt_pk_bf16_f32 v222, v180, v181
    v_cvt_pk_bf16_f32 v223, v182, v183
    v_mfma_f32_16x16x32_bf16 v[148:151], a[96:99], a[160:163], 0
    buffer_store_dwordx4 v[220:223], v246, s[20:23], s59 offen offset:0 sc1
    v_cvt_pk_bf16_f32 v224, v184, v185
    v_mfma_f32_16x16x32_bf16 v[152:155], a[96:99], a[192:195], 0
    v_cvt_pk_bf16_f32 v225, v186, v187
    v_cvt_pk_bf16_f32 v226, v188, v189
    v_mfma_f32_16x16x32_bf16 v[156:159], a[96:99], a[224:227], 0
    s_waitcnt lgkmcnt(4)
    s_waitcnt vmcnt(4)
    ds_read_b64_tr_b16 a[112:113], v253 offset:0
    v_mfma_f32_16x16x32_bf16 v[128:131], a[100:103], v[8:11], v[128:131]
    ds_read_b64_tr_b16 a[114:115], v253 offset:2048
    v_cvt_pk_bf16_f32 v227, v190, v191
    v_mfma_f32_16x16x32_bf16 v[132:135], a[100:103], v[72:75], v[132:135]
    buffer_store_dwordx4 v[224:227], v246, s[20:23], s59 offen offset:1024 sc1
    v_cvt_pk_bf16_f32 v228, v192, v193
    v_mfma_f32_16x16x32_bf16 v[136:139], a[100:103], v[12:15], v[136:139]
    v_cvt_pk_bf16_f32 v229, v194, v195
    v_cvt_pk_bf16_f32 v230, v196, v197
    v_mfma_f32_16x16x32_bf16 v[140:143], a[100:103], v[76:79], v[140:143]
    v_cvt_pk_bf16_f32 v231, v198, v199
    v_mfma_f32_16x16x32_bf16 v[144:147], a[100:103], a[132:135], v[144:147]
    buffer_store_dwordx4 v[228:231], v246, s[20:23], s59 offen offset:2048 sc1
    v_mfma_f32_16x16x32_bf16 v[148:151], a[100:103], a[164:167], v[148:151]
    v_mfma_f32_16x16x32_bf16 v[152:155], a[100:103], a[196:199], v[152:155]
    v_mfma_f32_16x16x32_bf16 v[156:159], a[100:103], a[228:231], v[156:159]
    s_waitcnt lgkmcnt(4)
    ds_read_b64_tr_b16 a[116:117], v253 offset:4096
    v_mfma_f32_16x16x32_bf16 v[128:131], a[104:107], v[16:19], v[128:131]
    ds_read_b64_tr_b16 a[118:119], v253 offset:6144
    v_mfma_f32_16x16x32_bf16 v[132:135], a[104:107], v[80:83], v[132:135]
    v_mfma_f32_16x16x32_bf16 v[136:139], a[104:107], v[20:23], v[136:139]
    v_mfma_f32_16x16x32_bf16 v[140:143], a[104:107], v[84:87], v[140:143]
    v_mfma_f32_16x16x32_bf16 v[144:147], a[104:107], a[136:139], v[144:147]
    v_mfma_f32_16x16x32_bf16 v[148:151], a[104:107], a[168:171], v[148:151]
    v_mfma_f32_16x16x32_bf16 v[152:155], a[104:107], a[200:203], v[152:155]
    v_mfma_f32_16x16x32_bf16 v[156:159], a[104:107], a[232:235], v[156:159]
    s_waitcnt lgkmcnt(4)
    ds_read_b64_tr_b16 a[120:121], v253 offset:8192
    v_mfma_f32_16x16x32_bf16 v[128:131], a[108:111], v[24:27], v[128:131]
    ds_read_b64_tr_b16 a[122:123], v253 offset:10240
    v_mfma_f32_16x16x32_bf16 v[132:135], a[108:111], v[88:91], v[132:135]
    v_mfma_f32_16x16x32_bf16 v[136:139], a[108:111], v[28:31], v[136:139]
    v_mfma_f32_16x16x32_bf16 v[140:143], a[108:111], v[92:95], v[140:143]
    v_mfma_f32_16x16x32_bf16 v[144:147], a[108:111], a[140:143], v[144:147]
    v_mfma_f32_16x16x32_bf16 v[148:151], a[108:111], a[172:175], v[148:151]
    v_mfma_f32_16x16x32_bf16 v[152:155], a[108:111], a[204:207], v[152:155]
    v_mfma_f32_16x16x32_bf16 v[156:159], a[108:111], a[236:239], v[156:159]
    s_waitcnt lgkmcnt(4)
    ds_read_b64_tr_b16 a[124:125], v253 offset:12288
    v_mfma_f32_16x16x32_bf16 v[128:131], a[112:115], v[32:35], v[128:131]
    ds_read_b64_tr_b16 a[126:127], v253 offset:14336
    v_mfma_f32_16x16x32_bf16 v[132:135], a[112:115], v[96:99], v[132:135]
    v_xor_b32 v253, 32, v253
    v_mfma_f32_16x16x32_bf16 v[136:139], a[112:115], v[36:39], v[136:139]
    v_mfma_f32_16x16x32_bf16 v[140:143], a[112:115], v[100:103], v[140:143]
    v_mfma_f32_16x16x32_bf16 v[144:147], a[112:115], a[144:147], v[144:147]
    v_mfma_f32_16x16x32_bf16 v[148:151], a[112:115], a[176:179], v[148:151]
    v_mfma_f32_16x16x32_bf16 v[152:155], a[112:115], a[208:211], v[152:155]
    v_mfma_f32_16x16x32_bf16 v[156:159], a[112:115], a[240:243], v[156:159]
    s_waitcnt lgkmcnt(4)
    ds_read_b64_tr_b16 a[96:97], v252 offset:0
    v_mfma_f32_16x16x32_bf16 v[128:131], a[116:119], v[40:43], v[128:131]
    ds_read_b64_tr_b16 a[98:99], v252 offset:2048
    v_mfma_f32_16x16x32_bf16 v[132:135], a[116:119], v[104:107], v[132:135]
    v_mfma_f32_16x16x32_bf16 v[136:139], a[116:119], v[44:47], v[136:139]
    v_mfma_f32_16x16x32_bf16 v[140:143], a[116:119], v[108:111], v[140:143]
    v_mfma_f32_16x16x32_bf16 v[144:147], a[116:119], a[148:151], v[144:147]
    v_mfma_f32_16x16x32_bf16 v[148:151], a[116:119], a[180:183], v[148:151]
    v_mfma_f32_16x16x32_bf16 v[152:155], a[116:119], a[212:215], v[152:155]
    v_mfma_f32_16x16x32_bf16 v[156:159], a[116:119], a[244:247], v[156:159]
    s_waitcnt lgkmcnt(4)
    ds_read_b64_tr_b16 a[100:101], v252 offset:4096
    v_mfma_f32_16x16x32_bf16 v[128:131], a[120:123], v[48:51], v[128:131]
    ds_read_b64_tr_b16 a[102:103], v252 offset:6144
    v_mfma_f32_16x16x32_bf16 v[132:135], a[120:123], v[112:115], v[132:135]
    v_mfma_f32_16x16x32_bf16 v[136:139], a[120:123], v[52:55], v[136:139]
    v_mfma_f32_16x16x32_bf16 v[140:143], a[120:123], v[116:119], v[140:143]
    v_mfma_f32_16x16x32_bf16 v[144:147], a[120:123], a[152:155], v[144:147]
    v_mfma_f32_16x16x32_bf16 v[148:151], a[120:123], a[184:187], v[148:151]
    v_mfma_f32_16x16x32_bf16 v[152:155], a[120:123], a[216:219], v[152:155]
    v_mfma_f32_16x16x32_bf16 v[156:159], a[120:123], a[248:251], v[156:159]
    s_waitcnt lgkmcnt(4)
    ds_read_b64_tr_b16 a[104:105], v252 offset:33088
    v_mfma_f32_16x16x32_bf16 v[128:131], a[124:127], v[56:59], v[128:131]
    ds_read_b64_tr_b16 a[106:107], v252 offset:35136
    v_mfma_f32_16x16x32_bf16 v[132:135], a[124:127], v[120:123], v[132:135]
    v_mfma_f32_16x16x32_bf16 v[136:139], a[124:127], v[60:63], v[136:139]
    v_mfma_f32_16x16x32_bf16 v[140:143], a[124:127], v[124:127], v[140:143]
    v_mfma_f32_16x16x32_bf16 v[144:147], a[124:127], a[156:159], v[144:147]
    v_mfma_f32_16x16x32_bf16 v[148:151], a[124:127], a[188:191], v[148:151]
    v_mfma_f32_16x16x32_bf16 v[152:155], a[124:127], a[220:223], v[152:155]
    v_mfma_f32_16x16x32_bf16 v[156:159], a[124:127], a[252:255], v[156:159]
    s_waitcnt lgkmcnt(4)
    ds_read_b64_tr_b16 a[108:109], v252 offset:37184
    v_mfma_f32_16x16x32_bf16 v[160:163], a[96:99], v[0:3], 0
    ds_read_b64_tr_b16 a[110:111], v252 offset:39232
    v_mfma_f32_16x16x32_bf16 v[164:167], a[96:99], v[64:67], 0
    v_xor_b32 v252, 96, v252
    v_mfma_f32_16x16x32_bf16 v[168:171], a[96:99], v[4:7], 0
    v_mfma_f32_16x16x32_bf16 v[172:175], a[96:99], v[68:71], 0
    v_cvt_pk_bf16_f32 v216, v128, v129
    v_cvt_pk_bf16_f32 v217, v130, v131
    v_mfma_f32_16x16x32_bf16 v[176:179], a[96:99], a[128:131], 0
    v_cvt_pk_bf16_f32 v218, v132, v133
    v_cvt_pk_bf16_f32 v219, v134, v135
    v_mfma_f32_16x16x32_bf16 v[180:183], a[96:99], a[160:163], 0
    buffer_store_dwordx4 v[216:219], v246, s[20:23], s60 offen offset:0 sc1
    v_cvt_pk_bf16_f32 v220, v136, v137
    v_mfma_f32_16x16x32_bf16 v[184:187], a[96:99], a[192:195], 0
    v_cvt_pk_bf16_f32 v221, v138, v139
    v_cvt_pk_bf16_f32 v222, v140, v141
    v_mfma_f32_16x16x32_bf16 v[188:191], a[96:99], a[224:227], 0
    s_waitcnt lgkmcnt(4)
    ds_read_b64_tr_b16 a[112:113], v253 offset:0
    v_cvt_pk_bf16_f32 v223, v142, v143
    v_mfma_f32_16x16x32_bf16 v[160:163], a[100:103], v[8:11], v[160:163]
    buffer_store_dwordx4 v[220:223], v246, s[20:23], s61 offen offset:0 sc1
    ds_read_b64_tr_b16 a[114:115], v253 offset:2048
    v_mfma_f32_16x16x32_bf16 v[164:167], a[100:103], v[72:75], v[164:167]
    v_cvt_pk_bf16_f32 v224, v144, v145
    v_cvt_pk_bf16_f32 v225, v146, v147
    v_mfma_f32_16x16x32_bf16 v[168:171], a[100:103], v[12:15], v[168:171]
    v_cvt_pk_bf16_f32 v226, v148, v149
    v_cvt_pk_bf16_f32 v227, v150, v151
    v_mfma_f32_16x16x32_bf16 v[172:175], a[100:103], v[76:79], v[172:175]
    buffer_store_dwordx4 v[224:227], v246, s[20:23], s62 offen offset:0 sc1
    v_cvt_pk_bf16_f32 v228, v152, v153
    v_mfma_f32_16x16x32_bf16 v[176:179], a[100:103], a[132:135], v[176:179]
    v_cvt_pk_bf16_f32 v229, v154, v155
    v_cvt_pk_bf16_f32 v230, v156, v157
    v_mfma_f32_16x16x32_bf16 v[180:183], a[100:103], a[164:167], v[180:183]
    v_cvt_pk_bf16_f32 v231, v158, v159
    v_mfma_f32_16x16x32_bf16 v[184:187], a[100:103], a[196:199], v[184:187]
    buffer_store_dwordx4 v[228:231], v246, s[20:23], s63 offen offset:0 sc1
    v_mfma_f32_16x16x32_bf16 v[188:191], a[100:103], a[228:231], v[188:191]
    s_waitcnt lgkmcnt(4)
    ds_read_b64_tr_b16 a[116:117], v253 offset:4096
    v_mfma_f32_16x16x32_bf16 v[160:163], a[104:107], v[16:19], v[160:163]
    ds_read_b64_tr_b16 a[118:119], v253 offset:6144
    v_mfma_f32_16x16x32_bf16 v[164:167], a[104:107], v[80:83], v[164:167]
    v_mfma_f32_16x16x32_bf16 v[168:171], a[104:107], v[20:23], v[168:171]
    v_mfma_f32_16x16x32_bf16 v[172:175], a[104:107], v[84:87], v[172:175]
    v_mfma_f32_16x16x32_bf16 v[176:179], a[104:107], a[136:139], v[176:179]
    v_mfma_f32_16x16x32_bf16 v[180:183], a[104:107], a[168:171], v[180:183]
    v_mfma_f32_16x16x32_bf16 v[184:187], a[104:107], a[200:203], v[184:187]
    v_mfma_f32_16x16x32_bf16 v[188:191], a[104:107], a[232:235], v[188:191]
    s_waitcnt lgkmcnt(4)
    ds_read_b64_tr_b16 a[120:121], v253 offset:8192
    v_mfma_f32_16x16x32_bf16 v[160:163], a[108:111], v[24:27], v[160:163]
    ds_read_b64_tr_b16 a[122:123], v253 offset:10240
    v_mfma_f32_16x16x32_bf16 v[164:167], a[108:111], v[88:91], v[164:167]
    v_mfma_f32_16x16x32_bf16 v[168:171], a[108:111], v[28:31], v[168:171]
    v_mfma_f32_16x16x32_bf16 v[172:175], a[108:111], v[92:95], v[172:175]
    v_mfma_f32_16x16x32_bf16 v[176:179], a[108:111], a[140:143], v[176:179]
    v_mfma_f32_16x16x32_bf16 v[180:183], a[108:111], a[172:175], v[180:183]
    v_mfma_f32_16x16x32_bf16 v[184:187], a[108:111], a[204:207], v[184:187]
    v_mfma_f32_16x16x32_bf16 v[188:191], a[108:111], a[236:239], v[188:191]
    s_waitcnt lgkmcnt(4)
    ds_read_b64_tr_b16 a[124:125], v253 offset:12288
    v_mfma_f32_16x16x32_bf16 v[160:163], a[112:115], v[32:35], v[160:163]
    ds_read_b64_tr_b16 a[126:127], v253 offset:14336
    v_mfma_f32_16x16x32_bf16 v[164:167], a[112:115], v[96:99], v[164:167]
    v_xor_b32 v253, 96, v253
    v_mfma_f32_16x16x32_bf16 v[168:171], a[112:115], v[36:39], v[168:171]
    v_mfma_f32_16x16x32_bf16 v[172:175], a[112:115], v[100:103], v[172:175]
    v_mfma_f32_16x16x32_bf16 v[176:179], a[112:115], a[144:147], v[176:179]
    v_mfma_f32_16x16x32_bf16 v[180:183], a[112:115], a[176:179], v[180:183]
    v_mfma_f32_16x16x32_bf16 v[184:187], a[112:115], a[208:211], v[184:187]
    v_mfma_f32_16x16x32_bf16 v[188:191], a[112:115], a[240:243], v[188:191]
    s_waitcnt lgkmcnt(4)
    ds_read_b64_tr_b16 a[96:97], v252 offset:0
    v_mfma_f32_16x16x32_bf16 v[160:163], a[116:119], v[40:43], v[160:163]
    ds_read_b64_tr_b16 a[98:99], v252 offset:2048
    v_mfma_f32_16x16x32_bf16 v[164:167], a[116:119], v[104:107], v[164:167]
    v_mfma_f32_16x16x32_bf16 v[168:171], a[116:119], v[44:47], v[168:171]
    v_mfma_f32_16x16x32_bf16 v[172:175], a[116:119], v[108:111], v[172:175]
    v_mfma_f32_16x16x32_bf16 v[176:179], a[116:119], a[148:151], v[176:179]
    v_mfma_f32_16x16x32_bf16 v[180:183], a[116:119], a[180:183], v[180:183]
    v_mfma_f32_16x16x32_bf16 v[184:187], a[116:119], a[212:215], v[184:187]
    v_mfma_f32_16x16x32_bf16 v[188:191], a[116:119], a[244:247], v[188:191]
    s_waitcnt lgkmcnt(4)
    ds_read_b64_tr_b16 a[100:101], v252 offset:4096
    v_mfma_f32_16x16x32_bf16 v[160:163], a[120:123], v[48:51], v[160:163]
    ds_read_b64_tr_b16 a[102:103], v252 offset:6144
    v_mfma_f32_16x16x32_bf16 v[164:167], a[120:123], v[112:115], v[164:167]
    v_mfma_f32_16x16x32_bf16 v[168:171], a[120:123], v[52:55], v[168:171]
    v_mfma_f32_16x16x32_bf16 v[172:175], a[120:123], v[116:119], v[172:175]
    v_mfma_f32_16x16x32_bf16 v[176:179], a[120:123], a[152:155], v[176:179]
    v_mfma_f32_16x16x32_bf16 v[180:183], a[120:123], a[184:187], v[180:183]
    v_mfma_f32_16x16x32_bf16 v[184:187], a[120:123], a[216:219], v[184:187]
    v_mfma_f32_16x16x32_bf16 v[188:191], a[120:123], a[248:251], v[188:191]
    s_waitcnt lgkmcnt(4)
    ds_read_b64_tr_b16 a[104:105], v252 offset:33088
    v_mfma_f32_16x16x32_bf16 v[160:163], a[124:127], v[56:59], v[160:163]
    ds_read_b64_tr_b16 a[106:107], v252 offset:35136
    v_mfma_f32_16x16x32_bf16 v[164:167], a[124:127], v[120:123], v[164:167]
    v_mfma_f32_16x16x32_bf16 v[168:171], a[124:127], v[60:63], v[168:171]
    v_mfma_f32_16x16x32_bf16 v[172:175], a[124:127], v[124:127], v[172:175]
    v_mfma_f32_16x16x32_bf16 v[176:179], a[124:127], a[156:159], v[176:179]
    v_mfma_f32_16x16x32_bf16 v[180:183], a[124:127], a[188:191], v[180:183]
    v_mfma_f32_16x16x32_bf16 v[184:187], a[124:127], a[220:223], v[184:187]
    v_mfma_f32_16x16x32_bf16 v[188:191], a[124:127], a[252:255], v[188:191]
    s_waitcnt lgkmcnt(4)
    ds_read_b64_tr_b16 a[108:109], v252 offset:37184
    v_mfma_f32_16x16x32_bf16 v[128:131], a[96:99], v[0:3], 0
    ds_read_b64_tr_b16 a[110:111], v252 offset:39232
    v_mfma_f32_16x16x32_bf16 v[132:135], a[96:99], v[64:67], 0
    v_xor_b32 v252, 32, v252
    v_mfma_f32_16x16x32_bf16 v[136:139], a[96:99], v[4:7], 0
    v_mfma_f32_16x16x32_bf16 v[140:143], a[96:99], v[68:71], 0
    v_cvt_pk_bf16_f32 v216, v160, v161
    v_cvt_pk_bf16_f32 v217, v162, v163
    v_mfma_f32_16x16x32_bf16 v[144:147], a[96:99], a[128:131], 0
    v_cvt_pk_bf16_f32 v218, v164, v165
    v_cvt_pk_bf16_f32 v219, v166, v167
    v_mfma_f32_16x16x32_bf16 v[148:151], a[96:99], a[160:163], 0
    buffer_store_dwordx4 v[216:219], v246, s[20:23], s60 offen offset:1024 sc1
    v_cvt_pk_bf16_f32 v220, v168, v169
    v_mfma_f32_16x16x32_bf16 v[152:155], a[96:99], a[192:195], 0
    v_cvt_pk_bf16_f32 v221, v170, v171
    v_cvt_pk_bf16_f32 v222, v172, v173
    v_mfma_f32_16x16x32_bf16 v[156:159], a[96:99], a[224:227], 0
    s_waitcnt lgkmcnt(4)
    ds_read_b64_tr_b16 a[112:113], v253 offset:0
    v_cvt_pk_bf16_f32 v223, v174, v175
    v_mfma_f32_16x16x32_bf16 v[128:131], a[100:103], v[8:11], v[128:131]
    buffer_store_dwordx4 v[220:223], v246, s[20:23], s61 offen offset:1024 sc1
    ds_read_b64_tr_b16 a[114:115], v253 offset:2048
    v_mfma_f32_16x16x32_bf16 v[132:135], a[100:103], v[72:75], v[132:135]
    v_cvt_pk_bf16_f32 v224, v176, v177
    v_cvt_pk_bf16_f32 v225, v178, v179
    v_mfma_f32_16x16x32_bf16 v[136:139], a[100:103], v[12:15], v[136:139]
    v_cvt_pk_bf16_f32 v226, v180, v181
    v_cvt_pk_bf16_f32 v227, v182, v183
    v_mfma_f32_16x16x32_bf16 v[140:143], a[100:103], v[76:79], v[140:143]
    buffer_store_dwordx4 v[224:227], v246, s[20:23], s62 offen offset:1024 sc1
    v_cvt_pk_bf16_f32 v228, v184, v185
    v_mfma_f32_16x16x32_bf16 v[144:147], a[100:103], a[132:135], v[144:147]
    v_cvt_pk_bf16_f32 v229, v186, v187
    v_cvt_pk_bf16_f32 v230, v188, v189
    v_mfma_f32_16x16x32_bf16 v[148:151], a[100:103], a[164:167], v[148:151]
    v_cvt_pk_bf16_f32 v231, v190, v191
    v_mfma_f32_16x16x32_bf16 v[152:155], a[100:103], a[196:199], v[152:155]
    buffer_store_dwordx4 v[228:231], v246, s[20:23], s63 offen offset:1024 sc1
    v_mfma_f32_16x16x32_bf16 v[156:159], a[100:103], a[228:231], v[156:159]
    s_waitcnt lgkmcnt(4)
    ds_read_b64_tr_b16 a[116:117], v253 offset:4096
    v_mfma_f32_16x16x32_bf16 v[128:131], a[104:107], v[16:19], v[128:131]
    ds_read_b64_tr_b16 a[118:119], v253 offset:6144
    v_mfma_f32_16x16x32_bf16 v[132:135], a[104:107], v[80:83], v[132:135]
    v_mfma_f32_16x16x32_bf16 v[136:139], a[104:107], v[20:23], v[136:139]
    v_mfma_f32_16x16x32_bf16 v[140:143], a[104:107], v[84:87], v[140:143]
    v_mfma_f32_16x16x32_bf16 v[144:147], a[104:107], a[136:139], v[144:147]
    v_mfma_f32_16x16x32_bf16 v[148:151], a[104:107], a[168:171], v[148:151]
    v_mfma_f32_16x16x32_bf16 v[152:155], a[104:107], a[200:203], v[152:155]
    v_mfma_f32_16x16x32_bf16 v[156:159], a[104:107], a[232:235], v[156:159]
    s_waitcnt lgkmcnt(4)
    ds_read_b64_tr_b16 a[120:121], v253 offset:8192
    v_mfma_f32_16x16x32_bf16 v[128:131], a[108:111], v[24:27], v[128:131]
    ds_read_b64_tr_b16 a[122:123], v253 offset:10240
    v_mfma_f32_16x16x32_bf16 v[132:135], a[108:111], v[88:91], v[132:135]
    v_mfma_f32_16x16x32_bf16 v[136:139], a[108:111], v[28:31], v[136:139]
    v_mfma_f32_16x16x32_bf16 v[140:143], a[108:111], v[92:95], v[140:143]
    v_mfma_f32_16x16x32_bf16 v[144:147], a[108:111], a[140:143], v[144:147]
    v_mfma_f32_16x16x32_bf16 v[148:151], a[108:111], a[172:175], v[148:151]
    v_mfma_f32_16x16x32_bf16 v[152:155], a[108:111], a[204:207], v[152:155]
    v_mfma_f32_16x16x32_bf16 v[156:159], a[108:111], a[236:239], v[156:159]
    s_waitcnt lgkmcnt(4)
    ds_read_b64_tr_b16 a[124:125], v253 offset:12288
    v_mfma_f32_16x16x32_bf16 v[128:131], a[112:115], v[32:35], v[128:131]
    ds_read_b64_tr_b16 a[126:127], v253 offset:14336
    v_mfma_f32_16x16x32_bf16 v[132:135], a[112:115], v[96:99], v[132:135]
    v_xor_b32 v253, 32, v253
    v_mfma_f32_16x16x32_bf16 v[136:139], a[112:115], v[36:39], v[136:139]
    v_mfma_f32_16x16x32_bf16 v[140:143], a[112:115], v[100:103], v[140:143]
    v_mfma_f32_16x16x32_bf16 v[144:147], a[112:115], a[144:147], v[144:147]
    v_mfma_f32_16x16x32_bf16 v[148:151], a[112:115], a[176:179], v[148:151]
    v_mfma_f32_16x16x32_bf16 v[152:155], a[112:115], a[208:211], v[152:155]
    v_mfma_f32_16x16x32_bf16 v[156:159], a[112:115], a[240:243], v[156:159]
    s_waitcnt lgkmcnt(4)
    ds_read_b64_tr_b16 a[96:97], v252 offset:0
    v_mfma_f32_16x16x32_bf16 v[128:131], a[116:119], v[40:43], v[128:131]
    ds_read_b64_tr_b16 a[98:99], v252 offset:2048
    v_mfma_f32_16x16x32_bf16 v[132:135], a[116:119], v[104:107], v[132:135]
    ds_read_b64_tr_b16 a[100:101], v252 offset:4096
    v_mfma_f32_16x16x32_bf16 v[136:139], a[116:119], v[44:47], v[136:139]
    ds_read_b64_tr_b16 a[102:103], v252 offset:6144
    v_mfma_f32_16x16x32_bf16 v[140:143], a[116:119], v[108:111], v[140:143]
    ds_read_b64_tr_b16 a[104:105], v252 offset:33088
    v_mfma_f32_16x16x32_bf16 v[144:147], a[116:119], a[148:151], v[144:147]
    ds_read_b64_tr_b16 a[106:107], v252 offset:35136
    v_mfma_f32_16x16x32_bf16 v[148:151], a[116:119], a[180:183], v[148:151]
    ds_read_b64_tr_b16 a[108:109], v252 offset:37184
    v_mfma_f32_16x16x32_bf16 v[152:155], a[116:119], a[212:215], v[152:155]
    ds_read_b64_tr_b16 a[110:111], v252 offset:39232
    v_mfma_f32_16x16x32_bf16 v[156:159], a[116:119], a[244:247], v[156:159]
    s_waitcnt lgkmcnt(10)
    ds_read_b64_tr_b16 a[112:113], v253 offset:0
    v_mfma_f32_16x16x32_bf16 v[128:131], a[120:123], v[48:51], v[128:131]
    ds_read_b64_tr_b16 a[114:115], v253 offset:2048
    v_mfma_f32_16x16x32_bf16 v[132:135], a[120:123], v[112:115], v[132:135]
    ds_read_b64_tr_b16 a[116:117], v253 offset:4096
    v_mfma_f32_16x16x32_bf16 v[136:139], a[120:123], v[52:55], v[136:139]
    ds_read_b64_tr_b16 a[118:119], v253 offset:6144
    v_mfma_f32_16x16x32_bf16 v[140:143], a[120:123], v[116:119], v[140:143]
    v_mfma_f32_16x16x32_bf16 v[144:147], a[120:123], a[152:155], v[144:147]
    v_mfma_f32_16x16x32_bf16 v[148:151], a[120:123], a[184:187], v[148:151]
    v_mfma_f32_16x16x32_bf16 v[152:155], a[120:123], a[216:219], v[152:155]
    v_mfma_f32_16x16x32_bf16 v[156:159], a[120:123], a[248:251], v[156:159]
    s_waitcnt lgkmcnt(12)
    ds_read_b64_tr_b16 a[120:121], v253 offset:8192
    v_mfma_f32_16x16x32_bf16 v[128:131], a[124:127], v[56:59], v[128:131]
    ds_read_b64_tr_b16 a[122:123], v253 offset:10240
    v_mfma_f32_16x16x32_bf16 v[132:135], a[124:127], v[120:123], v[132:135]
    v_mfma_f32_16x16x32_bf16 v[136:139], a[124:127], v[60:63], v[136:139]
    v_mfma_f32_16x16x32_bf16 v[140:143], a[124:127], v[124:127], v[140:143]
    v_mfma_f32_16x16x32_bf16 v[144:147], a[124:127], a[156:159], v[144:147]
    v_mfma_f32_16x16x32_bf16 v[148:151], a[124:127], a[188:191], v[148:151]
    v_mfma_f32_16x16x32_bf16 v[152:155], a[124:127], a[220:223], v[152:155]
    v_mfma_f32_16x16x32_bf16 v[156:159], a[124:127], a[252:255], v[156:159]
    s_waitcnt lgkmcnt(12)
    ds_read_b64_tr_b16 a[124:125], v253 offset:12288
    v_mfma_f32_16x16x32_bf16 v[160:163], a[96:99], v[0:3], 0
    ds_read_b64_tr_b16 a[126:127], v253 offset:14336
    v_mfma_f32_16x16x32_bf16 v[164:167], a[96:99], v[64:67], 0
    s_waitcnt lgkmcnt(12)
    v_mfma_f32_16x16x32_bf16 v[160:163], a[100:103], v[8:11], v[160:163]
    v_mfma_f32_16x16x32_bf16 v[164:167], a[100:103], v[72:75], v[164:167]
    s_waitcnt lgkmcnt(10)
    v_cvt_pk_bf16_f32 v216, v128, v129
    v_cvt_pk_bf16_f32 v217, v130, v131
    v_mfma_f32_16x16x32_bf16 v[160:163], a[104:107], v[16:19], v[160:163]
    v_cvt_pk_bf16_f32 v218, v132, v133
    v_cvt_pk_bf16_f32 v219, v134, v135
    v_mfma_f32_16x16x32_bf16 v[164:167], a[104:107], v[80:83], v[164:167]
    s_waitcnt lgkmcnt(8)
    buffer_store_dwordx4 v[216:219], v246, s[20:23], s60 offen offset:2048 sc1
    v_cvt_pk_bf16_f32 v220, v136, v137
    v_mfma_f32_16x16x32_bf16 v[160:163], a[108:111], v[24:27], v[160:163]
    v_cvt_pk_bf16_f32 v221, v138, v139
    v_cvt_pk_bf16_f32 v222, v140, v141
    v_mfma_f32_16x16x32_bf16 v[164:167], a[108:111], v[88:91], v[164:167]
    s_waitcnt lgkmcnt(6)
    v_cvt_pk_bf16_f32 v223, v142, v143
    v_mfma_f32_16x16x32_bf16 v[160:163], a[112:115], v[32:35], v[160:163]
    buffer_store_dwordx4 v[220:223], v246, s[20:23], s61 offen offset:2048 sc1
    v_cvt_pk_bf16_f32 v224, v144, v145
    v_mfma_f32_16x16x32_bf16 v[164:167], a[112:115], v[96:99], v[164:167]
    s_waitcnt lgkmcnt(4)
    v_cvt_pk_bf16_f32 v225, v146, v147
    v_cvt_pk_bf16_f32 v226, v148, v149
    v_mfma_f32_16x16x32_bf16 v[160:163], a[116:119], v[40:43], v[160:163]
    v_cvt_pk_bf16_f32 v227, v150, v151
    v_cvt_pk_bf16_f32 v228, v152, v153
    v_mfma_f32_16x16x32_bf16 v[164:167], a[116:119], v[104:107], v[164:167]
    s_waitcnt lgkmcnt(2)
    buffer_store_dwordx4 v[224:227], v246, s[20:23], s62 offen offset:2048 sc1
    v_cvt_pk_bf16_f32 v229, v154, v155
    v_mfma_f32_16x16x32_bf16 v[160:163], a[120:123], v[48:51], v[160:163]
    v_cvt_pk_bf16_f32 v230, v156, v157
    v_cvt_pk_bf16_f32 v231, v158, v159
    v_mfma_f32_16x16x32_bf16 v[164:167], a[120:123], v[112:115], v[164:167]
    s_waitcnt lgkmcnt(0)
    buffer_store_dwordx4 v[228:231], v246, s[20:23], s63 offen offset:2048 sc1
    v_mfma_f32_16x16x32_bf16 v[160:163], a[124:127], v[56:59], v[160:163]
    v_mfma_f32_16x16x32_bf16 v[164:167], a[124:127], v[120:123], v[164:167]
    v_mfma_f32_16x16x32_bf16 v[168:171], a[96:99], v[4:7], 0
    v_mfma_f32_16x16x32_bf16 v[172:175], a[96:99], v[68:71], 0
    v_mfma_f32_16x16x32_bf16 v[168:171], a[100:103], v[12:15], v[168:171]
    v_mfma_f32_16x16x32_bf16 v[172:175], a[100:103], v[76:79], v[172:175]
    s_nop 2
    v_cvt_pk_bf16_f32 v216, v160, v161
    v_cvt_pk_bf16_f32 v217, v162, v163
    v_mfma_f32_16x16x32_bf16 v[168:171], a[104:107], v[20:23], v[168:171]
    v_cvt_pk_bf16_f32 v218, v164, v165
    v_cvt_pk_bf16_f32 v219, v166, v167
    v_mfma_f32_16x16x32_bf16 v[172:175], a[104:107], v[84:87], v[172:175]
    buffer_store_dwordx4 v[216:219], v246, s[20:23], s60 offen offset:3072 sc1
    v_mfma_f32_16x16x32_bf16 v[168:171], a[108:111], v[28:31], v[168:171]
    v_mfma_f32_16x16x32_bf16 v[172:175], a[108:111], v[92:95], v[172:175]
    v_mfma_f32_16x16x32_bf16 v[168:171], a[112:115], v[36:39], v[168:171]
    v_mfma_f32_16x16x32_bf16 v[172:175], a[112:115], v[100:103], v[172:175]
    v_mfma_f32_16x16x32_bf16 v[168:171], a[116:119], v[44:47], v[168:171]
    v_mfma_f32_16x16x32_bf16 v[172:175], a[116:119], v[108:111], v[172:175]
    v_mfma_f32_16x16x32_bf16 v[168:171], a[120:123], v[52:55], v[168:171]
    v_mfma_f32_16x16x32_bf16 v[172:175], a[120:123], v[116:119], v[172:175]
    v_mfma_f32_16x16x32_bf16 v[168:171], a[124:127], v[60:63], v[168:171]
    v_mfma_f32_16x16x32_bf16 v[172:175], a[124:127], v[124:127], v[172:175]
    v_mfma_f32_16x16x32_bf16 v[176:179], a[96:99], a[128:131], 0
    v_mfma_f32_16x16x32_bf16 v[180:183], a[96:99], a[160:163], 0
    v_mfma_f32_16x16x32_bf16 v[176:179], a[100:103], a[132:135], v[176:179]
    v_mfma_f32_16x16x32_bf16 v[180:183], a[100:103], a[164:167], v[180:183]
    s_nop 2
    v_cvt_pk_bf16_f32 v220, v168, v169
    v_cvt_pk_bf16_f32 v221, v170, v171
    v_mfma_f32_16x16x32_bf16 v[176:179], a[104:107], a[136:139], v[176:179]
    v_cvt_pk_bf16_f32 v222, v172, v173
    v_cvt_pk_bf16_f32 v223, v174, v175
    v_mfma_f32_16x16x32_bf16 v[180:183], a[104:107], a[168:171], v[180:183]
    buffer_store_dwordx4 v[220:223], v246, s[20:23], s61 offen offset:3072 sc1
    v_mfma_f32_16x16x32_bf16 v[176:179], a[108:111], a[140:143], v[176:179]
    v_mfma_f32_16x16x32_bf16 v[180:183], a[108:111], a[172:175], v[180:183]
    v_mfma_f32_16x16x32_bf16 v[176:179], a[112:115], a[144:147], v[176:179]
    v_mfma_f32_16x16x32_bf16 v[180:183], a[112:115], a[176:179], v[180:183]
    v_mfma_f32_16x16x32_bf16 v[176:179], a[116:119], a[148:151], v[176:179]
    v_mfma_f32_16x16x32_bf16 v[180:183], a[116:119], a[180:183], v[180:183]
    v_mfma_f32_16x16x32_bf16 v[176:179], a[120:123], a[152:155], v[176:179]
    v_mfma_f32_16x16x32_bf16 v[180:183], a[120:123], a[184:187], v[180:183]
    v_mfma_f32_16x16x32_bf16 v[176:179], a[124:127], a[156:159], v[176:179]
    v_mfma_f32_16x16x32_bf16 v[180:183], a[124:127], a[188:191], v[180:183]
    v_mfma_f32_16x16x32_bf16 v[184:187], a[96:99], a[192:195], 0
    v_mfma_f32_16x16x32_bf16 v[188:191], a[96:99], a[224:227], 0
    v_mfma_f32_16x16x32_bf16 v[184:187], a[100:103], a[196:199], v[184:187]
    v_mfma_f32_16x16x32_bf16 v[188:191], a[100:103], a[228:231], v[188:191]
    s_nop 2
    v_cvt_pk_bf16_f32 v224, v176, v177
    v_cvt_pk_bf16_f32 v225, v178, v179
    v_mfma_f32_16x16x32_bf16 v[184:187], a[104:107], a[200:203], v[184:187]
    v_cvt_pk_bf16_f32 v226, v180, v181
    v_cvt_pk_bf16_f32 v227, v182, v183
    v_mfma_f32_16x16x32_bf16 v[188:191], a[104:107], a[232:235], v[188:191]
    buffer_store_dwordx4 v[224:227], v246, s[20:23], s62 offen offset:3072 sc1
    v_mfma_f32_16x16x32_bf16 v[184:187], a[108:111], a[204:207], v[184:187]
    v_mfma_f32_16x16x32_bf16 v[188:191], a[108:111], a[236:239], v[188:191]
    v_mfma_f32_16x16x32_bf16 v[184:187], a[112:115], a[208:211], v[184:187]
    v_mfma_f32_16x16x32_bf16 v[188:191], a[112:115], a[240:243], v[188:191]
    v_mfma_f32_16x16x32_bf16 v[184:187], a[116:119], a[212:215], v[184:187]
    v_mfma_f32_16x16x32_bf16 v[188:191], a[116:119], a[244:247], v[188:191]
    v_mfma_f32_16x16x32_bf16 v[184:187], a[120:123], a[216:219], v[184:187]
    v_mfma_f32_16x16x32_bf16 v[188:191], a[120:123], a[248:251], v[188:191]
    v_mfma_f32_16x16x32_bf16 v[184:187], a[124:127], a[220:223], v[184:187]
    v_mfma_f32_16x16x32_bf16 v[188:191], a[124:127], a[252:255], v[188:191]
    s_nop 6
    v_cvt_pk_bf16_f32 v228, v184, v185
    v_cvt_pk_bf16_f32 v229, v186, v187
    v_cvt_pk_bf16_f32 v230, v188, v189
    v_cvt_pk_bf16_f32 v231, v190, v191
    buffer_store_dwordx4 v[228:231], v246, s[20:23], s63 offen offset:3072 sc1
    s_endpgm
ka_kernel_slow:
    s_nop 7
    s_nop 7
    v_max3_f32 v236, v128, v129, v130
    v_max3_f32 v236, v236, v131, v144
    v_max3_f32 v236, v236, v145, v146
    v_max_f32 v236, v236, v147
    v_mov_b32 v240, v236
    s_nop 1
    v_permlane32_swap_b32 v236, v240
    v_max_f32 v236, v236, v240
    v_mov_b32 v240, v236
    s_nop 1
    v_permlane16_swap_b32 v236, v240
    v_max_f32 v236, v236, v240
    v_max3_f32 v237, v132, v133, v134
    v_max3_f32 v237, v237, v135, v148
    v_max3_f32 v237, v237, v149, v150
    v_max_f32 v237, v237, v151
    v_mov_b32 v241, v237
    s_nop 1
    v_permlane32_swap_b32 v237, v241
    v_max_f32 v237, v237, v241
    v_mov_b32 v241, v237
    s_nop 1
    v_permlane16_swap_b32 v237, v241
    v_max_f32 v237, v237, v241
    v_max3_f32 v238, v136, v137, v138
    v_max3_f32 v238, v238, v139, v152
    v_max3_f32 v238, v238, v153, v154
    v_max_f32 v238, v238, v155
    v_mov_b32 v242, v238
    s_nop 1
    v_permlane32_swap_b32 v238, v242
    v_max_f32 v238, v238, v242
    v_mov_b32 v242, v238
    s_nop 1
    v_permlane16_swap_b32 v238, v242
    v_max_f32 v238, v238, v242
    v_max3_f32 v239, v140, v141, v142
    v_max3_f32 v239, v239, v143, v156
    v_max3_f32 v239, v239, v157, v158
    v_max_f32 v239, v239, v159
    v_mov_b32 v243, v239
    s_nop 1
    v_permlane32_swap_b32 v239, v243
    v_max_f32 v239, v239, v243
    v_mov_b32 v243, v239
    s_nop 1
    v_permlane16_swap_b32 v239, v243
    v_max_f32 v239, v239, v243
    v_lshrrev_b32_e64 v244, 23, s38
    v_sub_u32 v244, 191, v244
    v_cvt_f32_u32 v244, v244
    v_add_f32 v236, v244, v236
    v_max_f32 v236, 0, v236
    v_sub_f32 v240, 0, v236
    v_exp_f32 v240, v240
    v_add_f32 v237, v244, v237
    v_max_f32 v237, 0, v237
    v_sub_f32 v241, 0, v237
    v_exp_f32 v241, v241
    v_add_f32 v238, v244, v238
    v_max_f32 v238, 0, v238
    v_sub_f32 v242, 0, v238
    v_exp_f32 v242, v242
    v_add_f32 v239, v244, v239
    v_max_f32 v239, 0, v239
    v_sub_f32 v243, 0, v239
    v_exp_f32 v243, v243
    v_mul_f32 v232, v232, v240
    v_sub_f32 v192, v192, v236
    v_sub_f32 v193, v193, v236
    v_sub_f32 v194, v194, v236
    v_sub_f32 v195, v195, v236
    v_sub_f32 v128, v128, v236
    v_sub_f32 v129, v129, v236
    v_sub_f32 v130, v130, v236
    v_sub_f32 v131, v131, v236
    v_sub_f32 v144, v144, v236
    v_sub_f32 v145, v145, v236
    v_sub_f32 v146, v146, v236
    v_sub_f32 v147, v147, v236
    v_mul_f32 v0, v0, v240
    v_mul_f32 v1, v1, v240
    v_mul_f32 v2, v2, v240
    v_mul_f32 v3, v3, v240
    v_mul_f32 v4, v4, v240
    v_mul_f32 v5, v5, v240
    v_mul_f32 v6, v6, v240
    v_mul_f32 v7, v7, v240
    v_mul_f32 v8, v8, v240
    v_mul_f32 v9, v9, v240
    v_mul_f32 v10, v10, v240
    v_mul_f32 v11, v11, v240
    v_mul_f32 v12, v12, v240
    v_mul_f32 v13, v13, v240
    v_mul_f32 v14, v14, v240
    v_mul_f32 v15, v15, v240
    v_mul_f32 v16, v16, v240
    v_mul_f32 v17, v17, v240
    v_mul_f32 v18, v18, v240
    v_mul_f32 v19, v19, v240
    v_mul_f32 v20, v20, v240
    v_mul_f32 v21, v21, v240
    v_mul_f32 v22, v22, v240
    v_mul_f32 v23, v23, v240
    v_mul_f32 v24, v24, v240
    v_mul_f32 v25, v25, v240
    v_mul_f32 v26, v26, v240
    v_mul_f32 v27, v27, v240
    v_mul_f32 v28, v28, v240
    v_mul_f32 v29, v29, v240
    v_mul_f32 v30, v30, v240
    v_mul_f32 v31, v31, v240
    v_mul_f32 v32, v32, v240
    v_mul_f32 v33, v33, v240
    v_mul_f32 v34, v34, v240
    v_mul_f32 v35, v35, v240
    v_mul_f32 v36, v36, v240
    v_mul_f32 v37, v37, v240
    v_mul_f32 v38, v38, v240
    v_mul_f32 v39, v39, v240
    v_mul_f32 v40, v40, v240
    v_mul_f32 v41, v41, v240
    v_mul_f32 v42, v42, v240
    v_mul_f32 v43, v43, v240
    v_mul_f32 v44, v44, v240
    v_mul_f32 v45, v45, v240
    v_mul_f32 v46, v46, v240
    v_mul_f32 v47, v47, v240
    v_mul_f32 v48, v48, v240
    v_mul_f32 v49, v49, v240
    v_mul_f32 v50, v50, v240
    v_mul_f32 v51, v51, v240
    v_mul_f32 v52, v52, v240
    v_mul_f32 v53, v53, v240
    v_mul_f32 v54, v54, v240
    v_mul_f32 v55, v55, v240
    v_mul_f32 v56, v56, v240
    v_mul_f32 v57, v57, v240
    v_mul_f32 v58, v58, v240
    v_mul_f32 v59, v59, v240
    v_mul_f32 v60, v60, v240
    v_mul_f32 v61, v61, v240
    v_mul_f32 v62, v62, v240
    v_mul_f32 v63, v63, v240
    v_mul_f32 v233, v233, v241
    v_sub_f32 v196, v196, v237
    v_sub_f32 v197, v197, v237
    v_sub_f32 v198, v198, v237
    v_sub_f32 v199, v199, v237
    v_sub_f32 v132, v132, v237
    v_sub_f32 v133, v133, v237
    v_sub_f32 v134, v134, v237
    v_sub_f32 v135, v135, v237
    v_sub_f32 v148, v148, v237
    v_sub_f32 v149, v149, v237
    v_sub_f32 v150, v150, v237
    v_sub_f32 v151, v151, v237
    v_mul_f32 v64, v64, v241
    v_mul_f32 v65, v65, v241
    v_mul_f32 v66, v66, v241
    v_mul_f32 v67, v67, v241
    v_mul_f32 v68, v68, v241
    v_mul_f32 v69, v69, v241
    v_mul_f32 v70, v70, v241
    v_mul_f32 v71, v71, v241
    v_mul_f32 v72, v72, v241
    v_mul_f32 v73, v73, v241
    v_mul_f32 v74, v74, v241
    v_mul_f32 v75, v75, v241
    v_mul_f32 v76, v76, v241
    v_mul_f32 v77, v77, v241
    v_mul_f32 v78, v78, v241
    v_mul_f32 v79, v79, v241
    v_mul_f32 v80, v80, v241
    v_mul_f32 v81, v81, v241
    v_mul_f32 v82, v82, v241
    v_mul_f32 v83, v83, v241
    v_mul_f32 v84, v84, v241
    v_mul_f32 v85, v85, v241
    v_mul_f32 v86, v86, v241
    v_mul_f32 v87, v87, v241
    v_mul_f32 v88, v88, v241
    v_mul_f32 v89, v89, v241
    v_mul_f32 v90, v90, v241
    v_mul_f32 v91, v91, v241
    v_mul_f32 v92, v92, v241
    v_mul_f32 v93, v93, v241
    v_mul_f32 v94, v94, v241
    v_mul_f32 v95, v95, v241
    v_mul_f32 v96, v96, v241
    v_mul_f32 v97, v97, v241
    v_mul_f32 v98, v98, v241
    v_mul_f32 v99, v99, v241
    v_mul_f32 v100, v100, v241
    v_mul_f32 v101, v101, v241
    v_mul_f32 v102, v102, v241
    v_mul_f32 v103, v103, v241
    v_mul_f32 v104, v104, v241
    v_mul_f32 v105, v105, v241
    v_mul_f32 v106, v106, v241
    v_mul_f32 v107, v107, v241
    v_mul_f32 v108, v108, v241
    v_mul_f32 v109, v109, v241
    v_mul_f32 v110, v110, v241
    v_mul_f32 v111, v111, v241
    v_mul_f32 v112, v112, v241
    v_mul_f32 v113, v113, v241
    v_mul_f32 v114, v114, v241
    v_mul_f32 v115, v115, v241
    v_mul_f32 v116, v116, v241
    v_mul_f32 v117, v117, v241
    v_mul_f32 v118, v118, v241
    v_mul_f32 v119, v119, v241
    v_mul_f32 v120, v120, v241
    v_mul_f32 v121, v121, v241
    v_mul_f32 v122, v122, v241
    v_mul_f32 v123, v123, v241
    v_mul_f32 v124, v124, v241
    v_mul_f32 v125, v125, v241
    v_mul_f32 v126, v126, v241
    v_mul_f32 v127, v127, v241
    v_mul_f32 v234, v234, v242
    v_sub_f32 v200, v200, v238
    v_sub_f32 v201, v201, v238
    v_sub_f32 v202, v202, v238
    v_sub_f32 v203, v203, v238
    v_sub_f32 v136, v136, v238
    v_sub_f32 v137, v137, v238
    v_sub_f32 v138, v138, v238
    v_sub_f32 v139, v139, v238
    v_sub_f32 v152, v152, v238
    v_sub_f32 v153, v153, v238
    v_sub_f32 v154, v154, v238
    v_sub_f32 v155, v155, v238
    v_accvgpr_read_b32 v244, a128
    v_accvgpr_read_b32 v245, a129
    v_accvgpr_read_b32 v246, a130
    v_accvgpr_read_b32 v247, a131
    v_mul_f32 v244, v244, v242
    v_mul_f32 v245, v245, v242
    v_mul_f32 v246, v246, v242
    v_mul_f32 v247, v247, v242
    v_accvgpr_write_b32 a128, v244
    v_accvgpr_write_b32 a129, v245
    v_accvgpr_write_b32 a130, v246
    v_accvgpr_write_b32 a131, v247
    v_accvgpr_read_b32 v244, a132
    v_accvgpr_read_b32 v245, a133
    v_accvgpr_read_b32 v246, a134
    v_accvgpr_read_b32 v247, a135
    v_mul_f32 v244, v244, v242
    v_mul_f32 v245, v245, v242
    v_mul_f32 v246, v246, v242
    v_mul_f32 v247, v247, v242
    v_accvgpr_write_b32 a132, v244
    v_accvgpr_write_b32 a133, v245
    v_accvgpr_write_b32 a134, v246
    v_accvgpr_write_b32 a135, v247
    v_accvgpr_read_b32 v244, a136
    v_accvgpr_read_b32 v245, a137
    v_accvgpr_read_b32 v246, a138
    v_accvgpr_read_b32 v247, a139
    v_mul_f32 v244, v244, v242
    v_mul_f32 v245, v245, v242
    v_mul_f32 v246, v246, v242
    v_mul_f32 v247, v247, v242
    v_accvgpr_write_b32 a136, v244
    v_accvgpr_write_b32 a137, v245
    v_accvgpr_write_b32 a138, v246
    v_accvgpr_write_b32 a139, v247
    v_accvgpr_read_b32 v244, a140
    v_accvgpr_read_b32 v245, a141
    v_accvgpr_read_b32 v246, a142
    v_accvgpr_read_b32 v247, a143
    v_mul_f32 v244, v244, v242
    v_mul_f32 v245, v245, v242
    v_mul_f32 v246, v246, v242
    v_mul_f32 v247, v247, v242
    v_accvgpr_write_b32 a140, v244
    v_accvgpr_write_b32 a141, v245
    v_accvgpr_write_b32 a142, v246
    v_accvgpr_write_b32 a143, v247
    v_accvgpr_read_b32 v244, a144
    v_accvgpr_read_b32 v245, a145
    v_accvgpr_read_b32 v246, a146
    v_accvgpr_read_b32 v247, a147
    v_mul_f32 v244, v244, v242
    v_mul_f32 v245, v245, v242
    v_mul_f32 v246, v246, v242
    v_mul_f32 v247, v247, v242
    v_accvgpr_write_b32 a144, v244
    v_accvgpr_write_b32 a145, v245
    v_accvgpr_write_b32 a146, v246
    v_accvgpr_write_b32 a147, v247
    v_accvgpr_read_b32 v244, a148
    v_accvgpr_read_b32 v245, a149
    v_accvgpr_read_b32 v246, a150
    v_accvgpr_read_b32 v247, a151
    v_mul_f32 v244, v244, v242
    v_mul_f32 v245, v245, v242
    v_mul_f32 v246, v246, v242
    v_mul_f32 v247, v247, v242
    v_accvgpr_write_b32 a148, v244
    v_accvgpr_write_b32 a149, v245
    v_accvgpr_write_b32 a150, v246
    v_accvgpr_write_b32 a151, v247
    v_accvgpr_read_b32 v244, a152
    v_accvgpr_read_b32 v245, a153
    v_accvgpr_read_b32 v246, a154
    v_accvgpr_read_b32 v247, a155
    v_mul_f32 v244, v244, v242
    v_mul_f32 v245, v245, v242
    v_mul_f32 v246, v246, v242
    v_mul_f32 v247, v247, v242
    v_accvgpr_write_b32 a152, v244
    v_accvgpr_write_b32 a153, v245
    v_accvgpr_write_b32 a154, v246
    v_accvgpr_write_b32 a155, v247
    v_accvgpr_read_b32 v244, a156
    v_accvgpr_read_b32 v245, a157
    v_accvgpr_read_b32 v246, a158
    v_accvgpr_read_b32 v247, a159
    v_mul_f32 v244, v244, v242
    v_mul_f32 v245, v245, v242
    v_mul_f32 v246, v246, v242
    v_mul_f32 v247, v247, v242
    v_accvgpr_write_b32 a156, v244
    v_accvgpr_write_b32 a157, v245
    v_accvgpr_write_b32 a158, v246
    v_accvgpr_write_b32 a159, v247
    v_accvgpr_read_b32 v244, a160
    v_accvgpr_read_b32 v245, a161
    v_accvgpr_read_b32 v246, a162
    v_accvgpr_read_b32 v247, a163
    v_mul_f32 v244, v244, v242
    v_mul_f32 v245, v245, v242
    v_mul_f32 v246, v246, v242
    v_mul_f32 v247, v247, v242
    v_accvgpr_write_b32 a160, v244
    v_accvgpr_write_b32 a161, v245
    v_accvgpr_write_b32 a162, v246
    v_accvgpr_write_b32 a163, v247
    v_accvgpr_read_b32 v244, a164
    v_accvgpr_read_b32 v245, a165
    v_accvgpr_read_b32 v246, a166
    v_accvgpr_read_b32 v247, a167
    v_mul_f32 v244, v244, v242
    v_mul_f32 v245, v245, v242
    v_mul_f32 v246, v246, v242
    v_mul_f32 v247, v247, v242
    v_accvgpr_write_b32 a164, v244
    v_accvgpr_write_b32 a165, v245
    v_accvgpr_write_b32 a166, v246
    v_accvgpr_write_b32 a167, v247
    v_accvgpr_read_b32 v244, a168
    v_accvgpr_read_b32 v245, a169
    v_accvgpr_read_b32 v246, a170
    v_accvgpr_read_b32 v247, a171
    v_mul_f32 v244, v244, v242
    v_mul_f32 v245, v245, v242
    v_mul_f32 v246, v246, v242
    v_mul_f32 v247, v247, v242
    v_accvgpr_write_b32 a168, v244
    v_accvgpr_write_b32 a169, v245
    v_accvgpr_write_b32 a170, v246
    v_accvgpr_write_b32 a171, v247
    v_accvgpr_read_b32 v244, a172
    v_accvgpr_read_b32 v245, a173
    v_accvgpr_read_b32 v246, a174
    v_accvgpr_read_b32 v247, a175
    v_mul_f32 v244, v244, v242
    v_mul_f32 v245, v245, v242
    v_mul_f32 v246, v246, v242
    v_mul_f32 v247, v247, v242
    v_accvgpr_write_b32 a172, v244
    v_accvgpr_write_b32 a173, v245
    v_accvgpr_write_b32 a174, v246
    v_accvgpr_write_b32 a175, v247
    v_accvgpr_read_b32 v244, a176
    v_accvgpr_read_b32 v245, a177
    v_accvgpr_read_b32 v246, a178
    v_accvgpr_read_b32 v247, a179
    v_mul_f32 v244, v244, v242
    v_mul_f32 v245, v245, v242
    v_mul_f32 v246, v246, v242
    v_mul_f32 v247, v247, v242
    v_accvgpr_write_b32 a176, v244
    v_accvgpr_write_b32 a177, v245
    v_accvgpr_write_b32 a178, v246
    v_accvgpr_write_b32 a179, v247
    v_accvgpr_read_b32 v244, a180
    v_accvgpr_read_b32 v245, a181
    v_accvgpr_read_b32 v246, a182
    v_accvgpr_read_b32 v247, a183
    v_mul_f32 v244, v244, v242
    v_mul_f32 v245, v245, v242
    v_mul_f32 v246, v246, v242
    v_mul_f32 v247, v247, v242
    v_accvgpr_write_b32 a180, v244
    v_accvgpr_write_b32 a181, v245
    v_accvgpr_write_b32 a182, v246
    v_accvgpr_write_b32 a183, v247
    v_accvgpr_read_b32 v244, a184
    v_accvgpr_read_b32 v245, a185
    v_accvgpr_read_b32 v246, a186
    v_accvgpr_read_b32 v247, a187
    v_mul_f32 v244, v244, v242
    v_mul_f32 v245, v245, v242
    v_mul_f32 v246, v246, v242
    v_mul_f32 v247, v247, v242
    v_accvgpr_write_b32 a184, v244
    v_accvgpr_write_b32 a185, v245
    v_accvgpr_write_b32 a186, v246
    v_accvgpr_write_b32 a187, v247
    v_accvgpr_read_b32 v244, a188
    v_accvgpr_read_b32 v245, a189
    v_accvgpr_read_b32 v246, a190
    v_accvgpr_read_b32 v247, a191
    v_mul_f32 v244, v244, v242
    v_mul_f32 v245, v245, v242
    v_mul_f32 v246, v246, v242
    v_mul_f32 v247, v247, v242
    v_accvgpr_write_b32 a188, v244
    v_accvgpr_write_b32 a189, v245
    v_accvgpr_write_b32 a190, v246
    v_accvgpr_write_b32 a191, v247
    v_mul_f32 v235, v235, v243
    v_sub_f32 v204, v204, v239
    v_sub_f32 v205, v205, v239
    v_sub_f32 v206, v206, v239
    v_sub_f32 v207, v207, v239
    v_sub_f32 v140, v140, v239
    v_sub_f32 v141, v141, v239
    v_sub_f32 v142, v142, v239
    v_sub_f32 v143, v143, v239
    v_sub_f32 v156, v156, v239
    v_sub_f32 v157, v157, v239
    v_sub_f32 v158, v158, v239
    v_sub_f32 v159, v159, v239
    v_accvgpr_read_b32 v244, a192
    v_accvgpr_read_b32 v245, a193
    v_accvgpr_read_b32 v246, a194
    v_accvgpr_read_b32 v247, a195
    v_mul_f32 v244, v244, v243
    v_mul_f32 v245, v245, v243
    v_mul_f32 v246, v246, v243
    v_mul_f32 v247, v247, v243
    v_accvgpr_write_b32 a192, v244
    v_accvgpr_write_b32 a193, v245
    v_accvgpr_write_b32 a194, v246
    v_accvgpr_write_b32 a195, v247
    v_accvgpr_read_b32 v244, a196
    v_accvgpr_read_b32 v245, a197
    v_accvgpr_read_b32 v246, a198
    v_accvgpr_read_b32 v247, a199
    v_mul_f32 v244, v244, v243
    v_mul_f32 v245, v245, v243
    v_mul_f32 v246, v246, v243
    v_mul_f32 v247, v247, v243
    v_accvgpr_write_b32 a196, v244
    v_accvgpr_write_b32 a197, v245
    v_accvgpr_write_b32 a198, v246
    v_accvgpr_write_b32 a199, v247
    v_accvgpr_read_b32 v244, a200
    v_accvgpr_read_b32 v245, a201
    v_accvgpr_read_b32 v246, a202
    v_accvgpr_read_b32 v247, a203
    v_mul_f32 v244, v244, v243
    v_mul_f32 v245, v245, v243
    v_mul_f32 v246, v246, v243
    v_mul_f32 v247, v247, v243
    v_accvgpr_write_b32 a200, v244
    v_accvgpr_write_b32 a201, v245
    v_accvgpr_write_b32 a202, v246
    v_accvgpr_write_b32 a203, v247
    v_accvgpr_read_b32 v244, a204
    v_accvgpr_read_b32 v245, a205
    v_accvgpr_read_b32 v246, a206
    v_accvgpr_read_b32 v247, a207
    v_mul_f32 v244, v244, v243
    v_mul_f32 v245, v245, v243
    v_mul_f32 v246, v246, v243
    v_mul_f32 v247, v247, v243
    v_accvgpr_write_b32 a204, v244
    v_accvgpr_write_b32 a205, v245
    v_accvgpr_write_b32 a206, v246
    v_accvgpr_write_b32 a207, v247
    v_accvgpr_read_b32 v244, a208
    v_accvgpr_read_b32 v245, a209
    v_accvgpr_read_b32 v246, a210
    v_accvgpr_read_b32 v247, a211
    v_mul_f32 v244, v244, v243
    v_mul_f32 v245, v245, v243
    v_mul_f32 v246, v246, v243
    v_mul_f32 v247, v247, v243
    v_accvgpr_write_b32 a208, v244
    v_accvgpr_write_b32 a209, v245
    v_accvgpr_write_b32 a210, v246
    v_accvgpr_write_b32 a211, v247
    v_accvgpr_read_b32 v244, a212
    v_accvgpr_read_b32 v245, a213
    v_accvgpr_read_b32 v246, a214
    v_accvgpr_read_b32 v247, a215
    v_mul_f32 v244, v244, v243
    v_mul_f32 v245, v245, v243
    v_mul_f32 v246, v246, v243
    v_mul_f32 v247, v247, v243
    v_accvgpr_write_b32 a212, v244
    v_accvgpr_write_b32 a213, v245
    v_accvgpr_write_b32 a214, v246
    v_accvgpr_write_b32 a215, v247
    v_accvgpr_read_b32 v244, a216
    v_accvgpr_read_b32 v245, a217
    v_accvgpr_read_b32 v246, a218
    v_accvgpr_read_b32 v247, a219
    v_mul_f32 v244, v244, v243
    v_mul_f32 v245, v245, v243
    v_mul_f32 v246, v246, v243
    v_mul_f32 v247, v247, v243
    v_accvgpr_write_b32 a216, v244
    v_accvgpr_write_b32 a217, v245
    v_accvgpr_write_b32 a218, v246
    v_accvgpr_write_b32 a219, v247
    v_accvgpr_read_b32 v244, a220
    v_accvgpr_read_b32 v245, a221
    v_accvgpr_read_b32 v246, a222
    v_accvgpr_read_b32 v247, a223
    v_mul_f32 v244, v244, v243
    v_mul_f32 v245, v245, v243
    v_mul_f32 v246, v246, v243
    v_mul_f32 v247, v247, v243
    v_accvgpr_write_b32 a220, v244
    v_accvgpr_write_b32 a221, v245
    v_accvgpr_write_b32 a222, v246
    v_accvgpr_write_b32 a223, v247
    v_accvgpr_read_b32 v244, a224
    v_accvgpr_read_b32 v245, a225
    v_accvgpr_read_b32 v246, a226
    v_accvgpr_read_b32 v247, a227
    v_mul_f32 v244, v244, v243
    v_mul_f32 v245, v245, v243
    v_mul_f32 v246, v246, v243
    v_mul_f32 v247, v247, v243
    v_accvgpr_write_b32 a224, v244
    v_accvgpr_write_b32 a225, v245
    v_accvgpr_write_b32 a226, v246
    v_accvgpr_write_b32 a227, v247
    v_accvgpr_read_b32 v244, a228
    v_accvgpr_read_b32 v245, a229
    v_accvgpr_read_b32 v246, a230
    v_accvgpr_read_b32 v247, a231
    v_mul_f32 v244, v244, v243
    v_mul_f32 v245, v245, v243
    v_mul_f32 v246, v246, v243
    v_mul_f32 v247, v247, v243
    v_accvgpr_write_b32 a228, v244
    v_accvgpr_write_b32 a229, v245
    v_accvgpr_write_b32 a230, v246
    v_accvgpr_write_b32 a231, v247
    v_accvgpr_read_b32 v244, a232
    v_accvgpr_read_b32 v245, a233
    v_accvgpr_read_b32 v246, a234
    v_accvgpr_read_b32 v247, a235
    v_mul_f32 v244, v244, v243
    v_mul_f32 v245, v245, v243
    v_mul_f32 v246, v246, v243
    v_mul_f32 v247, v247, v243
    v_accvgpr_write_b32 a232, v244
    v_accvgpr_write_b32 a233, v245
    v_accvgpr_write_b32 a234, v246
    v_accvgpr_write_b32 a235, v247
    v_accvgpr_read_b32 v244, a236
    v_accvgpr_read_b32 v245, a237
    v_accvgpr_read_b32 v246, a238
    v_accvgpr_read_b32 v247, a239
    v_mul_f32 v244, v244, v243
    v_mul_f32 v245, v245, v243
    v_mul_f32 v246, v246, v243
    v_mul_f32 v247, v247, v243
    v_accvgpr_write_b32 a236, v244
    v_accvgpr_write_b32 a237, v245
    v_accvgpr_write_b32 a238, v246
    v_accvgpr_write_b32 a239, v247
    v_accvgpr_read_b32 v244, a240
    v_accvgpr_read_b32 v245, a241
    v_accvgpr_read_b32 v246, a242
    v_accvgpr_read_b32 v247, a243
    v_mul_f32 v244, v244, v243
    v_mul_f32 v245, v245, v243
    v_mul_f32 v246, v246, v243
    v_mul_f32 v247, v247, v243
    v_accvgpr_write_b32 a240, v244
    v_accvgpr_write_b32 a241, v245
    v_accvgpr_write_b32 a242, v246
    v_accvgpr_write_b32 a243, v247
    v_accvgpr_read_b32 v244, a244
    v_accvgpr_read_b32 v245, a245
    v_accvgpr_read_b32 v246, a246
    v_accvgpr_read_b32 v247, a247
    v_mul_f32 v244, v244, v243
    v_mul_f32 v245, v245, v243
    v_mul_f32 v246, v246, v243
    v_mul_f32 v247, v247, v243
    v_accvgpr_write_b32 a244, v244
    v_accvgpr_write_b32 a245, v245
    v_accvgpr_write_b32 a246, v246
    v_accvgpr_write_b32 a247, v247
    v_accvgpr_read_b32 v244, a248
    v_accvgpr_read_b32 v245, a249
    v_accvgpr_read_b32 v246, a250
    v_accvgpr_read_b32 v247, a251
    v_mul_f32 v244, v244, v243
    v_mul_f32 v245, v245, v243
    v_mul_f32 v246, v246, v243
    v_mul_f32 v247, v247, v243
    v_accvgpr_write_b32 a248, v244
    v_accvgpr_write_b32 a249, v245
    v_accvgpr_write_b32 a250, v246
    v_accvgpr_write_b32 a251, v247
    v_accvgpr_read_b32 v244, a252
    v_accvgpr_read_b32 v245, a253
    v_accvgpr_read_b32 v246, a254
    v_accvgpr_read_b32 v247, a255
    v_mul_f32 v244, v244, v243
    v_mul_f32 v245, v245, v243
    v_mul_f32 v246, v246, v243
    v_mul_f32 v247, v247, v243
    v_accvgpr_write_b32 a252, v244
    v_accvgpr_write_b32 a253, v245
    v_accvgpr_write_b32 a254, v246
    v_accvgpr_write_b32 a255, v247
    s_bitcmp1_b32 s37, 0
    s_cbranch_scc1 ka_kernel_slow0
    v_exp_f32 v240, v128
    v_exp_f32 v241, v129
    v_exp_f32 v242, v130
    v_exp_f32 v243, v131
    v_cvt_pk_bf16_f32 v176, v240, v241
    v_add_f32 v240, v240, v241
    v_cvt_pk_bf16_f32 v177, v242, v243
    v_add_f32 v242, v242, v243
    v_add_f32 v236, v240, v242
    v_exp_f32 v244, v132
    v_exp_f32 v245, v133
    v_exp_f32 v246, v134
    v_exp_f32 v247, v135
    v_cvt_pk_bf16_f32 v180, v244, v245
    v_add_f32 v244, v244, v245
    v_cvt_pk_bf16_f32 v181, v246, v247
    v_add_f32 v246, v246, v247
    v_add_f32 v237, v244, v246
    v_exp_f32 v240, v136
    v_exp_f32 v241, v137
    v_exp_f32 v242, v138
    v_exp_f32 v243, v139
    v_cvt_pk_bf16_f32 v184, v240, v241
    v_add_f32 v240, v240, v241
    v_cvt_pk_bf16_f32 v185, v242, v243
    v_add_f32 v242, v242, v243
    v_add_f32 v238, v240, v242
    v_exp_f32 v244, v140
    v_exp_f32 v245, v141
    v_exp_f32 v246, v142
    v_exp_f32 v247, v143
    v_cvt_pk_bf16_f32 v188, v244, v245
    v_add_f32 v244, v244, v245
    v_cvt_pk_bf16_f32 v189, v246, v247
    v_add_f32 v246, v246, v247
    v_add_f32 v239, v244, v246
    v_exp_f32 v240, v144
    v_exp_f32 v241, v145
    v_exp_f32 v242, v146
    v_exp_f32 v243, v147
    v_cvt_pk_bf16_f32 v178, v240, v241
    v_add_f32 v240, v240, v241
    v_cvt_pk_bf16_f32 v179, v242, v243
    v_add_f32 v242, v242, v243
    v_add_f32 v240, v240, v242
    v_add_f32 v236, v236, v240
    v_exp_f32 v244, v148
    v_exp_f32 v245, v149
    v_exp_f32 v246, v150
    v_exp_f32 v247, v151
    v_cvt_pk_bf16_f32 v182, v244, v245
    v_add_f32 v244, v244, v245
    v_cvt_pk_bf16_f32 v183, v246, v247
    v_add_f32 v246, v246, v247
    v_add_f32 v244, v244, v246
    v_add_f32 v237, v237, v244
    v_exp_f32 v240, v152
    v_exp_f32 v241, v153
    v_exp_f32 v242, v154
    v_exp_f32 v243, v155
    v_cvt_pk_bf16_f32 v186, v240, v241
    v_add_f32 v240, v240, v241
    v_cvt_pk_bf16_f32 v187, v242, v243
    v_add_f32 v242, v242, v243
    v_add_f32 v240, v240, v242
    v_add_f32 v238, v238, v240
    v_exp_f32 v244, v156
    v_exp_f32 v245, v157
    v_exp_f32 v246, v158
    v_exp_f32 v247, v159
    v_cvt_pk_bf16_f32 v190, v244, v245
    v_add_f32 v244, v244, v245
    v_cvt_pk_bf16_f32 v191, v246, v247
    v_add_f32 v246, v246, v247
    v_add_f32 v244, v244, v246
    v_add_f32 v239, v239, v244
    s_nop 1
    s_cmp_eq_u32 s37, 0
    s_cbranch_scc1 ka_kernel_ret0
    s_cmp_eq_u32 s37, 2
    s_cbranch_scc1 ka_kernel_ret2
    s_branch ka_kernel_ret4
ka_kernel_slow0:
    v_exp_f32 v240, v128
    v_exp_f32 v241, v129
    v_exp_f32 v242, v130
    v_exp_f32 v243, v131
    v_cvt_pk_bf16_f32 v160, v240, v241
    v_add_f32 v240, v240, v241
    v_cvt_pk_bf16_f32 v161, v242, v243
    v_add_f32 v242, v242, v243
    v_add_f32 v236, v240, v242
    v_exp_f32 v244, v132
    v_exp_f32 v245, v133
    v_exp_f32 v246, v134
    v_exp_f32 v247, v135
    v_cvt_pk_bf16_f32 v164, v244, v245
    v_add_f32 v244, v244, v245
    v_cvt_pk_bf16_f32 v165, v246, v247
    v_add_f32 v246, v246, v247
    v_add_f32 v237, v244, v246
    v_exp_f32 v240, v136
    v_exp_f32 v241, v137
    v_exp_f32 v242, v138
    v_exp_f32 v243, v139
    v_cvt_pk_bf16_f32 v168, v240, v241
    v_add_f32 v240, v240, v241
    v_cvt_pk_bf16_f32 v169, v242, v243
    v_add_f32 v242, v242, v243
    v_add_f32 v238, v240, v242
    v_exp_f32 v244, v140
    v_exp_f32 v245, v141
    v_exp_f32 v246, v142
    v_exp_f32 v247, v143
    v_cvt_pk_bf16_f32 v172, v244, v245
    v_add_f32 v244, v244, v245
    v_cvt_pk_bf16_f32 v173, v246, v247
    v_add_f32 v246, v246, v247
    v_add_f32 v239, v244, v246
    v_exp_f32 v240, v144
    v_exp_f32 v241, v145
    v_exp_f32 v242, v146
    v_exp_f32 v243, v147
    v_cvt_pk_bf16_f32 v162, v240, v241
    v_add_f32 v240, v240, v241
    v_cvt_pk_bf16_f32 v163, v242, v243
    v_add_f32 v242, v242, v243
    v_add_f32 v240, v240, v242
    v_add_f32 v236, v236, v240
    v_exp_f32 v244, v148
    v_exp_f32 v245, v149
    v_exp_f32 v246, v150
    v_exp_f32 v247, v151
    v_cvt_pk_bf16_f32 v166, v244, v245
    v_add_f32 v244, v244, v245
    v_cvt_pk_bf16_f32 v167, v246, v247
    v_add_f32 v246, v246, v247
    v_add_f32 v244, v244, v246
    v_add_f32 v237, v237, v244
    v_exp_f32 v240, v152
    v_exp_f32 v241, v153
    v_exp_f32 v242, v154
    v_exp_f32 v243, v155
    v_cvt_pk_bf16_f32 v170, v240, v241
    v_add_f32 v240, v240, v241
    v_cvt_pk_bf16_f32 v171, v242, v243
    v_add_f32 v242, v242, v243
    v_add_f32 v240, v240, v242
    v_add_f32 v238, v238, v240
    v_exp_f32 v244, v156
    v_exp_f32 v245, v157
    v_exp_f32 v246, v158
    v_exp_f32 v247, v159
    v_cvt_pk_bf16_f32 v174, v244, v245
    v_add_f32 v244, v244, v245
    v_cvt_pk_bf16_f32 v175, v246, v247
    v_add_f32 v246, v246, v247
    v_add_f32 v244, v244, v246
    v_add_f32 v239, v239, v244
    s_nop 1
    s_cmp_eq_u32 s37, 1
    s_cbranch_scc1 ka_kernel_ret1
    s_branch ka_kernel_ret3
ka_kernel_end:
    s_endpgm
.globl kb_kernel
.p2align 8
.type kb_kernel,@function
kb_kernel:
    s_cmp_ge_u32 s2, 224
    s_cbranch_scc1 kb_kernel_end
    s_load_dwordx2 s[4:5], s[0:1], 0
    s_load_dwordx4 s[8:11], s[0:1], 64
    s_load_dwordx2 s[12:13], s[0:1], 88
    v_lshrrev_b32 v248, 6, v0
    v_and_b32 v251, 63, v0
    s_and_b32 s14, s2, 7
    v_readfirstlane_b32 s35, v248
    s_lshr_b32 s15, s2, 3
    s_mul_i32 s16, s15, 37
    s_lshr_b32 s16, s16, 8
    s_mul_i32 s17, s16, 7
    s_sub_u32 s34, s15, s17
    s_lshl_b32 s14, s14, 2
    s_add_u32 s14, s14, s16
    v_lshlrev_b32 v246, 4, v251
    s_movk_i32 s16, 896
    v_lshrrev_b32 v248, 3, v251
    v_mul_u32_u24 v249, s16, v248
    v_lshrrev_b32 v248, 1, v248
    v_bfe_u32 v250, v251, 1, 2
    v_xor_b32 v248, v248, v250
    v_lshlrev_b32 v248, 5, v248
    v_and_b32 v250, 1, v251
    v_lshlrev_b32 v250, 4, v250
    v_add3_u32 v238, v248, v249, v250
    v_add_u32 v239, 6144, v238
    v_add_u32 v240, 12288, v238
    v_add_u32 v241, 18432, v238
    s_lshl_b32 s33, s35, 15
    s_mul_i32 s15, s35, 14
    s_mul_i32 s37, s14, 229376
    s_lshl_b32 s17, s15, 12
    s_add_u32 s37, s37, s17
    s_add_u32 s32, s37, 57344
    s_mul_i32 s38, s15, 28672
    s_lshl_b32 s17, s34, 7
    s_add_u32 s38, s38, s17
    s_lshl_b32 s17, s34, 13
    s_add_u32 s31, s37, s17
    s_mul_i32 s17, s34, 57344
    s_add_u32 s30, s38, s17
    s_waitcnt lgkmcnt(0)
    s_mov_b32 s24, s12
    s_mov_b32 s25, s13
    s_mov_b32 s26, 67108864
    s_mov_b32 s27, 0x00020000
    s_mov_b32 s48, s12
    s_mov_b32 s49, s13
    s_mov_b32 s50, 67108864
    s_mov_b32 s51, 0x00020000
    s_mov_b32 s20, s8
    s_mov_b32 s21, s9
    s_mov_b32 s22, 1605632
    s_mov_b32 s23, 0x00020000
    s_lshl_b32 s15, s34, 2
    s_add_u32 s15, s15, s35
    s_lshl_b32 s15, s15, 10
    s_mul_i32 s36, s14, 917504
    s_add_u32 s36, s36, s15
    s_add_u32 s36, s36, 8388608
    buffer_load_dwordx4 v[64:67], v246, s[48:51], s36 offen nt
    s_add_u32 s36, s36, 28672
    buffer_load_dwordx4 v[68:71], v246, s[48:51], s36 offen nt
    s_add_u32 s36, s36, 28672
    s_add_u32 m0, s33, 0
    buffer_load_dwordx4 a[0:3], v246, s[24:27], s31 offen offset:0
    buffer_load_dwordx4 a[4:7], v246, s[24:27], s31 offen offset:1024
    buffer_load_dwordx4 a[8:11], v246, s[24:27], s31 offen offset:2048
    buffer_load_dwordx4 a[12:15], v246, s[24:27], s31 offen offset:3072
    buffer_load_dwordx4 v238, s[20:23], s30 offen offset:0 lds
    buffer_load_dwordx4 v239, s[20:23], s30 offen offset:1024 lds
    buffer_load_dwordx4 v240, s[20:23], s30 offen offset:2048 lds
    buffer_load_dwordx4 v241, s[20:23], s30 offen offset:3072 lds
    s_add_u32 s31, s31, 4096
    s_add_u32 s30, s30, 28672
    s_cmp_eq_u32 s31, s32
    s_cselect_b32 s31, s37, s31
    s_cselect_b32 s30, s38, s30
    buffer_load_dwordx4 v[72:75], v246, s[48:51], s36 offen nt
    s_add_u32 s36, s36, 28672
    buffer_load_dwordx4 v[76:79], v246, s[48:51], s36 offen nt
    s_add_u32 s36, s36, 28672
    s_add_u32 m0, s33, 4096
    buffer_load_dwordx4 a[16:19], v246, s[24:27], s31 offen offset:0
    buffer_load_dwordx4 a[20:23], v246, s[24:27], s31 offen offset:1024
    buffer_load_dwordx4 a[24:27], v246, s[24:27], s31 offen offset:2048
    buffer_load_dwordx4 a[28:31], v246, s[24:27], s31 offen offset:3072
    buffer_load_dwordx4 v238, s[20:23], s30 offen offset:0 lds
    buffer_load_dwordx4 v239, s[20:23], s30 offen offset:1024 lds
    buffer_load_dwordx4 v240, s[20:23], s30 offen offset:2048 lds
    buffer_load_dwordx4 v241, s[20:23], s30 offen offset:3072 lds
    s_add_u32 s31, s31, 4096
    s_add_u32 s30, s30, 28672
    s_cmp_eq_u32 s31, s32
    s_cselect_b32 s31, s37, s31
    s_cselect_b32 s30, s38, s30
    buffer_load_dwordx4 v[80:83], v246, s[48:51], s36 offen nt
    s_add_u32 s36, s36, 28672
    buffer_load_dwordx4 v[84:87], v246, s[48:51], s36 offen nt
    s_add_u32 s36, s36, 28672
    s_add_u32 m0, s33, 8192
    buffer_load_dwordx4 a[32:35], v246, s[24:27], s31 offen offset:0
    buffer_load_dwordx4 a[36:39], v246, s[24:27], s31 offen offset:1024
    buffer_load_dwordx4 a[40:43], v246, s[24:27], s31 offen offset:2048
    buffer_load_dwordx4 a[44:47], v246, s[24:27], s31 offen offset:3072
    buffer_load_dwordx4 v238, s[20:23], s30 offen offset:0 lds
    buffer_load_dwordx4 v239, s[20:23], s30 offen offset:1024 lds
    buffer_load_dwordx4 v240, s[20:23], s30 offen offset:2048 lds
    buffer_load_dwordx4 v241, s[20:23], s30 offen offset:3072 lds
    s_add_u32 s31, s31, 4096
    s_add_u32 s30, s30, 28672
    s_cmp_eq_u32 s31, s32
    s_cselect_b32 s31, s37, s31
    s_cselect_b32 s30, s38, s30
    s_mov_b32 s40, s4
    s_mov_b32 s41, s5
    s_mov_b32 s42, 1835008
    s_mov_b32 s43, 0x00020000
    s_mov_b32 s44, s10
    s_mov_b32 s45, s11
    s_mov_b32 s46, 1835008
    s_mov_b32 s47, 0x00020000
    v_and_b32 v248, 15, v251
    s_lshl_b32 s15, s14, 6
    v_add_u32 v248, s15, v248
    v_mul_lo_u32 v248, v248, s16
    v_lshrrev_b32 v249, 4, v251
    v_lshlrev_b32 v249, 3, v249
    s_lshl_b32 s15, s34, 2
    s_add_u32 s15, s15, s35
    s_lshl_b32 s17, s15, 5
    v_add3_u32 v247, v248, v249, s17
    s_movk_i32 s18, 14336
    s_movk_i32 s19, 28672
    s_mov_b32 s28, 43008
    v_bfe_u32 v248, v251, 2, 3
    v_lshlrev_b32 v249, 7, v248
    v_lshrrev_b32 v250, 5, v251
    v_lshlrev_b32 v250, 10, v250
    v_add3_u32 v249, v249, v250, s33
    v_and_b32 v250, 3, v251
    v_lshlrev_b32 v250, 3, v250
    v_add_u32 v249, v249, v250
    v_lshrrev_b32 v248, 1, v248
    v_xor_b32 v248, s35, v248
    v_lshl_add_u32 v242, v248, 5, v249
    v_xor_b32 v243, 32, v242
    v_xor_b32 v244, 64, v242
    v_xor_b32 v245, 96, v242
    v_lshrrev_b32 v248, 4, v251
    v_bfe_u32 v249, v251, 2, 2
    v_cmp_eq_u32 vcc, v248, v249
    v_and_b32 v248, 1, v251
    v_lshlrev_b32 v248, 4, v248
    v_mov_b32 v249, 0x3f80
    v_lshlrev_b32 v248, v248, v249
    v_cndmask_b32 v248, 0, v248, vcc
    v_and_b32 v249, 2, v251
    v_cmp_eq_u32 vcc, 0, v249
    v_mov_b32 v232, 0
    v_mov_b32 v233, 0
    v_cndmask_b32 v234, 0, v248, vcc
    v_cndmask_b32 v235, v248, 0, vcc
    v_mov_b32 v236, 0
    v_mov_b32 v237, 0
    s_waitcnt vmcnt(20)
    ds_read_b64_tr_b16 v[192:193], v242 offset:0
    ds_read_b64_tr_b16 v[194:195], v242 offset:2048
    ds_read_b64_tr_b16 v[196:197], v243 offset:0
    ds_read_b64_tr_b16 v[198:199], v243 offset:2048
    ds_read_b64_tr_b16 v[200:201], v244 offset:0
    ds_read_b64_tr_b16 v[202:203], v244 offset:2048
    ds_read_b64_tr_b16 v[204:205], v245 offset:0
    ds_read_b64_tr_b16 v[206:207], v245 offset:2048
    s_waitcnt vmcnt(10) lgkmcnt(0)
    v_mfma_f32_16x16x32_bf16 a[224:227], v[234:237], v[64:67], 0
    ds_read_b64_tr_b16 v[208:209], v242 offset:4096
    v_mfma_f32_16x16x32_bf16 a[228:231], v[232:235], v[64:67], 0
    ds_read_b64_tr_b16 v[210:211], v242 offset:6144
    v_mfma_f32_16x16x32_bf16 a[224:227], v[234:237], v[68:71], a[224:227]
    ds_read_b64_tr_b16 v[212:213], v243 offset:4096
    v_mfma_f32_16x16x32_bf16 a[228:231], v[232:235], v[68:71], a[228:231]
    ds_read_b64_tr_b16 v[214:215], v243 offset:6144
    v_mfma_f32_16x16x32_bf16 v[0:3], v[192:195], a[0:3], 0
    ds_read_b64_tr_b16 v[216:217], v244 offset:4096
    v_mfma_f32_16x16x32_bf16 v[4:7], v[196:199], a[0:3], 0
    ds_read_b64_tr_b16 v[218:219], v244 offset:6144
    v_mfma_f32_16x16x32_bf16 v[8:11], v[200:203], a[0:3], 0
    ds_read_b64_tr_b16 v[220:221], v245 offset:4096
    v_mfma_f32_16x16x32_bf16 v[12:15], v[204:207], a[0:3], 0
    ds_read_b64_tr_b16 v[222:223], v245 offset:6144
    v_mfma_f32_16x16x32_bf16 v[16:19], v[192:195], a[4:7], 0
    buffer_load_dwordx4 v[88:91], v246, s[48:51], s36 offen nt
    s_add_u32 s36, s36, 28672
    v_mfma_f32_16x16x32_bf16 v[20:23], v[196:199], a[4:7], 0
    buffer_load_dwordx4 v[92:95], v246, s[48:51], s36 offen nt
    s_add_u32 s36, s36, 28672
    v_mfma_f32_16x16x32_bf16 v[24:27], v[200:203], a[4:7], 0
    s_add_u32 m0, s33, 12288
    v_mfma_f32_16x16x32_bf16 v[28:31], v[204:207], a[4:7], 0
    buffer_load_dwordx4 a[48:51], v246, s[24:27], s31 offen offset:0
    v_mfma_f32_16x16x32_bf16 v[32:35], v[192:195], a[8:11], 0
    buffer_load_dwordx4 a[52:55], v246, s[24:27], s31 offen offset:1024
    v_mfma_f32_16x16x32_bf16 v[36:39], v[196:199], a[8:11], 0
    buffer_load_dwordx4 a[56:59], v246, s[24:27], s31 offen offset:2048
    v_mfma_f32_16x16x32_bf16 v[40:43], v[200:203], a[8:11], 0
    buffer_load_dwordx4 a[60:63], v246, s[24:27], s31 offen offset:3072
    v_mfma_f32_16x16x32_bf16 v[44:47], v[204:207], a[8:11], 0
    buffer_load_dwordx4 v238, s[20:23], s30 offen offset:0 lds
    v_mfma_f32_16x16x32_bf16 v[48:51], v[192:195], a[12:15], 0
    buffer_load_dwordx4 v239, s[20:23], s30 offen offset:1024 lds
    v_mfma_f32_16x16x32_bf16 v[52:55], v[196:199], a[12:15], 0
    buffer_load_dwordx4 v240, s[20:23], s30 offen offset:2048 lds
    v_mfma_f32_16x16x32_bf16 v[56:59], v[200:203], a[12:15], 0
    buffer_load_dwordx4 v241, s[20:23], s30 offen offset:3072 lds
    v_mfma_f32_16x16x32_bf16 v[60:63], v[204:207], a[12:15], 0
    s_add_u32 s31, s31, 4096
    s_add_u32 s30, s30, 28672
    s_cmp_eq_u32 s31, s32
    s_cselect_b32 s31, s37, s31
    s_cselect_b32 s30, s38, s30
    s_waitcnt vmcnt(10) lgkmcnt(0)
    v_mfma_f32_16x16x32_bf16 a[224:227], v[234:237], v[72:75], a[224:227]
    ds_read_b64_tr_b16 v[192:193], v242 offset:8192
    v_mfma_f32_16x16x32_bf16 a[228:231], v[232:235], v[72:75], a[228:231]
    ds_read_b64_tr_b16 v[194:195], v242 offset:10240
    v_mfma_f32_16x16x32_bf16 a[224:227], v[234:237], v[76:79], a[224:227]
    ds_read_b64_tr_b16 v[196:197], v243 offset:8192
    v_mfma_f32_16x16x32_bf16 a[228:231], v[232:235], v[76:79], a[228:231]
    ds_read_b64_tr_b16 v[198:199], v243 offset:10240
    v_mfma_f32_16x16x32_bf16 v[0:3], v[208:211], a[16:19], v[0:3]
    ds_read_b64_tr_b16 v[200:201], v244 offset:8192
    v_mfma_f32_16x16x32_bf16 v[4:7], v[212:215], a[16:19], v[4:7]
    ds_read_b64_tr_b16 v[202:203], v244 offset:10240
    v_mfma_f32_16x16x32_bf16 v[8:11], v[216:219], a[16:19], v[8:11]
    ds_read_b64_tr_b16 v[204:205], v245 offset:8192
    v_mfma_f32_16x16x32_bf16 v[12:15], v[220:223], a[16:19], v[12:15]
    ds_read_b64_tr_b16 v[206:207], v245 offset:10240
    v_mfma_f32_16x16x32_bf16 v[16:19], v[208:211], a[20:23], v[16:19]
    buffer_load_dwordx4 v[96:99], v246, s[48:51], s36 offen nt
    s_add_u32 s36, s36, 28672
    v_mfma_f32_16x16x32_bf16 v[20:23], v[212:215], a[20:23], v[20:23]
    buffer_load_dwordx4 v[100:103], v246, s[48:51], s36 offen nt
    s_add_u32 s36, s36, 28672
    v_mfma_f32_16x16x32_bf16 v[24:27], v[216:219], a[20:23], v[24:27]
    s_add_u32 m0, s33, 16384
    v_mfma_f32_16x16x32_bf16 v[28:31], v[220:223], a[20:23], v[28:31]
    buffer_load_dwordx4 a[64:67], v246, s[24:27], s31 offen offset:0
    v_mfma_f32_16x16x32_bf16 v[32:35], v[208:211], a[24:27], v[32:35]
    buffer_load_dwordx4 a[68:71], v246, s[24:27], s31 offen offset:1024
    v_mfma_f32_16x16x32_bf16 v[36:39], v[212:215], a[24:27], v[36:39]
    buffer_load_dwordx4 a[72:75], v246, s[24:27], s31 offen offset:2048
    v_mfma_f32_16x16x32_bf16 v[40:43], v[216:219], a[24:27], v[40:43]
    buffer_load_dwordx4 a[76:79], v246, s[24:27], s31 offen offset:3072
    v_mfma_f32_16x16x32_bf16 v[44:47], v[220:223], a[24:27], v[44:47]
    buffer_load_dwordx4 v238, s[20:23], s30 offen offset:0 lds
    v_mfma_f32_16x16x32_bf16 v[48:51], v[208:211], a[28:31], v[48:51]
    buffer_load_dwordx4 v239, s[20:23], s30 offen offset:1024 lds
    v_mfma_f32_16x16x32_bf16 v[52:55], v[212:215], a[28:31], v[52:55]
    buffer_load_dwordx4 v240, s[20:23], s30 offen offset:2048 lds
    v_mfma_f32_16x16x32_bf16 v[56:59], v[216:219], a[28:31], v[56:59]
    buffer_load_dwordx4 v241, s[20:23], s30 offen offset:3072 lds
    v_mfma_f32_16x16x32_bf16 v[60:63], v[220:223], a[28:31], v[60:63]
    s_add_u32 s31, s31, 4096
    s_add_u32 s30, s30, 28672
    s_cmp_eq_u32 s31, s32
    s_cselect_b32 s31, s37, s31
    s_cselect_b32 s30, s38, s30
    s_waitcnt vmcnt(10) lgkmcnt(0)
    v_mfma_f32_16x16x32_bf16 a[224:227], v[234:237], v[80:83], a[224:227]
    ds_read_b64_tr_b16 v[208:209], v242 offset:12288
    v_mfma_f32_16x16x32_bf16 a[228:231], v[232:235], v[80:83], a[228:231]
    ds_read_b64_tr_b16 v[210:211], v242 offset:14336
    v_mfma_f32_16x16x32_bf16 a[224:227], v[234:237], v[84:87], a[224:227]
    ds_read_b64_tr_b16 v[212:213], v243 offset:12288
    v_mfma_f32_16x16x32_bf16 a[228:231], v[232:235], v[84:87], a[228:231]
    ds_read_b64_tr_b16 v[214:215], v243 offset:14336
    v_mfma_f32_16x16x32_bf16 v[0:3], v[192:195], a[32:35], v[0:3]
    ds_read_b64_tr_b16 v[216:217], v244 offset:12288
    v_mfma_f32_16x16x32_bf16 v[4:7], v[196:199], a[32:35], v[4:7]
    ds_read_b64_tr_b16 v[218:219], v244 offset:14336
    v_mfma_f32_16x16x32_bf16 v[8:11], v[200:203], a[32:35], v[8:11]
    ds_read_b64_tr_b16 v[220:221], v245 offset:12288
    v_mfma_f32_16x16x32_bf16 v[12:15], v[204:207], a[32:35], v[12:15]
    ds_read_b64_tr_b16 v[222:223], v245 offset:14336
    v_mfma_f32_16x16x32_bf16 v[16:19], v[192:195], a[36:39], v[16:19]
    buffer_load_dwordx4 v[104:107], v246, s[48:51], s36 offen nt
    s_add_u32 s36, s36, 28672
    v_mfma_f32_16x16x32_bf16 v[20:23], v[196:199], a[36:39], v[20:23]
    buffer_load_dwordx4 v[108:111], v246, s[48:51], s36 offen nt
    s_add_u32 s36, s36, 28672
    v_mfma_f32_16x16x32_bf16 v[24:27], v[200:203], a[36:39], v[24:27]
    s_add_u32 m0, s33, 20480
    v_mfma_f32_16x16x32_bf16 v[28:31], v[204:207], a[36:39], v[28:31]
    buffer_load_dwordx4 a[80:83], v246, s[24:27], s31 offen offset:0
    v_mfma_f32_16x16x32_bf16 v[32:35], v[192:195], a[40:43], v[32:35]
    buffer_load_dwordx4 a[84:87], v246, s[24:27], s31 offen offset:1024
    v_mfma_f32_16x16x32_bf16 v[36:39], v[196:199], a[40:43], v[36:39]
    buffer_load_dwordx4 a[88:91], v246, s[24:27], s31 offen offset:2048
    v_mfma_f32_16x16x32_bf16 v[40:43], v[200:203], a[40:43], v[40:43]
    buffer_load_dwordx4 a[92:95], v246, s[24:27], s31 offen offset:3072
    v_mfma_f32_16x16x32_bf16 v[44:47], v[204:207], a[40:43], v[44:47]
    buffer_load_dwordx4 v238, s[20:23], s30 offen offset:0 lds
    v_mfma_f32_16x16x32_bf16 v[48:51], v[192:195], a[44:47], v[48:51]
    buffer_load_dwordx4 v239, s[20:23], s30 offen offset:1024 lds
    v_mfma_f32_16x16x32_bf16 v[52:55], v[196:199], a[44:47], v[52:55]
    buffer_load_dwordx4 v240, s[20:23], s30 offen offset:2048 lds
    v_mfma_f32_16x16x32_bf16 v[56:59], v[200:203], a[44:47], v[56:59]
    buffer_load_dwordx4 v241, s[20:23], s30 offen offset:3072 lds
    v_mfma_f32_16x16x32_bf16 v[60:63], v[204:207], a[44:47], v[60:63]
    s_add_u32 s31, s31, 4096
    s_add_u32 s30, s30, 28672
    s_cmp_eq_u32 s31, s32
    s_cselect_b32 s31, s37, s31
    s_cselect_b32 s30, s38, s30
    s_waitcnt vmcnt(10) lgkmcnt(0)
    v_mfma_f32_16x16x32_bf16 a[224:227], v[234:237], v[88:91], a[224:227]
    ds_read_b64_tr_b16 v[192:193], v242 offset:16384
    v_mfma_f32_16x16x32_bf16 a[228:231], v[232:235], v[88:91], a[228:231]
    ds_read_b64_tr_b16 v[194:195], v242 offset:18432
    v_mfma_f32_16x16x32_bf16 a[224:227], v[234:237], v[92:95], a[224:227]
    ds_read_b64_tr_b16 v[196:197], v243 offset:16384
    v_mfma_f32_16x16x32_bf16 a[228:231], v[232:235], v[92:95], a[228:231]
    ds_read_b64_tr_b16 v[198:199], v243 offset:18432
    v_mfma_f32_16x16x32_bf16 v[0:3], v[208:211], a[48:51], v[0:3]
    ds_read_b64_tr_b16 v[200:201], v244 offset:16384
    v_mfma_f32_16x16x32_bf16 v[4:7], v[212:215], a[48:51], v[4:7]
    ds_read_b64_tr_b16 v[202:203], v244 offset:18432
    v_mfma_f32_16x16x32_bf16 v[8:11], v[216:219], a[48:51], v[8:11]
    ds_read_b64_tr_b16 v[204:205], v245 offset:16384
    v_mfma_f32_16x16x32_bf16 v[12:15], v[220:223], a[48:51], v[12:15]
    ds_read_b64_tr_b16 v[206:207], v245 offset:18432
    v_mfma_f32_16x16x32_bf16 v[16:19], v[208:211], a[52:55], v[16:19]
    buffer_load_dwordx4 v[112:115], v246, s[48:51], s36 offen nt
    s_add_u32 s36, s36, 28672
    v_mfma_f32_16x16x32_bf16 v[20:23], v[212:215], a[52:55], v[20:23]
    buffer_load_dwordx4 v[116:119], v246, s[48:51], s36 offen nt
    s_add_u32 s36, s36, 28672
    v_mfma_f32_16x16x32_bf16 v[24:27], v[216:219], a[52:55], v[24:27]
    s_add_u32 m0, s33, 24576
    v_mfma_f32_16x16x32_bf16 v[28:31], v[220:223], a[52:55], v[28:31]
    buffer_load_dwordx4 a[96:99], v246, s[24:27], s31 offen offset:0
    v_mfma_f32_16x16x32_bf16 v[32:35], v[208:211], a[56:59], v[32:35]
    buffer_load_dwordx4 a[100:103], v246, s[24:27], s31 offen offset:1024
    v_mfma_f32_16x16x32_bf16 v[36:39], v[212:215], a[56:59], v[36:39]
    buffer_load_dwordx4 a[104:107], v246, s[24:27], s31 offen offset:2048
    v_mfma_f32_16x16x32_bf16 v[40:43], v[216:219], a[56:59], v[40:43]
    buffer_load_dwordx4 a[108:111], v246, s[24:27], s31 offen offset:3072
    v_mfma_f32_16x16x32_bf16 v[44:47], v[220:223], a[56:59], v[44:47]
    buffer_load_dwordx4 v238, s[20:23], s30 offen offset:0 lds
    v_mfma_f32_16x16x32_bf16 v[48:51], v[208:211], a[60:63], v[48:51]
    buffer_load_dwordx4 v239, s[20:23], s30 offen offset:1024 lds
    v_mfma_f32_16x16x32_bf16 v[52:55], v[212:215], a[60:63], v[52:55]
    buffer_load_dwordx4 v240, s[20:23], s30 offen offset:2048 lds
    v_mfma_f32_16x16x32_bf16 v[56:59], v[216:219], a[60:63], v[56:59]
    buffer_load_dwordx4 v241, s[20:23], s30 offen offset:3072 lds
    v_mfma_f32_16x16x32_bf16 v[60:63], v[220:223], a[60:63], v[60:63]
    s_add_u32 s31, s31, 4096
    s_add_u32 s30, s30, 28672
    s_cmp_eq_u32 s31, s32
    s_cselect_b32 s31, s37, s31
    s_cselect_b32 s30, s38, s30
    s_waitcnt vmcnt(10) lgkmcnt(0)
    v_mfma_f32_16x16x32_bf16 a[224:227], v[234:237], v[96:99], a[224:227]
    ds_read_b64_tr_b16 v[208:209], v242 offset:20480
    v_mfma_f32_16x16x32_bf16 a[228:231], v[232:235], v[96:99], a[228:231]
    ds_read_b64_tr_b16 v[210:211], v242 offset:22528
    v_mfma_f32_16x16x32_bf16 a[224:227], v[234:237], v[100:103], a[224:227]
    ds_read_b64_tr_b16 v[212:213], v243 offset:20480
    v_mfma_f32_16x16x32_bf16 a[228:231], v[232:235], v[100:103], a[228:231]
    ds_read_b64_tr_b16 v[214:215], v243 offset:22528
    v_mfma_f32_16x16x32_bf16 v[0:3], v[192:195], a[64:67], v[0:3]
    ds_read_b64_tr_b16 v[216:217], v244 offset:20480
    v_mfma_f32_16x16x32_bf16 v[4:7], v[196:199], a[64:67], v[4:7]
    ds_read_b64_tr_b16 v[218:219], v244 offset:22528
    v_mfma_f32_16x16x32_bf16 v[8:11], v[200:203], a[64:67], v[8:11]
    ds_read_b64_tr_b16 v[220:221], v245 offset:20480
    v_mfma_f32_16x16x32_bf16 v[12:15], v[204:207], a[64:67], v[12:15]
    ds_read_b64_tr_b16 v[222:223], v245 offset:22528
    v_mfma_f32_16x16x32_bf16 v[16:19], v[192:195], a[68:71], v[16:19]
    buffer_load_dwordx4 v[120:123], v246, s[48:51], s36 offen nt
    s_add_u32 s36, s36, 28672
    v_mfma_f32_16x16x32_bf16 v[20:23], v[196:199], a[68:71], v[20:23]
    buffer_load_dwordx4 v[124:127], v246, s[48:51], s36 offen nt
    s_add_u32 s36, s36, 28672
    v_mfma_f32_16x16x32_bf16 v[24:27], v[200:203], a[68:71], v[24:27]
    s_add_u32 m0, s33, 28672
    v_mfma_f32_16x16x32_bf16 v[28:31], v[204:207], a[68:71], v[28:31]
    buffer_load_dwordx4 a[112:115], v246, s[24:27], s31 offen offset:0
    v_mfma_f32_16x16x32_bf16 v[32:35], v[192:195], a[72:75], v[32:35]
    buffer_load_dwordx4 a[116:119], v246, s[24:27], s31 offen offset:1024
    v_mfma_f32_16x16x32_bf16 v[36:39], v[196:199], a[72:75], v[36:39]
    buffer_load_dwordx4 a[120:123], v246, s[24:27], s31 offen offset:2048
    v_mfma_f32_16x16x32_bf16 v[40:43], v[200:203], a[72:75], v[40:43]
    buffer_load_dwordx4 a[124:127], v246, s[24:27], s31 offen offset:3072
    v_mfma_f32_16x16x32_bf16 v[44:47], v[204:207], a[72:75], v[44:47]
    buffer_load_dwordx4 v238, s[20:23], s30 offen offset:0 lds
    v_mfma_f32_16x16x32_bf16 v[48:51], v[192:195], a[76:79], v[48:51]
    buffer_load_dwordx4 v239, s[20:23], s30 offen offset:1024 lds
    v_mfma_f32_16x16x32_bf16 v[52:55], v[196:199], a[76:79], v[52:55]
    buffer_load_dwordx4 v240, s[20:23], s30 offen offset:2048 lds
    v_mfma_f32_16x16x32_bf16 v[56:59], v[200:203], a[76:79], v[56:59]
    buffer_load_dwordx4 v241, s[20:23], s30 offen offset:3072 lds
    v_mfma_f32_16x16x32_bf16 v[60:63], v[204:207], a[76:79], v[60:63]
    s_add_u32 s31, s31, 4096
    s_add_u32 s30, s30, 28672
    s_cmp_eq_u32 s31, s32
    s_cselect_b32 s31, s37, s31
    s_cselect_b32 s30, s38, s30
    s_waitcnt vmcnt(10) lgkmcnt(0)
    v_mfma_f32_16x16x32_bf16 a[224:227], v[234:237], v[104:107], a[224:227]
    ds_read_b64_tr_b16 v[192:193], v242 offset:24576
    v_mfma_f32_16x16x32_bf16 a[228:231], v[232:235], v[104:107], a[228:231]
    ds_read_b64_tr_b16 v[194:195], v242 offset:26624
    v_mfma_f32_16x16x32_bf16 a[224:227], v[234:237], v[108:111], a[224:227]
    ds_read_b64_tr_b16 v[196:197], v243 offset:24576
    v_mfma_f32_16x16x32_bf16 a[228:231], v[232:235], v[108:111], a[228:231]
    ds_read_b64_tr_b16 v[198:199], v243 offset:26624
    v_mfma_f32_16x16x32_bf16 v[0:3], v[208:211], a[80:83], v[0:3]
    ds_read_b64_tr_b16 v[200:201], v244 offset:24576
    v_mfma_f32_16x16x32_bf16 v[4:7], v[212:215], a[80:83], v[4:7]
    ds_read_b64_tr_b16 v[202:203], v244 offset:26624
    v_mfma_f32_16x16x32_bf16 v[8:11], v[216:219], a[80:83], v[8:11]
    ds_read_b64_tr_b16 v[204:205], v245 offset:24576
    v_mfma_f32_16x16x32_bf16 v[12:15], v[220:223], a[80:83], v[12:15]
    ds_read_b64_tr_b16 v[206:207], v245 offset:26624
    v_mfma_f32_16x16x32_bf16 v[16:19], v[208:211], a[84:87], v[16:19]
    buffer_load_dwordx4 v[128:131], v246, s[48:51], s36 offen nt
    s_add_u32 s36, s36, 28672
    v_mfma_f32_16x16x32_bf16 v[20:23], v[212:215], a[84:87], v[20:23]
    buffer_load_dwordx4 v[132:135], v246, s[48:51], s36 offen nt
    s_add_u32 s36, s36, 28672
    v_mfma_f32_16x16x32_bf16 v[24:27], v[216:219], a[84:87], v[24:27]
    s_add_u32 m0, s33, 0
    v_mfma_f32_16x16x32_bf16 v[28:31], v[220:223], a[84:87], v[28:31]
    buffer_load_dwordx4 a[128:131], v246, s[24:27], s31 offen offset:0
    v_mfma_f32_16x16x32_bf16 v[32:35], v[208:211], a[88:91], v[32:35]
    buffer_load_dwordx4 a[132:135], v246, s[24:27], s31 offen offset:1024
    v_mfma_f32_16x16x32_bf16 v[36:39], v[212:215], a[88:91], v[36:39]
    buffer_load_dwordx4 a[136:139], v246, s[24:27], s31 offen offset:2048
    v_mfma_f32_16x16x32_bf16 v[40:43], v[216:219], a[88:91], v[40:43]
    buffer_load_dwordx4 a[140:143], v246, s[24:27], s31 offen offset:3072
    v_mfma_f32_16x16x32_bf16 v[44:47], v[220:223], a[88:91], v[44:47]
    buffer_load_dwordx4 v238, s[20:23], s30 offen offset:0 lds
    v_mfma_f32_16x16x32_bf16 v[48:51], v[208:211], a[92:95], v[48:51]
    buffer_load_dwordx4 v239, s[20:23], s30 offen offset:1024 lds
    v_mfma_f32_16x16x32_bf16 v[52:55], v[212:215], a[92:95], v[52:55]
    buffer_load_dwordx4 v240, s[20:23], s30 offen offset:2048 lds
    v_mfma_f32_16x16x32_bf16 v[56:59], v[216:219], a[92:95], v[56:59]
    buffer_load_dwordx4 v241, s[20:23], s30 offen offset:3072 lds
    v_mfma_f32_16x16x32_bf16 v[60:63], v[220:223], a[92:95], v[60:63]
    s_add_u32 s31, s31, 4096
    s_add_u32 s30, s30, 28672
    s_cmp_eq_u32 s31, s32
    s_cselect_b32 s31, s37, s31
    s_cselect_b32 s30, s38, s30
    s_waitcnt vmcnt(10) lgkmcnt(0)
    v_mfma_f32_16x16x32_bf16 a[224:227], v[234:237], v[112:115], a[224:227]
    ds_read_b64_tr_b16 v[208:209], v242 offset:28672
    v_mfma_f32_16x16x32_bf16 a[228:231], v[232:235], v[112:115], a[228:231]
    ds_read_b64_tr_b16 v[210:211], v242 offset:30720
    v_mfma_f32_16x16x32_bf16 a[224:227], v[234:237], v[116:119], a[224:227]
    ds_read_b64_tr_b16 v[212:213], v243 offset:28672
    v_mfma_f32_16x16x32_bf16 a[228:231], v[232:235], v[116:119], a[228:231]
    ds_read_b64_tr_b16 v[214:215], v243 offset:30720
    v_mfma_f32_16x16x32_bf16 v[0:3], v[192:195], a[96:99], v[0:3]
    ds_read_b64_tr_b16 v[216:217], v244 offset:28672
    v_mfma_f32_16x16x32_bf16 v[4:7], v[196:199], a[96:99], v[4:7]
    ds_read_b64_tr_b16 v[218:219], v244 offset:30720
    v_mfma_f32_16x16x32_bf16 v[8:11], v[200:203], a[96:99], v[8:11]
    ds_read_b64_tr_b16 v[220:221], v245 offset:28672
    v_mfma_f32_16x16x32_bf16 v[12:15], v[204:207], a[96:99], v[12:15]
    ds_read_b64_tr_b16 v[222:223], v245 offset:30720
    v_mfma_f32_16x16x32_bf16 v[16:19], v[192:195], a[100:103], v[16:19]
    buffer_load_dwordx4 v[136:139], v246, s[48:51], s36 offen nt
    s_add_u32 s36, s36, 28672
    v_mfma_f32_16x16x32_bf16 v[20:23], v[196:199], a[100:103], v[20:23]
    buffer_load_dwordx4 v[140:143], v246, s[48:51], s36 offen nt
    s_add_u32 s36, s36, 28672
    v_mfma_f32_16x16x32_bf16 v[24:27], v[200:203], a[100:103], v[24:27]
    s_add_u32 m0, s33, 4096
    v_mfma_f32_16x16x32_bf16 v[28:31], v[204:207], a[100:103], v[28:31]
    buffer_load_dwordx4 a[144:147], v246, s[24:27], s31 offen offset:0
    v_mfma_f32_16x16x32_bf16 v[32:35], v[192:195], a[104:107], v[32:35]
    buffer_load_dwordx4 a[148:151], v246, s[24:27], s31 offen offset:1024
    v_mfma_f32_16x16x32_bf16 v[36:39], v[196:199], a[104:107], v[36:39]
    buffer_load_dwordx4 a[152:155], v246, s[24:27], s31 offen offset:2048
    v_mfma_f32_16x16x32_bf16 v[40:43], v[200:203], a[104:107], v[40:43]
    buffer_load_dwordx4 a[156:159], v246, s[24:27], s31 offen offset:3072
    v_mfma_f32_16x16x32_bf16 v[44:47], v[204:207], a[104:107], v[44:47]
    buffer_load_dwordx4 v238, s[20:23], s30 offen offset:0 lds
    v_mfma_f32_16x16x32_bf16 v[48:51], v[192:195], a[108:111], v[48:51]
    buffer_load_dwordx4 v239, s[20:23], s30 offen offset:1024 lds
    v_mfma_f32_16x16x32_bf16 v[52:55], v[196:199], a[108:111], v[52:55]
    buffer_load_dwordx4 v240, s[20:23], s30 offen offset:2048 lds
    v_mfma_f32_16x16x32_bf16 v[56:59], v[200:203], a[108:111], v[56:59]
    buffer_load_dwordx4 v241, s[20:23], s30 offen offset:3072 lds
    v_mfma_f32_16x16x32_bf16 v[60:63], v[204:207], a[108:111], v[60:63]
    s_add_u32 s31, s31, 4096
    s_add_u32 s30, s30, 28672
    s_cmp_eq_u32 s31, s32
    s_cselect_b32 s31, s37, s31
    s_cselect_b32 s30, s38, s30
    s_waitcnt vmcnt(10) lgkmcnt(0)
    v_mfma_f32_16x16x32_bf16 a[224:227], v[234:237], v[120:123], a[224:227]
    ds_read_b64_tr_b16 v[192:193], v242 offset:0
    v_mfma_f32_16x16x32_bf16 a[228:231], v[232:235], v[120:123], a[228:231]
    ds_read_b64_tr_b16 v[194:195], v242 offset:2048
    v_mfma_f32_16x16x32_bf16 a[224:227], v[234:237], v[124:127], a[224:227]
    ds_read_b64_tr_b16 v[196:197], v243 offset:0
    v_mfma_f32_16x16x32_bf16 a[228:231], v[232:235], v[124:127], a[228:231]
    ds_read_b64_tr_b16 v[198:199], v243 offset:2048
    v_mfma_f32_16x16x32_bf16 v[0:3], v[208:211], a[112:115], v[0:3]
    ds_read_b64_tr_b16 v[200:201], v244 offset:0
    v_mfma_f32_16x16x32_bf16 v[4:7], v[212:215], a[112:115], v[4:7]
    ds_read_b64_tr_b16 v[202:203], v244 offset:2048
    v_mfma_f32_16x16x32_bf16 v[8:11], v[216:219], a[112:115], v[8:11]
    ds_read_b64_tr_b16 v[204:205], v245 offset:0
    v_mfma_f32_16x16x32_bf16 v[12:15], v[220:223], a[112:115], v[12:15]
    ds_read_b64_tr_b16 v[206:207], v245 offset:2048
    v_mfma_f32_16x16x32_bf16 v[16:19], v[208:211], a[116:119], v[16:19]
    buffer_load_dwordx4 v[144:147], v246, s[48:51], s36 offen nt
    s_add_u32 s36, s36, 28672
    v_mfma_f32_16x16x32_bf16 v[20:23], v[212:215], a[116:119], v[20:23]
    buffer_load_dwordx4 v[148:151], v246, s[48:51], s36 offen nt
    s_add_u32 s36, s36, 28672
    v_mfma_f32_16x16x32_bf16 v[24:27], v[216:219], a[116:119], v[24:27]
    s_add_u32 m0, s33, 8192
    v_mfma_f32_16x16x32_bf16 v[28:31], v[220:223], a[116:119], v[28:31]
    buffer_load_dwordx4 a[160:163], v246, s[24:27], s31 offen offset:0
    v_mfma_f32_16x16x32_bf16 v[32:35], v[208:211], a[120:123], v[32:35]
    buffer_load_dwordx4 a[164:167], v246, s[24:27], s31 offen offset:1024
    v_mfma_f32_16x16x32_bf16 v[36:39], v[212:215], a[120:123], v[36:39]
    buffer_load_dwordx4 a[168:171], v246, s[24:27], s31 offen offset:2048
    v_mfma_f32_16x16x32_bf16 v[40:43], v[216:219], a[120:123], v[40:43]
    buffer_load_dwordx4 a[172:175], v246, s[24:27], s31 offen offset:3072
    v_mfma_f32_16x16x32_bf16 v[44:47], v[220:223], a[120:123], v[44:47]
    buffer_load_dwordx4 v238, s[20:23], s30 offen offset:0 lds
    v_mfma_f32_16x16x32_bf16 v[48:51], v[208:211], a[124:127], v[48:51]
    buffer_load_dwordx4 v239, s[20:23], s30 offen offset:1024 lds
    v_mfma_f32_16x16x32_bf16 v[52:55], v[212:215], a[124:127], v[52:55]
    buffer_load_dwordx4 v240, s[20:23], s30 offen offset:2048 lds
    v_mfma_f32_16x16x32_bf16 v[56:59], v[216:219], a[124:127], v[56:59]
    buffer_load_dwordx4 v241, s[20:23], s30 offen offset:3072 lds
    v_mfma_f32_16x16x32_bf16 v[60:63], v[220:223], a[124:127], v[60:63]
    s_add_u32 s31, s31, 4096
    s_add_u32 s30, s30, 28672
    s_cmp_eq_u32 s31, s32
    s_cselect_b32 s31, s37, s31
    s_cselect_b32 s30, s38, s30
    s_waitcnt vmcnt(10) lgkmcnt(0)
    v_mfma_f32_16x16x32_bf16 a[232:235], v[234:237], v[128:131], 0
    ds_read_b64_tr_b16 v[208:209], v242 offset:4096
    v_mfma_f32_16x16x32_bf16 a[236:239], v[232:235], v[128:131], 0
    ds_read_b64_tr_b16 v[210:211], v242 offset:6144
    v_mfma_f32_16x16x32_bf16 a[232:235], v[234:237], v[132:135], a[232:235]
    ds_read_b64_tr_b16 v[212:213], v243 offset:4096
    v_mfma_f32_16x16x32_bf16 a[236:239], v[232:235], v[132:135], a[236:239]
    ds_read_b64_tr_b16 v[214:215], v243 offset:6144
    v_mfma_f32_16x16x32_bf16 v[0:3], v[192:195], a[128:131], v[0:3]
    ds_read_b64_tr_b16 v[216:217], v244 offset:4096
    v_mfma_f32_16x16x32_bf16 v[4:7], v[196:199], a[128:131], v[4:7]
    ds_read_b64_tr_b16 v[218:219], v244 offset:6144
    v_mfma_f32_16x16x32_bf16 v[8:11], v[200:203], a[128:131], v[8:11]
    ds_read_b64_tr_b16 v[220:221], v245 offset:4096
    v_mfma_f32_16x16x32_bf16 v[12:15], v[204:207], a[128:131], v[12:15]
    ds_read_b64_tr_b16 v[222:223], v245 offset:6144
    v_mfma_f32_16x16x32_bf16 v[16:19], v[192:195], a[132:135], v[16:19]
    s_add_u32 m0, s33, 12288
    v_mfma_f32_16x16x32_bf16 v[20:23], v[196:199], a[132:135], v[20:23]
    buffer_load_dwordx4 a[176:179], v246, s[24:27], s31 offen offset:0
    v_mfma_f32_16x16x32_bf16 v[24:27], v[200:203], a[132:135], v[24:27]
    buffer_load_dwordx4 a[180:183], v246, s[24:27], s31 offen offset:1024
    v_mfma_f32_16x16x32_bf16 v[28:31], v[204:207], a[132:135], v[28:31]
    buffer_load_dwordx4 a[184:187], v246, s[24:27], s31 offen offset:2048
    v_mfma_f32_16x16x32_bf16 v[32:35], v[192:195], a[136:139], v[32:35]
    buffer_load_dwordx4 a[188:191], v246, s[24:27], s31 offen offset:3072
    v_mfma_f32_16x16x32_bf16 v[36:39], v[196:199], a[136:139], v[36:39]
    buffer_load_dwordx4 v238, s[20:23], s30 offen offset:0 lds
    v_mfma_f32_16x16x32_bf16 v[40:43], v[200:203], a[136:139], v[40:43]
    buffer_load_dwordx4 v239, s[20:23], s30 offen offset:1024 lds
    v_mfma_f32_16x16x32_bf16 v[44:47], v[204:207], a[136:139], v[44:47]
    buffer_load_dwordx4 v240, s[20:23], s30 offen offset:2048 lds
    v_mfma_f32_16x16x32_bf16 v[48:51], v[192:195], a[140:143], v[48:51]
    buffer_load_dwordx4 v241, s[20:23], s30 offen offset:3072 lds
    v_mfma_f32_16x16x32_bf16 v[52:55], v[196:199], a[140:143], v[52:55]
    s_add_u32 s31, s31, 4096
    s_add_u32 s30, s30, 28672
    s_cmp_eq_u32 s31, s32
    s_cselect_b32 s31, s37, s31
    s_cselect_b32 s30, s38, s30
    v_mfma_f32_16x16x32_bf16 v[56:59], v[200:203], a[140:143], v[56:59]
    v_mfma_f32_16x16x32_bf16 v[60:63], v[204:207], a[140:143], v[60:63]
    s_waitcnt vmcnt(8) lgkmcnt(0)
    v_mfma_f32_16x16x32_bf16 a[232:235], v[234:237], v[136:139], a[232:235]
    ds_read_b64_tr_b16 v[192:193], v242 offset:8192
    v_mfma_f32_16x16x32_bf16 a[236:239], v[232:235], v[136:139], a[236:239]
    ds_read_b64_tr_b16 v[194:195], v242 offset:10240
    v_mfma_f32_16x16x32_bf16 a[232:235], v[234:237], v[140:143], a[232:235]
    ds_read_b64_tr_b16 v[196:197], v243 offset:8192
    v_mfma_f32_16x16x32_bf16 a[236:239], v[232:235], v[140:143], a[236:239]
    ds_read_b64_tr_b16 v[198:199], v243 offset:10240
    v_mfma_f32_16x16x32_bf16 v[0:3], v[208:211], a[144:147], v[0:3]
    ds_read_b64_tr_b16 v[200:201], v244 offset:8192
    v_mfma_f32_16x16x32_bf16 v[4:7], v[212:215], a[144:147], v[4:7]
    ds_read_b64_tr_b16 v[202:203], v244 offset:10240
    v_mfma_f32_16x16x32_bf16 v[8:11], v[216:219], a[144:147], v[8:11]
    ds_read_b64_tr_b16 v[204:205], v245 offset:8192
    v_mfma_f32_16x16x32_bf16 v[12:15], v[220:223], a[144:147], v[12:15]
    ds_read_b64_tr_b16 v[206:207], v245 offset:10240
    v_mfma_f32_16x16x32_bf16 v[16:19], v[208:211], a[148:151], v[16:19]
    s_add_u32 m0, s33, 16384
    v_mfma_f32_16x16x32_bf16 v[20:23], v[212:215], a[148:151], v[20:23]
    buffer_load_dwordx4 a[192:195], v246, s[24:27], s31 offen offset:0
    v_mfma_f32_16x16x32_bf16 v[24:27], v[216:219], a[148:151], v[24:27]
    buffer_load_dwordx4 a[196:199], v246, s[24:27], s31 offen offset:1024
    v_mfma_f32_16x16x32_bf16 v[28:31], v[220:223], a[148:151], v[28:31]
    buffer_load_dwordx4 a[200:203], v246, s[24:27], s31 offen offset:2048
    v_mfma_f32_16x16x32_bf16 v[32:35], v[208:211], a[152:155], v[32:35]
    buffer_load_dwordx4 a[204:207], v246, s[24:27], s31 offen offset:3072
    v_mfma_f32_16x16x32_bf16 v[36:39], v[212:215], a[152:155], v[36:39]
    buffer_load_dwordx4 v238, s[20:23], s30 offen offset:0 lds
    v_mfma_f32_16x16x32_bf16 v[40:43], v[216:219], a[152:155], v[40:43]
    buffer_load_dwordx4 v239, s[20:23], s30 offen offset:1024 lds
    v_mfma_f32_16x16x32_bf16 v[44:47], v[220:223], a[152:155], v[44:47]
    buffer_load_dwordx4 v240, s[20:23], s30 offen offset:2048 lds
    v_mfma_f32_16x16x32_bf16 v[48:51], v[208:211], a[156:159], v[48:51]
    buffer_load_dwordx4 v241, s[20:23], s30 offen offset:3072 lds
    v_mfma_f32_16x16x32_bf16 v[52:55], v[212:215], a[156:159], v[52:55]
    s_add_u32 s31, s31, 4096
    s_add_u32 s30, s30, 28672
    s_cmp_eq_u32 s31, s32
    s_cselect_b32 s31, s37, s31
    s_cselect_b32 s30, s38, s30
    v_mfma_f32_16x16x32_bf16 v[56:59], v[216:219], a[156:159], v[56:59]
    v_mfma_f32_16x16x32_bf16 v[60:63], v[220:223], a[156:159], v[60:63]
    s_waitcnt vmcnt(8) lgkmcnt(0)
    v_mfma_f32_16x16x32_bf16 a[232:235], v[234:237], v[144:147], a[232:235]
    ds_read_b64_tr_b16 v[208:209], v242 offset:12288
    v_mfma_f32_16x16x32_bf16 a[236:239], v[232:235], v[144:147], a[236:239]
    ds_read_b64_tr_b16 v[210:211], v242 offset:14336
    v_mfma_f32_16x16x32_bf16 a[232:235], v[234:237], v[148:151], a[232:235]
    ds_read_b64_tr_b16 v[212:213], v243 offset:12288
    v_mfma_f32_16x16x32_bf16 a[236:239], v[232:235], v[148:151], a[236:239]
    ds_read_b64_tr_b16 v[214:215], v243 offset:14336
    v_mfma_f32_16x16x32_bf16 v[0:3], v[192:195], a[160:163], v[0:3]
    ds_read_b64_tr_b16 v[216:217], v244 offset:12288
    v_mfma_f32_16x16x32_bf16 v[4:7], v[196:199], a[160:163], v[4:7]
    ds_read_b64_tr_b16 v[218:219], v244 offset:14336
    v_mfma_f32_16x16x32_bf16 v[8:11], v[200:203], a[160:163], v[8:11]
    ds_read_b64_tr_b16 v[220:221], v245 offset:12288
    v_mfma_f32_16x16x32_bf16 v[12:15], v[204:207], a[160:163], v[12:15]
    ds_read_b64_tr_b16 v[222:223], v245 offset:14336
    v_mfma_f32_16x16x32_bf16 v[16:19], v[192:195], a[164:167], v[16:19]
    s_add_u32 m0, s33, 20480
    v_mfma_f32_16x16x32_bf16 v[20:23], v[196:199], a[164:167], v[20:23]
    buffer_load_dwordx4 a[208:211], v246, s[24:27], s31 offen offset:0
    v_mfma_f32_16x16x32_bf16 v[24:27], v[200:203], a[164:167], v[24:27]
    buffer_load_dwordx4 a[212:215], v246, s[24:27], s31 offen offset:1024
    v_mfma_f32_16x16x32_bf16 v[28:31], v[204:207], a[164:167], v[28:31]
    buffer_load_dwordx4 a[216:219], v246, s[24:27], s31 offen offset:2048
    v_mfma_f32_16x16x32_bf16 v[32:35], v[192:195], a[168:171], v[32:35]
    buffer_load_dwordx4 a[220:223], v246, s[24:27], s31 offen offset:3072
    v_mfma_f32_16x16x32_bf16 v[36:39], v[196:199], a[168:171], v[36:39]
    buffer_load_dwordx4 v238, s[20:23], s30 offen offset:0 lds
    v_mfma_f32_16x16x32_bf16 v[40:43], v[200:203], a[168:171], v[40:43]
    buffer_load_dwordx4 v239, s[20:23], s30 offen offset:1024 lds
    v_mfma_f32_16x16x32_bf16 v[44:47], v[204:207], a[168:171], v[44:47]
    buffer_load_dwordx4 v240, s[20:23], s30 offen offset:2048 lds
    v_mfma_f32_16x16x32_bf16 v[48:51], v[192:195], a[172:175], v[48:51]
    buffer_load_dwordx4 v241, s[20:23], s30 offen offset:3072 lds
    v_mfma_f32_16x16x32_bf16 v[52:55], v[196:199], a[172:175], v[52:55]
    s_add_u32 s31, s31, 4096
    s_add_u32 s30, s30, 28672
    s_cmp_eq_u32 s31, s32
    s_cselect_b32 s31, s37, s31
    s_cselect_b32 s30, s38, s30
    v_mfma_f32_16x16x32_bf16 v[56:59], v[200:203], a[172:175], v[56:59]
    v_mfma_f32_16x16x32_bf16 v[60:63], v[204:207], a[172:175], v[60:63]
    s_waitcnt vmcnt(8) lgkmcnt(0)
    v_mfma_f32_16x16x32_bf16 v[0:3], v[208:211], a[176:179], v[0:3]
    ds_read_b64_tr_b16 v[192:193], v242 offset:16384
    v_mfma_f32_16x16x32_bf16 v[4:7], v[212:215], a[176:179], v[4:7]
    ds_read_b64_tr_b16 v[194:195], v242 offset:18432
    v_mfma_f32_16x16x32_bf16 v[8:11], v[216:219], a[176:179], v[8:11]
    ds_read_b64_tr_b16 v[196:197], v243 offset:16384
    v_mfma_f32_16x16x32_bf16 v[12:15], v[220:223], a[176:179], v[12:15]
    ds_read_b64_tr_b16 v[198:199], v243 offset:18432
    v_mfma_f32_16x16x32_bf16 v[16:19], v[208:211], a[180:183], v[16:19]
    ds_read_b64_tr_b16 v[200:201], v244 offset:16384
    v_mfma_f32_16x16x32_bf16 v[20:23], v[212:215], a[180:183], v[20:23]
    ds_read_b64_tr_b16 v[202:203], v244 offset:18432
    v_mfma_f32_16x16x32_bf16 v[24:27], v[216:219], a[180:183], v[24:27]
    ds_read_b64_tr_b16 v[204:205], v245 offset:16384
    v_mfma_f32_16x16x32_bf16 v[28:31], v[220:223], a[180:183], v[28:31]
    ds_read_b64_tr_b16 v[206:207], v245 offset:18432
    v_mfma_f32_16x16x32_bf16 v[32:35], v[208:211], a[184:187], v[32:35]
    buffer_load_dwordx2 v[224:225], v247, s[40:43], 0 offen
    v_mfma_f32_16x16x32_bf16 v[36:39], v[212:215], a[184:187], v[36:39]
    buffer_load_dwordx2 v[226:227], v247, s[40:43], s18 offen
    v_mfma_f32_16x16x32_bf16 v[40:43], v[216:219], a[184:187], v[40:43]
    buffer_load_dwordx2 v[228:229], v247, s[40:43], s19 offen
    v_mfma_f32_16x16x32_bf16 v[44:47], v[220:223], a[184:187], v[44:47]
    buffer_load_dwordx2 v[230:231], v247, s[40:43], s28 offen
    v_mfma_f32_16x16x32_bf16 v[48:51], v[208:211], a[188:191], v[48:51]
    buffer_load_dwordx4 v[152:155], v246, s[48:51], s36 offen nt
    s_add_u32 s36, s36, 28672
    v_mfma_f32_16x16x32_bf16 v[52:55], v[212:215], a[188:191], v[52:55]
    buffer_load_dwordx4 v[156:159], v246, s[48:51], s36 offen nt
    s_add_u32 s36, s36, 28672
    v_mfma_f32_16x16x32_bf16 v[56:59], v[216:219], a[188:191], v[56:59]
    buffer_load_dwordx4 v[160:163], v246, s[48:51], s36 offen nt
    s_add_u32 s36, s36, 28672
    v_mfma_f32_16x16x32_bf16 v[60:63], v[220:223], a[188:191], v[60:63]
    buffer_load_dwordx4 v[164:167], v246, s[48:51], s36 offen nt
    s_add_u32 s36, s36, 28672
    buffer_load_dwordx4 v[168:171], v246, s[48:51], s36 offen nt
    s_add_u32 s36, s36, 28672
    buffer_load_dwordx4 v[172:175], v246, s[48:51], s36 offen nt
    s_add_u32 s36, s36, 28672
    buffer_load_dwordx4 v[176:179], v246, s[48:51], s36 offen nt
    s_add_u32 s36, s36, 28672
    buffer_load_dwordx4 v[180:183], v246, s[48:51], s36 offen nt
    s_add_u32 s36, s36, 28672
    buffer_load_dwordx4 v[184:187], v246, s[48:51], s36 offen nt
    s_add_u32 s36, s36, 28672
    buffer_load_dwordx4 v[188:191], v246, s[48:51], s36 offen nt
    s_add_u32 s36, s36, 28672
    s_waitcnt vmcnt(14) lgkmcnt(0)
    v_mfma_f32_16x16x32_bf16 v[0:3], v[192:195], a[192:195], v[0:3]
    ds_read_b64_tr_b16 v[208:209], v242 offset:20480
    v_mfma_f32_16x16x32_bf16 v[4:7], v[196:199], a[192:195], v[4:7]
    ds_read_b64_tr_b16 v[210:211], v242 offset:22528
    v_mfma_f32_16x16x32_bf16 v[8:11], v[200:203], a[192:195], v[8:11]
    ds_read_b64_tr_b16 v[212:213], v243 offset:20480
    v_mfma_f32_16x16x32_bf16 v[12:15], v[204:207], a[192:195], v[12:15]
    ds_read_b64_tr_b16 v[214:215], v243 offset:22528
    v_mfma_f32_16x16x32_bf16 v[16:19], v[192:195], a[196:199], v[16:19]
    ds_read_b64_tr_b16 v[216:217], v244 offset:20480
    v_mfma_f32_16x16x32_bf16 v[20:23], v[196:199], a[196:199], v[20:23]
    ds_read_b64_tr_b16 v[218:219], v244 offset:22528
    v_mfma_f32_16x16x32_bf16 v[24:27], v[200:203], a[196:199], v[24:27]
    ds_read_b64_tr_b16 v[220:221], v245 offset:20480
    v_mfma_f32_16x16x32_bf16 v[28:31], v[204:207], a[196:199], v[28:31]
    ds_read_b64_tr_b16 v[222:223], v245 offset:22528
    v_mfma_f32_16x16x32_bf16 v[32:35], v[192:195], a[200:203], v[32:35]
    v_mfma_f32_16x16x32_bf16 v[36:39], v[196:199], a[200:203], v[36:39]
    v_mfma_f32_16x16x32_bf16 v[40:43], v[200:203], a[200:203], v[40:43]
    v_mfma_f32_16x16x32_bf16 v[44:47], v[204:207], a[200:203], v[44:47]
    v_mfma_f32_16x16x32_bf16 v[48:51], v[192:195], a[204:207], v[48:51]
    v_mfma_f32_16x16x32_bf16 v[52:55], v[196:199], a[204:207], v[52:55]
    v_mfma_f32_16x16x32_bf16 v[56:59], v[200:203], a[204:207], v[56:59]
    v_mfma_f32_16x16x32_bf16 v[60:63], v[204:207], a[204:207], v[60:63]
    s_waitcnt lgkmcnt(0)
    v_mfma_f32_16x16x32_bf16 v[0:3], v[208:211], a[208:211], v[0:3]
    v_mfma_f32_16x16x32_bf16 v[4:7], v[212:215], a[208:211], v[4:7]
    v_mfma_f32_16x16x32_bf16 v[8:11], v[216:219], a[208:211], v[8:11]
    v_mfma_f32_16x16x32_bf16 v[12:15], v[220:223], a[208:211], v[12:15]
    v_mfma_f32_16x16x32_bf16 v[16:19], v[208:211], a[212:215], v[16:19]
    v_mfma_f32_16x16x32_bf16 v[20:23], v[212:215], a[212:215], v[20:23]
    v_mfma_f32_16x16x32_bf16 v[24:27], v[216:219], a[212:215], v[24:27]
    v_mfma_f32_16x16x32_bf16 v[28:31], v[220:223], a[212:215], v[28:31]
    v_mfma_f32_16x16x32_bf16 v[32:35], v[208:211], a[216:219], v[32:35]
    v_mfma_f32_16x16x32_bf16 v[36:39], v[212:215], a[216:219], v[36:39]
    v_mfma_f32_16x16x32_bf16 v[40:43], v[216:219], a[216:219], v[40:43]
    v_mfma_f32_16x16x32_bf16 v[44:47], v[220:223], a[216:219], v[44:47]
    v_mfma_f32_16x16x32_bf16 v[48:51], v[208:211], a[220:223], v[48:51]
    v_mfma_f32_16x16x32_bf16 v[52:55], v[212:215], a[220:223], v[52:55]
    v_mfma_f32_16x16x32_bf16 v[56:59], v[216:219], a[220:223], v[56:59]
    v_mfma_f32_16x16x32_bf16 v[60:63], v[220:223], a[220:223], v[60:63]
    s_xor_b32 s15, s35, 1
    s_lshl_b32 s15, s15, 15
    v_add_u32 v253, s15, v246
    s_xor_b32 s15, s35, 2
    s_lshl_b32 s15, s15, 15
    v_add_u32 v254, s15, v246
    s_xor_b32 s15, s35, 3
    s_lshl_b32 s15, s15, 15
    v_add_u32 v255, s15, v246
    v_add_u32 v248, s33, v246
    s_mov_b32 s16, 0xbfb8aa3b
    s_mov_b32 s17, 0xffff0000
    ds_write_b128 v248, v[4:7] offset:4096
    ds_write_b128 v248, v[20:23] offset:5120
    ds_write_b128 v248, v[36:39] offset:6144
    ds_write_b128 v248, v[52:55] offset:7168
    ds_write_b128 v248, v[8:11] offset:8192
    ds_write_b128 v248, v[24:27] offset:9216
    ds_write_b128 v248, v[40:43] offset:10240
    ds_write_b128 v248, v[56:59] offset:11264
    ds_write_b128 v248, v[12:15] offset:12288
    ds_write_b128 v248, v[28:31] offset:13312
    ds_write_b128 v248, v[44:47] offset:14336
    ds_write_b128 v248, v[60:63] offset:15360
    v_accvgpr_read_b32 v64, a224
    v_accvgpr_read_b32 v65, a225
    v_accvgpr_read_b32 v66, a226
    v_accvgpr_read_b32 v67, a227
    v_accvgpr_read_b32 v68, a228
    v_accvgpr_read_b32 v69, a229
    v_accvgpr_read_b32 v70, a230
    v_accvgpr_read_b32 v71, a231
    s_waitcnt vmcnt(10)
    v_lshlrev_b32 v80, 16, v224
    v_and_b32 v81, s17, v224
    v_lshlrev_b32 v82, 16, v225
    v_and_b32 v83, s17, v225
    v_lshlrev_b32 v84, 16, v226
    v_and_b32 v85, s17, v226
    v_lshlrev_b32 v86, 16, v227
    v_and_b32 v87, s17, v227
    v_lshlrev_b32 v88, 16, v228
    v_and_b32 v89, s17, v228
    v_lshlrev_b32 v90, 16, v229
    v_and_b32 v91, s17, v229
    v_lshlrev_b32 v92, 16, v230
    v_and_b32 v93, s17, v230
    v_lshlrev_b32 v94, 16, v231
    v_and_b32 v95, s17, v231
    s_waitcnt lgkmcnt(0)
    s_barrier
    ds_read_b128 v[4:7], v253 offset:4096
    ds_read_b128 v[8:11], v254 offset:8192
    ds_read_b128 v[12:15], v255 offset:12288
    ds_read_b128 v[20:23], v253 offset:5120
    ds_read_b128 v[24:27], v254 offset:9216
    ds_read_b128 v[28:31], v255 offset:13312
    ds_read_b128 v[36:39], v253 offset:6144
    ds_read_b128 v[40:43], v254 offset:10240
    ds_read_b128 v[44:47], v255 offset:14336
    ds_read_b128 v[52:55], v253 offset:7168
    ds_read_b128 v[56:59], v254 offset:11264
    ds_read_b128 v[60:63], v255 offset:15360
    s_waitcnt lgkmcnt(9)
    v_pk_add_f32 v[0:1], v[0:1], v[4:5]
    v_pk_add_f32 v[8:9], v[8:9], v[12:13]
    v_pk_add_f32 v[2:3], v[2:3], v[6:7]
    v_pk_add_f32 v[10:11], v[10:11], v[14:15]
    v_pk_add_f32 v[0:1], v[0:1], v[8:9]
    v_pk_add_f32 v[2:3], v[2:3], v[10:11]
    v_mul_f32 v4, s16, v0
    v_mul_f32 v5, s16, v1
    v_mul_f32 v6, s16, v2
    v_mul_f32 v7, s16, v3
    v_exp_f32 v4, v4
    v_exp_f32 v5, v5
    v_exp_f32 v6, v6
    v_exp_f32 v7, v7
    v_pk_mul_f32 v[0:1], v[0:1], v[64:65]
    v_pk_mul_f32 v[2:3], v[2:3], v[66:67]
    v_add_f32 v4, 1.0, v4
    v_add_f32 v5, 1.0, v5
    v_add_f32 v6, 1.0, v6
    v_add_f32 v7, 1.0, v7
    v_rcp_f32 v4, v4
    v_rcp_f32 v5, v5
    v_rcp_f32 v6, v6
    v_rcp_f32 v7, v7
    v_fma_f32 v0, v0, v4, v80
    v_fma_f32 v1, v1, v5, v81
    v_fma_f32 v2, v2, v6, v82
    v_fma_f32 v3, v3, v7, v83
    v_cvt_pk_bf16_f32 v8, v0, v1
    v_cvt_pk_bf16_f32 v9, v2, v3
    buffer_store_dwordx2 v[8:9], v247, s[44:47], 0 offen
    s_waitcnt lgkmcnt(6)
    v_pk_add_f32 v[16:17], v[16:17], v[20:21]
    v_pk_add_f32 v[24:25], v[24:25], v[28:29]
    v_pk_add_f32 v[18:19], v[18:19], v[22:23]
    v_pk_add_f32 v[26:27], v[26:27], v[30:31]
    v_pk_add_f32 v[16:17], v[16:17], v[24:25]
    v_pk_add_f32 v[18:19], v[18:19], v[26:27]
    v_mul_f32 v20, s16, v16
    v_mul_f32 v21, s16, v17
    v_mul_f32 v22, s16, v18
    v_mul_f32 v23, s16, v19
    v_exp_f32 v20, v20
    v_exp_f32 v21, v21
    v_exp_f32 v22, v22
    v_exp_f32 v23, v23
    v_pk_mul_f32 v[16:17], v[16:17], v[68:69]
    v_pk_mul_f32 v[18:19], v[18:19], v[70:71]
    v_add_f32 v20, 1.0, v20
    v_add_f32 v21, 1.0, v21
    v_add_f32 v22, 1.0, v22
    v_add_f32 v23, 1.0, v23
    v_rcp_f32 v20, v20
    v_rcp_f32 v21, v21
    v_rcp_f32 v22, v22
    v_rcp_f32 v23, v23
    v_fma_f32 v16, v16, v20, v84
    v_fma_f32 v17, v17, v21, v85
    v_fma_f32 v18, v18, v22, v86
    v_fma_f32 v19, v19, v23, v87
    v_cvt_pk_bf16_f32 v24, v16, v17
    v_cvt_pk_bf16_f32 v25, v18, v19
    buffer_store_dwordx2 v[24:25], v247, s[44:47], s18 offen
    s_waitcnt lgkmcnt(3)
    v_pk_add_f32 v[32:33], v[32:33], v[36:37]
    v_pk_add_f32 v[40:41], v[40:41], v[44:45]
    v_pk_add_f32 v[34:35], v[34:35], v[38:39]
    v_pk_add_f32 v[42:43], v[42:43], v[46:47]
    v_pk_add_f32 v[32:33], v[32:33], v[40:41]
    v_pk_add_f32 v[34:35], v[34:35], v[42:43]
    v_mul_f32 v36, s16, v32
    v_mul_f32 v37, s16, v33
    v_mul_f32 v38, s16, v34
    v_mul_f32 v39, s16, v35
    v_exp_f32 v36, v36
    v_exp_f32 v37, v37
    v_exp_f32 v38, v38
    v_exp_f32 v39, v39
    v_add_f32 v36, 1.0, v36
    v_add_f32 v37, 1.0, v37
    v_add_f32 v38, 1.0, v38
    v_add_f32 v39, 1.0, v39
    v_rcp_f32 v36, v36
    v_rcp_f32 v37, v37
    v_rcp_f32 v38, v38
    v_rcp_f32 v39, v39
    s_waitcnt vmcnt(2)
    v_mfma_f32_16x16x32_bf16 a[232:235], v[234:237], v[152:155], a[232:235]
    v_mfma_f32_16x16x32_bf16 a[236:239], v[232:235], v[152:155], a[236:239]
    v_mfma_f32_16x16x32_bf16 a[232:235], v[234:237], v[156:159], a[232:235]
    v_mfma_f32_16x16x32_bf16 a[236:239], v[232:235], v[156:159], a[236:239]
    v_mfma_f32_16x16x32_bf16 a[232:235], v[234:237], v[160:163], a[232:235]
    v_mfma_f32_16x16x32_bf16 a[236:239], v[232:235], v[160:163], a[236:239]
    v_mfma_f32_16x16x32_bf16 a[232:235], v[234:237], v[164:167], a[232:235]
    v_mfma_f32_16x16x32_bf16 a[236:239], v[232:235], v[164:167], a[236:239]
    v_mfma_f32_16x16x32_bf16 a[232:235], v[234:237], v[168:171], a[232:235]
    v_mfma_f32_16x16x32_bf16 a[236:239], v[232:235], v[168:171], a[236:239]
    v_mfma_f32_16x16x32_bf16 a[232:235], v[234:237], v[172:175], a[232:235]
    v_mfma_f32_16x16x32_bf16 a[236:239], v[232:235], v[172:175], a[236:239]
    v_mfma_f32_16x16x32_bf16 a[232:235], v[234:237], v[176:179], a[232:235]
    v_mfma_f32_16x16x32_bf16 a[236:239], v[232:235], v[176:179], a[236:239]
    v_mfma_f32_16x16x32_bf16 a[232:235], v[234:237], v[180:183], a[232:235]
    v_mfma_f32_16x16x32_bf16 a[236:239], v[232:235], v[180:183], a[236:239]
    v_mfma_f32_16x16x32_bf16 a[232:235], v[234:237], v[184:187], a[232:235]
    v_mfma_f32_16x16x32_bf16 a[236:239], v[232:235], v[184:187], a[236:239]
    v_mfma_f32_16x16x32_bf16 a[232:235], v[234:237], v[188:191], a[232:235]
    v_mfma_f32_16x16x32_bf16 a[236:239], v[232:235], v[188:191], a[236:239]
    s_waitcnt lgkmcnt(0)
    v_pk_add_f32 v[48:49], v[48:49], v[52:53]
    v_pk_add_f32 v[56:57], v[56:57], v[60:61]
    v_pk_add_f32 v[50:51], v[50:51], v[54:55]
    v_pk_add_f32 v[58:59], v[58:59], v[62:63]
    v_pk_add_f32 v[48:49], v[48:49], v[56:57]
    v_pk_add_f32 v[50:51], v[50:51], v[58:59]
    v_mul_f32 v52, s16, v48
    v_mul_f32 v53, s16, v49
    v_mul_f32 v54, s16, v50
    v_mul_f32 v55, s16, v51
    v_exp_f32 v52, v52
    v_exp_f32 v53, v53
    v_exp_f32 v54, v54
    v_exp_f32 v55, v55
    v_add_f32 v52, 1.0, v52
    v_add_f32 v53, 1.0, v53
    v_add_f32 v54, 1.0, v54
    v_add_f32 v55, 1.0, v55
    v_rcp_f32 v52, v52
    v_rcp_f32 v53, v53
    v_rcp_f32 v54, v54
    v_rcp_f32 v55, v55
    v_accvgpr_read_b32 v72, a232
    v_accvgpr_read_b32 v73, a233
    v_accvgpr_read_b32 v74, a234
    v_accvgpr_read_b32 v75, a235
    v_pk_mul_f32 v[32:33], v[32:33], v[72:73]
    v_pk_mul_f32 v[34:35], v[34:35], v[74:75]
    v_fma_f32 v32, v32, v36, v88
    v_fma_f32 v33, v33, v37, v89
    v_fma_f32 v34, v34, v38, v90
    v_fma_f32 v35, v35, v39, v91
    v_cvt_pk_bf16_f32 v40, v32, v33
    v_cvt_pk_bf16_f32 v41, v34, v35
    buffer_store_dwordx2 v[40:41], v247, s[44:47], s19 offen
    v_accvgpr_read_b32 v76, a236
    v_accvgpr_read_b32 v77, a237
    v_accvgpr_read_b32 v78, a238
    v_accvgpr_read_b32 v79, a239
    v_pk_mul_f32 v[48:49], v[48:49], v[76:77]
    v_pk_mul_f32 v[50:51], v[50:51], v[78:79]
    v_fma_f32 v48, v48, v52, v92
    v_fma_f32 v49, v49, v53, v93
    v_fma_f32 v50, v50, v54, v94
    v_fma_f32 v51, v51, v55, v95
    v_cvt_pk_bf16_f32 v56, v48, v49
    v_cvt_pk_bf16_f32 v57, v50, v51
    buffer_store_dwordx2 v[56:57], v247, s[44:47], s28 offen
kb_kernel_end:
    s_endpgm
.section .rodata,"a"
.p2align 6
.amdhsa_kernel ka_kernel
  .amdhsa_next_free_vgpr 512
  .amdhsa_next_free_sgpr 102
  .amdhsa_accum_offset 256
  .amdhsa_group_segment_fixed_size 0
  .amdhsa_kernarg_size 96
  .amdhsa_user_sgpr_count 2
  .amdhsa_user_sgpr_kernarg_segment_ptr 1
  .amdhsa_system_sgpr_workgroup_id_x 1
  .amdhsa_float_denorm_mode_32 3
  .amdhsa_float_denorm_mode_16_64 3
.end_amdhsa_kernel
.p2align 6
.amdhsa_kernel kb_kernel
  .amdhsa_next_free_vgpr 512
  .amdhsa_next_free_sgpr 102
  .amdhsa_accum_offset 256
  .amdhsa_group_segment_fixed_size 0
  .amdhsa_kernarg_size 96
  .amdhsa_user_sgpr_count 2
  .amdhsa_user_sgpr_kernarg_segment_ptr 1
  .amdhsa_system_sgpr_workgroup_id_x 1
  .amdhsa_float_denorm_mode_32 3
  .amdhsa_float_denorm_mode_16_64 3
.end_amdhsa_kernel
```
